```python
import torch

def _softmax(x, axis=-1):
    return torch.softmax(x, dim=axis)
def _gelu(x):
    return torch.nn.functional.gelu(x, approximate="tanh")
def _silu(x):
    return torch.nn.functional.silu(x)
def _sigmoid(x):
    return torch.sigmoid(x)
def _layernorm(x, axis=-1, eps=1e-5):
    m = x.mean(dim=axis, keepdim=True)
    v = x.var(dim=axis, keepdim=True, unbiased=False)
    return (x - m) / torch.sqrt(v + eps)
def _scatter_add(tgt, idx, src, axis=0):
    return tgt.clone().index_add_(axis, idx, src)
def _segment_sum(src, seg, n):
    out = torch.zeros((n,) + src.shape[1:], dtype=src.dtype)
    return out.index_add_(0, seg, src)
def _pad(x, pw):
    flat = tuple(v for pair in reversed(pw) for v in pair)
    return torch.nn.functional.pad(x, flat)

kernel_name = 'concat_heads__mha_block_cached__gqa_block_cached__near_ridge'

def setup_inputs():

    _w = (lambda a: (lambda t: t.to(torch.bfloat16) if t.is_floating_point() else t)(torch.as_tensor(a)))
    def _A_setup():
        B, Sq, D = 8, 160, 448
        H, Sk, Dh = 16, 512, 256
        return {
            "x": _w((lambda *s: torch.randn(*s, dtype=torch.bfloat16) * 0.8)(B, Sq, D)),
            "k_cache": _w((lambda *s: torch.randn(*s, dtype=torch.bfloat16) * 0.8)(B, H, Sk, Dh)),
            "v_cache": _w((lambda *s: torch.randn(*s, dtype=torch.bfloat16) * 0.05)(B, H, Sk, Dh)),
            "wq": _w((lambda *s: torch.randn(*s, dtype=torch.bfloat16) * 0.8)(D, H * Dh) * (D ** -0.5)),
            "wo": _w((lambda *s: torch.randn(*s, dtype=torch.bfloat16) * 0.05)(H * Dh, D) * ((H * Dh) ** -0.5)),
        }
    _A_in = _A_setup()

    def _B_setup():
        B, Sq, D = 8, 160, 448
        Hq, Hkv, Sk, Dh = 16, 16, 512, 256
        assert Hq % Hkv == 0, (Hq, Hkv)
        return {
            "x": _w((lambda *s: torch.randn(*s, dtype=torch.bfloat16) * 0.8)(B, Sq, D)),
            "k_cache": _w((lambda *s: torch.randn(*s, dtype=torch.bfloat16) * 0.8)(B, Hkv, Sk, Dh)),
            "v_cache": _w((lambda *s: torch.randn(*s, dtype=torch.bfloat16) * 0.05)(B, Hkv, Sk, Dh)),
            "wq": _w((lambda *s: torch.randn(*s, dtype=torch.bfloat16) * 0.8)(D, Hq * Dh) * (D ** -0.5)),
            "wo": _w((lambda *s: torch.randn(*s, dtype=torch.bfloat16) * 0.05)(Hq * Dh, D) * ((Hq * Dh) ** -0.5)),
        }
    _B_in = _B_setup()

    return {
        "A_x": _A_in["x"],
        "A_k_cache": _A_in["k_cache"],
        "A_v_cache": _A_in["v_cache"],
        "A_wq": _A_in["wq"],
        "A_wo": _A_in["wo"],
        "B_x": _B_in["x"],
        "B_k_cache": _B_in["k_cache"],
        "B_v_cache": _B_in["v_cache"],
        "B_wq": _B_in["wq"],
        "B_wo": _B_in["wo"],
    }

def reference(A_x, A_k_cache, A_v_cache, A_wq, A_wo, B_x, B_k_cache, B_v_cache, B_wq, B_wo):
    def _A_ref(x, k_cache, v_cache, wq, wo):
        B, Sq, D = x.shape
        H, Dh = 16, 256
        q = (lambda x, *d: x.permute(*d))((x @ wq).reshape(B, Sq, H, Dh), 0, 2, 1, 3)
        scores = torch.einsum("bhqd,bhkd->bhqk", q, k_cache) * (Dh ** -0.5)
        p = _softmax(scores, axis=-1)
        o = torch.einsum("bhqk,bhkd->bhqd", p, v_cache)
        return (lambda x, *d: x.permute(*d))(o, 0, 2, 1, 3).reshape(B, Sq, H * Dh) @ wo

    def _B_ref(x, k_cache, v_cache, wq, wo):
        B, Sq, D = x.shape
        Hq, Dh = 16, 256
        Hkv = k_cache.shape[1]
        rep = Hq // Hkv
        q = (lambda x, *d: x.permute(*d))((x @ wq).reshape(B, Sq, Hq, Dh), 0, 2, 1, 3)
        k = (lambda x, n, axis: torch.repeat_interleave(x, n, dim=axis))(k_cache, rep, axis=1)
        v = (lambda x, n, axis: torch.repeat_interleave(x, n, dim=axis))(v_cache, rep, axis=1)
        scores = torch.einsum("bhqd,bhkd->bhqk", q, k) * (Dh ** -0.5)
        p = _softmax(scores, axis=-1)
        o = torch.einsum("bhqk,bhkd->bhqd", p, v)
        return (lambda x, *d: x.permute(*d))(o, 0, 2, 1, 3).reshape(B, Sq, Hq * Dh) @ wo

    a = _A_ref(A_x, A_k_cache, A_v_cache, A_wq, A_wo)
    b = _B_ref(B_x, B_k_cache, B_v_cache, B_wq, B_wo)
    return torch.concatenate([a, b], axis=-1)
```

```asm
; @launch grid=(256,1,1) block=(256,1,1) lds=163840
.amdgcn_target "amdgcn-amd-amdhsa--gfx950"
.macro Maaa d,a,b
  v_mfma_f32_16x16x32_bf16 a[\d:\d+3], a[\a:\a+3], a[\b:\b+3], a[\d:\d+3]
.endm
.macro Maaaz d,a,b
  v_mfma_f32_16x16x32_bf16 a[\d:\d+3], a[\a:\a+3], a[\b:\b+3], 0
.endm
.macro Maav d,a,b
  v_mfma_f32_16x16x32_bf16 a[\d:\d+3], a[\a:\a+3], v[\b:\b+3], a[\d:\d+3]
.endm
.macro Maavz d,a,b
  v_mfma_f32_16x16x32_bf16 a[\d:\d+3], a[\a:\a+3], v[\b:\b+3], 0
.endm
.macro Mava d,a,b
  v_mfma_f32_16x16x32_bf16 a[\d:\d+3], v[\a:\a+3], a[\b:\b+3], a[\d:\d+3]
.endm
.macro Mavaz d,a,b
  v_mfma_f32_16x16x32_bf16 a[\d:\d+3], v[\a:\a+3], a[\b:\b+3], 0
.endm
.macro Mavv d,a,b
  v_mfma_f32_16x16x32_bf16 a[\d:\d+3], v[\a:\a+3], v[\b:\b+3], a[\d:\d+3]
.endm
.macro Mavvz d,a,b
  v_mfma_f32_16x16x32_bf16 a[\d:\d+3], v[\a:\a+3], v[\b:\b+3], 0
.endm
.macro Mvaa d,a,b
  v_mfma_f32_16x16x32_bf16 v[\d:\d+3], a[\a:\a+3], a[\b:\b+3], v[\d:\d+3]
.endm
.macro Mvaaz d,a,b
  v_mfma_f32_16x16x32_bf16 v[\d:\d+3], a[\a:\a+3], a[\b:\b+3], 0
.endm
.macro Mvav d,a,b
  v_mfma_f32_16x16x32_bf16 v[\d:\d+3], a[\a:\a+3], v[\b:\b+3], v[\d:\d+3]
.endm
.macro Mvavz d,a,b
  v_mfma_f32_16x16x32_bf16 v[\d:\d+3], a[\a:\a+3], v[\b:\b+3], 0
.endm
.macro Mvva d,a,b
  v_mfma_f32_16x16x32_bf16 v[\d:\d+3], v[\a:\a+3], a[\b:\b+3], v[\d:\d+3]
.endm
.macro Mvvaz d,a,b
  v_mfma_f32_16x16x32_bf16 v[\d:\d+3], v[\a:\a+3], a[\b:\b+3], 0
.endm
.macro Mvvv d,a,b
  v_mfma_f32_16x16x32_bf16 v[\d:\d+3], v[\a:\a+3], v[\b:\b+3], v[\d:\d+3]
.endm
.macro Mvvvz d,a,b
  v_mfma_f32_16x16x32_bf16 v[\d:\d+3], v[\a:\a+3], v[\b:\b+3], 0
.endm
.macro T d,x,o
  ds_read_b64_tr_b16 a[\d:\d+1], v\x offset:\o
.endm
.macro R d,x,o
  ds_read_b128 a[\d:\d+3], v\x offset:\o
.endm
.macro CV d,a,b
  v_cvt_pk_bf16_f32 v\d, v\a, v\b
.endm
.macro AR d,a
  v_accvgpr_read_b32 v\d, a\a
.endm
.macro AW d,a
  v_accvgpr_write_b32 a\d, v\a
.endm
.macro Mc d,a,b,c
  v_mfma_f32_16x16x32_bf16 v[\d:\d+3], a[\a:\a+3], v[\b:\b+3], v[\c:\c+3]
.endm
.macro EX d
  v_exp_f32 v\d, v\d
.endm
.text
.globl concat_heads__mha_block_cached__gqa_block_cached__near_ridge_kernel
.p2align 8
.type concat_heads__mha_block_cached__gqa_block_cached__near_ridge_kernel,@function
concat_heads__mha_block_cached__gqa_block_cached__near_ridge_kernel:
L_code_start:
 s_cmp_ge_u32 s2, 256
 s_cbranch_scc1 L_exit0
 s_bfe_u32 s39, s2, 0x10002
 s_mul_i32 s45, s39, 40
 s_add_u32 s40, s0, s45
 s_addc_u32 s41, s1, 0
 s_load_dwordx8 s[48:55], s[40:41], 0
 s_load_dwordx2 s[56:57], s[40:41], 32
 s_load_dwordx2 s[58:59], s[0:1], 96
 s_load_dwordx4 s[92:95], s[0:1], 80
 s_lshr_b32 s38, s2, 3
 s_mov_b32 s31, 0x00020000
 s_getpc_b64 s[28:29]
L_pc:
 s_mov_b32 s30, L_code_end-L_pc
 s_lshl_b32 s45, s38, 12
 v_lshrrev_b32 v5, 2, v0
 v_lshlrev_b32 v5, 7, v5
 buffer_load_dword v198, v5, s[28:31], s45 offen
 s_mov_b32 s37, 1
L_setup:
 s_and_b32 s3, s2, 3
 s_lshl_b32 s3, s3, 2
 s_and_b32 s45, s38, 3
 s_add_u32 s3, s3, s45
 s_lshr_b32 s44, s38, 2
 v_lshrrev_b32 v2, 6, v0
 v_and_b32 v1, 63, v0
 v_readfirstlane_b32 s60, v2
 v_lshrrev_b32 v5, 3, v1
 v_lshrrev_b32 v6, 4, v1
 v_and_b32 v7, 7, v1
 v_xor_b32 v6, v6, v7
 v_mul_u32_u24 v5, 896, v5
 v_lshl_add_u32 v205, v6, 4, v5
 v_xor_b32 v206, 64, v205
 v_add_u32 v206, 6144, v206
 v_lshrrev_b32 v3, 5, v1
 v_and_b32 v4, 31, v1
 v_lshlrev_b32 v5, 1, v3
 v_xor_b32 v2, v4, v5
 s_lshr_b32 s45, s60, 1
 s_lshl_b32 s33, s45, 12
 s_lshl_b32 s61, s60, 12
 s_lshl_b32 s62, s45, 11
 s_add_u32 s62, s62, 16384
 s_mul_i32 s63, s45, 10240
 s_mul_i32 s32, s45, 71680
 s_mov_b32 s6, 71680
 s_mov_b32 s7, 0x00020000
 s_mul_i32 s45, s44, 143360
 s_add_u32 s45, s45, s32
 s_waitcnt lgkmcnt(0)
 s_mov_b32 s41, s63
 s_add_u32 s4, s48, s45
 s_addc_u32 s5, s49, 0
 s_bitcmp1_b32 s60, 0
 s_cbranch_scc1 L_startE1
 s_add_u32 m0, s41, 49152
 s_mov_b32 s32, 0
 buffer_load_dwordx4 v205, s[4:7], s32 offen lds
 buffer_load_dwordx4 v206, s[4:7], s32 offen offset:1024 lds
 s_add_u32 m0, s41, 51200
 s_mov_b32 s32, 14336
 buffer_load_dwordx4 v205, s[4:7], s32 offen lds
 buffer_load_dwordx4 v206, s[4:7], s32 offen offset:1024 lds
 s_add_u32 m0, s41, 53248
 s_mov_b32 s32, 28672
 buffer_load_dwordx4 v205, s[4:7], s32 offen lds
 buffer_load_dwordx4 v206, s[4:7], s32 offen offset:1024 lds
 s_add_u32 m0, s41, 55296
 s_mov_b32 s32, 43008
 buffer_load_dwordx4 v205, s[4:7], s32 offen lds
 buffer_load_dwordx4 v206, s[4:7], s32 offen offset:1024 lds
 s_add_u32 m0, s41, 57344
 s_mov_b32 s32, 57344
 buffer_load_dwordx4 v205, s[4:7], s32 offen lds
 buffer_load_dwordx4 v206, s[4:7], s32 offen offset:1024 lds
 v_lshlrev_b32 v5, 13, v3
 v_xor_b32 v6, 0, v2
 v_lshl_add_u32 v248, v6, 4, v5
 v_xor_b32 v6, 4, v2
 v_lshl_add_u32 v249, v6, 4, v5
 v_add_u32 v249, 15360, v249
 v_xor_b32 v6, 8, v2
 v_lshl_add_u32 v250, v6, 4, v5
 v_add_u32 v250, 63488, v250
 v_xor_b32 v6, 12, v2
 v_lshl_add_u32 v251, v6, 4, v5
 v_add_u32 v251, 78848, v251
 s_lshl_b32 s45, s3, 9
 s_lshl_b32 s32, s33, 5
 s_add_u32 s45, s45, s32
 s_sub_u32 s10, 3670016, s45
 s_mov_b32 s11, 0x00020000
 s_add_u32 s8, s54, s45
 s_addc_u32 s9, s55, 0
 s_add_u32 m0, s33, 131072
 s_mov_b32 s32, 0
 buffer_load_dwordx4 v248, s[8:11], s32 offen lds
 buffer_load_dwordx4 v249, s[8:11], s32 offen offset:1024 lds
 buffer_load_dwordx4 v250, s[8:11], s32 offen offset:2048 lds
 buffer_load_dwordx4 v251, s[8:11], s32 offen offset:3072 lds
 s_add_u32 m0, s33, 139264
 s_mov_b32 s32, 32768
 buffer_load_dwordx4 v248, s[8:11], s32 offen lds
 buffer_load_dwordx4 v249, s[8:11], s32 offen offset:1024 lds
 buffer_load_dwordx4 v250, s[8:11], s32 offen offset:2048 lds
 buffer_load_dwordx4 v251, s[8:11], s32 offen offset:3072 lds
 v_lshrrev_b32 v5, 2, v1
 v_lshlrev_b32 v208, 9, v5
 v_and_b32 v5, 7, v5
 v_lshl_add_u32 v208, v5, 5, v208
 v_and_b32 v5, 3, v1
 v_lshl_add_u32 v208, v5, 3, v208
 v_xor_b32 v209, 32, v208
 v_xor_b32 v210, 64, v208
 v_xor_b32 v211, 96, v208
 v_xor_b32 v212, 128, v208
 v_xor_b32 v213, 160, v208
 v_xor_b32 v214, 192, v208
 v_xor_b32 v215, 224, v208
 v_add_u32 v216, 65536, v208
 v_add_u32 v217, 65536, v209
 v_add_u32 v218, 65536, v210
 v_add_u32 v219, 65536, v211
 v_add_u32 v220, 65536, v212
 v_add_u32 v221, 65536, v213
 v_add_u32 v222, 65536, v214
 v_add_u32 v223, 65536, v215
 v_add_u32 v224, 131072, v208
 v_add_u32 v225, 131072, v209
 v_add_u32 v226, 131072, v210
 v_add_u32 v227, 131072, v211
 v_add_u32 v228, 131072, v212
 v_add_u32 v229, 131072, v213
 v_add_u32 v230, 131072, v214
 v_add_u32 v231, 131072, v215
 v_and_b32 v5, 15, v1
 v_lshrrev_b32 v6, 1, v5
 v_lshrrev_b32 v7, 4, v1
 v_xor_b32 v6, v6, v7
 v_lshlrev_b32 v6, 4, v6
 v_lshl_add_u32 v7, v5, 7, v6
 v_add_u32 v7, 49152, v7
 v_add_u32 v195, s61, v7
 v_xor_b32 v196, 64, v195
 v_add_u32 v197, s62, v7
 v_xor_b32 v207, 64, v197
 s_add_u32 m0, s33, 147456
 s_mov_b32 s32, 262144
 buffer_load_dwordx4 v248, s[8:11], s32 offen lds
 buffer_load_dwordx4 v249, s[8:11], s32 offen offset:1024 lds
 buffer_load_dwordx4 v250, s[8:11], s32 offen offset:2048 lds
 buffer_load_dwordx4 v251, s[8:11], s32 offen offset:3072 lds
 s_add_u32 m0, s33, 155648
 s_mov_b32 s32, 294912
 buffer_load_dwordx4 v248, s[8:11], s32 offen lds
 buffer_load_dwordx4 v249, s[8:11], s32 offen offset:1024 lds
 buffer_load_dwordx4 v250, s[8:11], s32 offen offset:2048 lds
 buffer_load_dwordx4 v251, s[8:11], s32 offen offset:3072 lds
 s_add_u32 m0, s41, 69632
 s_mov_b32 s32, 128
 buffer_load_dwordx4 v205, s[4:7], s32 offen lds
 buffer_load_dwordx4 v206, s[4:7], s32 offen offset:1024 lds
 s_add_u32 m0, s41, 71680
 s_mov_b32 s32, 14464
 buffer_load_dwordx4 v205, s[4:7], s32 offen lds
 buffer_load_dwordx4 v206, s[4:7], s32 offen offset:1024 lds
 s_add_u32 m0, s41, 73728
 s_mov_b32 s32, 28800
 buffer_load_dwordx4 v205, s[4:7], s32 offen lds
 buffer_load_dwordx4 v206, s[4:7], s32 offen offset:1024 lds
 s_add_u32 m0, s41, 75776
 s_mov_b32 s32, 43136
 buffer_load_dwordx4 v205, s[4:7], s32 offen lds
 buffer_load_dwordx4 v206, s[4:7], s32 offen offset:1024 lds
 s_add_u32 m0, s41, 77824
 s_mov_b32 s32, 57472
 buffer_load_dwordx4 v205, s[4:7], s32 offen lds
 buffer_load_dwordx4 v206, s[4:7], s32 offen offset:1024 lds
 s_lshr_b32 s45, s33, 9
 v_xor_b32 v5, v4, v3
 v_xor_b32 v5, s45, v5
 v_lshlrev_b32 v6, 9, v3
 v_lshl_add_u32 v244, v5, 4, v6
 v_xor_b32 v245, 32, v244
 v_xor_b32 v246, 64, v244
 v_xor_b32 v247, 96, v244
 s_lshl_b32 s45, s44, 4
 s_add_u32 s45, s45, s3
 s_lshl_b32 s45, s45, 18
 s_add_u32 s45, s45, s33
 s_sub_u32 s14, 262144, s33
 s_mov_b32 s15, 0x00020000
 s_add_u32 s12, s50, s45
 s_addc_u32 s13, s51, 0
 v_and_b32 v5, 15, v1
 v_bfe_u32 v6, v1, 4, 1
 v_lshlrev_b32 v6, 1, v6
 v_or_b32 v6, v6, v3
 v_xor_b32 v6, v6, v5
 v_lshlrev_b32 v6, 4, v6
 v_lshl_add_u32 v232, v5, 9, v6
 v_xor_b32 v233, 64, v232
 v_xor_b32 v234, 128, v232
 v_xor_b32 v235, 192, v232
 v_add_u32 v236, 65536, v232
 v_add_u32 v237, 65536, v233
 v_add_u32 v238, 65536, v234
 v_add_u32 v239, 65536, v235
 v_add_u32 v240, 131072, v232
 v_add_u32 v241, 131072, v233
 v_add_u32 v242, 131072, v234
 v_add_u32 v243, 131072, v235
 v_lshlrev_b32 v204, 4, v1
 s_add_u32 s45, s61, 81920
 v_add_u32 v202, s45, v204
 v_xor_b32 v203, 0x1000, v202
 v_xor_b32 v5, 0, v2
 v_lshrrev_b32 v6, 3, v5
 v_lshl_add_u32 v6, v6, 5, v3
 v_mul_u32_u24 v6, 896, v6
 v_and_b32 v5, 7, v5
 v_lshl_add_u32 v252, v5, 4, v6
 v_xor_b32 v5, 4, v2
 v_lshrrev_b32 v6, 3, v5
 v_lshl_add_u32 v6, v6, 5, v3
 v_mul_u32_u24 v6, 896, v6
 v_and_b32 v5, 7, v5
 v_lshl_add_u32 v253, v5, 4, v6
 v_add_u32 v253, 768, v253
 v_xor_b32 v5, 8, v2
 v_lshrrev_b32 v6, 3, v5
 v_lshl_add_u32 v6, v6, 5, v3
 v_mul_u32_u24 v6, 896, v6
 v_and_b32 v5, 7, v5
 v_lshl_add_u32 v254, v5, 4, v6
 v_add_u32 v254, 1536, v254
 v_xor_b32 v5, 12, v2
 v_lshrrev_b32 v6, 3, v5
 v_lshl_add_u32 v6, v6, 5, v3
 v_mul_u32_u24 v6, 896, v6
 v_and_b32 v5, 7, v5
 v_lshl_add_u32 v255, v5, 4, v6
 v_add_u32 v255, 2304, v255
 s_lshl_b32 s45, s3, 8
 s_lshr_b32 s32, s33, 9
 s_add_u32 s45, s45, s32
 s_mul_i32 s45, s45, 896
 s_add_u32 s20, s56, s45
 s_addc_u32 s21, s57, 0
 s_mul_i32 s32, s32, 896
 s_sub_u32 s22, 229376, s32
 s_mov_b32 s23, 0x00020000
 s_lshl_b32 s45, s39, 3
 s_add_u32 s45, s45, s44
 s_lshl_b32 s45, s45, 4
 s_add_u32 s88, s94, s45
 s_addc_u32 s89, s95, 0
 s_mov_b32 s90, 16
 s_mov_b32 s91, 0x00020000
 s_mul_i32 s32, s45, 16
 s_add_u32 s32, s32, 41943040
 s_add_u32 s84, s58, s32
 s_addc_u32 s85, s59, 0
 s_mov_b32 s86, 64
 s_mov_b32 s87, 0x00020000
 s_add_u32 s45, s45, s3
 s_mul_i32 s45, s45, 143360
 s_add_u32 s24, s58, s45
 s_addc_u32 s25, s59, 0
 s_mov_b32 s26, 143360
 s_mov_b32 s27, 0x00020000
 s_add_u32 s46, s3, s33
 s_lshl_b32 s47, s46, 2
 s_mul_i32 s68, s60, 5120
 s_mov_b32 s34, 0x3db8aa3b
 s_mov_b32 s36, 0x4e800000
 s_lshl_b32 s67, s38, 1
 s_add_u32 s67, s67, s60
 s_lshl_b32 s67, s67, 11
 s_mul_i32 s64, s44, 286720
 s_mul_i32 s45, s39, 896
 s_add_u32 s64, s64, s45
 s_lshl_b32 s78, s60, 2
 s_sub_u32 s78, s3, s78
 s_and_b32 s78, s78, 15
 s_mov_b32 s80, 143360
 s_mov_b32 s81, 286720
 s_add_u32 s79, s78, 0
 s_mul_hi_u32 s45, s79, 858993460
 s_mul_i32 s66, s45, 15
 s_add_u32 s66, s66, s79
 s_mul_i32 s45, s60, 5
 s_add_u32 s66, s66, s45
 s_add_u32 s66, s66, 0
 s_mul_hi_u32 s45, s66, 858993460
 s_mul_i32 s32, s45, 5
 s_sub_u32 s32, s66, s32
 s_and_b32 s63, s45, 3
 s_lshr_b32 s45, s45, 2
 s_lshl_b32 s69, s63, 2
 s_add_u32 s69, s69, s32
 s_add_u32 s63, s63, 16
 s_cmp_eq_u32 s32, 4
 s_cselect_b32 s69, s63, s69
 s_lshr_b32 s32, s69, 1
 s_mul_i32 s74, s32, 28672
 s_and_b32 s69, s69, 1
 s_lshl_b32 s45, s45, 1
 s_add_u32 s45, s45, s69
 s_lshl_b32 s45, s45, 6
 s_add_u32 s74, s74, s45
 s_add_u32 s74, s74, s64
 s_lshl_b32 s70, s66, 10
 s_cmp_lt_u32 s79, 20
 s_cselect_b32 s70, s70, 0x10000000
 s_cselect_b32 s74, s74, 0x10000000
 s_add_u32 s79, s78, 16
 s_mul_hi_u32 s45, s79, 858993460
 s_mul_i32 s66, s45, 15
 s_add_u32 s66, s66, s79
 s_mul_i32 s45, s60, 5
 s_add_u32 s66, s66, s45
 s_add_u32 s66, s66, 0
 s_mul_hi_u32 s45, s66, 858993460
 s_mul_i32 s32, s45, 5
 s_sub_u32 s32, s66, s32
 s_and_b32 s63, s45, 3
 s_lshr_b32 s45, s45, 2
 s_lshl_b32 s69, s63, 2
 s_add_u32 s69, s69, s32
 s_add_u32 s63, s63, 16
 s_cmp_eq_u32 s32, 4
 s_cselect_b32 s69, s63, s69
 s_lshr_b32 s32, s69, 1
 s_mul_i32 s75, s32, 28672
 s_and_b32 s69, s69, 1
 s_lshl_b32 s45, s45, 1
 s_add_u32 s45, s45, s69
 s_lshl_b32 s45, s45, 6
 s_add_u32 s75, s75, s45
 s_add_u32 s75, s75, s64
 s_lshl_b32 s71, s66, 10
 s_cmp_lt_u32 s79, 20
 s_cselect_b32 s71, s71, 0x10000000
 s_cselect_b32 s75, s75, 0x10000000
 s_add_u32 s79, s78, 0
 s_mul_hi_u32 s45, s79, 858993460
 s_mul_i32 s66, s45, 15
 s_add_u32 s66, s66, s79
 s_mul_i32 s45, s60, 5
 s_add_u32 s66, s66, s45
 s_add_u32 s66, s66, 80
 s_mul_hi_u32 s45, s66, 858993460
 s_mul_i32 s32, s45, 5
 s_sub_u32 s32, s66, s32
 s_and_b32 s63, s45, 3
 s_lshr_b32 s45, s45, 2
 s_lshl_b32 s69, s63, 2
 s_add_u32 s69, s69, s32
 s_add_u32 s63, s63, 16
 s_cmp_eq_u32 s32, 4
 s_cselect_b32 s69, s63, s69
 s_lshr_b32 s32, s69, 1
 s_mul_i32 s76, s32, 28672
 s_and_b32 s69, s69, 1
 s_lshl_b32 s45, s45, 1
 s_add_u32 s45, s45, s69
 s_lshl_b32 s45, s45, 6
 s_add_u32 s76, s76, s45
 s_add_u32 s76, s76, s64
 s_lshl_b32 s72, s66, 10
 s_cmp_lt_u32 s79, 15
 s_cselect_b32 s72, s72, 0x10000000
 s_cselect_b32 s76, s76, 0x10000000
 v_mov_b32 v192, 0xff800000
 v_mov_b32 v193, 0xff800000
 v_mov_b32 v194, 0xff800000
 s_branch L_mainE0
L_exit0:
 s_endpgm
L_startE1:
 s_lshr_b32 s45, s33, 9
 v_xor_b32 v5, v4, v3
 v_xor_b32 v5, s45, v5
 v_lshlrev_b32 v6, 9, v3
 v_lshl_add_u32 v244, v5, 4, v6
 v_xor_b32 v245, 32, v244
 v_xor_b32 v246, 64, v244
 v_xor_b32 v247, 96, v244
 s_lshl_b32 s45, s44, 4
 s_add_u32 s45, s45, s3
 s_lshl_b32 s45, s45, 18
 s_add_u32 s45, s45, s33
 s_sub_u32 s14, 262144, s33
 s_mov_b32 s15, 0x00020000
 s_add_u32 s12, s50, s45
 s_addc_u32 s13, s51, 0
 v_lshl_add_u32 v248, v2, 4, v6
 v_xor_b32 v249, 64, v248
 v_xor_b32 v250, 128, v248
 v_xor_b32 v251, 192, v248
 s_mov_b32 s18, s14
 s_mov_b32 s19, 0x00020000
 s_add_u32 s16, s52, s45
 s_addc_u32 s17, s53, 0
 s_add_u32 m0, s33, 0
 s_mov_b32 s32, 0
 buffer_load_dwordx4 v244, s[12:15], s32 offen nt lds
 buffer_load_dwordx4 v245, s[12:15], s32 offen offset:1024 nt lds
 buffer_load_dwordx4 v246, s[12:15], s32 offen offset:2048 nt lds
 buffer_load_dwordx4 v247, s[12:15], s32 offen offset:3072 nt lds
 s_add_u32 m0, s33, 8192
 s_mov_b32 s32, 8192
 buffer_load_dwordx4 v244, s[12:15], s32 offen nt lds
 buffer_load_dwordx4 v245, s[12:15], s32 offen offset:1024 nt lds
 buffer_load_dwordx4 v246, s[12:15], s32 offen offset:2048 nt lds
 buffer_load_dwordx4 v247, s[12:15], s32 offen offset:3072 nt lds
 v_lshrrev_b32 v5, 2, v1
 v_lshlrev_b32 v208, 9, v5
 v_and_b32 v5, 7, v5
 v_lshl_add_u32 v208, v5, 5, v208
 v_and_b32 v5, 3, v1
 v_lshl_add_u32 v208, v5, 3, v208
 v_xor_b32 v209, 32, v208
 v_xor_b32 v210, 64, v208
 v_xor_b32 v211, 96, v208
 v_xor_b32 v212, 128, v208
 v_xor_b32 v213, 160, v208
 v_xor_b32 v214, 192, v208
 v_xor_b32 v215, 224, v208
 v_add_u32 v216, 65536, v208
 v_add_u32 v217, 65536, v209
 v_add_u32 v218, 65536, v210
 v_add_u32 v219, 65536, v211
 v_add_u32 v220, 65536, v212
 v_add_u32 v221, 65536, v213
 v_add_u32 v222, 65536, v214
 v_add_u32 v223, 65536, v215
 v_add_u32 v224, 131072, v208
 v_add_u32 v225, 131072, v209
 v_add_u32 v226, 131072, v210
 v_add_u32 v227, 131072, v211
 v_add_u32 v228, 131072, v212
 v_add_u32 v229, 131072, v213
 v_add_u32 v230, 131072, v214
 v_add_u32 v231, 131072, v215
 v_and_b32 v5, 15, v1
 v_lshrrev_b32 v6, 1, v5
 v_lshrrev_b32 v7, 4, v1
 v_xor_b32 v6, v6, v7
 v_lshlrev_b32 v6, 4, v6
 v_lshl_add_u32 v7, v5, 7, v6
 v_add_u32 v7, 49152, v7
 v_add_u32 v195, s61, v7
 v_xor_b32 v196, 64, v195
 v_add_u32 v197, s62, v7
 v_xor_b32 v207, 64, v197
 v_and_b32 v5, 15, v1
 v_bfe_u32 v6, v1, 4, 1
 v_lshlrev_b32 v6, 1, v6
 v_or_b32 v6, v6, v3
 v_xor_b32 v6, v6, v5
 v_lshlrev_b32 v6, 4, v6
 v_lshl_add_u32 v232, v5, 9, v6
 v_xor_b32 v233, 64, v232
 v_xor_b32 v234, 128, v232
 v_xor_b32 v235, 192, v232
 v_add_u32 v236, 65536, v232
 v_add_u32 v237, 65536, v233
 v_add_u32 v238, 65536, v234
 v_add_u32 v239, 65536, v235
 v_add_u32 v240, 131072, v232
 v_add_u32 v241, 131072, v233
 v_add_u32 v242, 131072, v234
 v_add_u32 v243, 131072, v235
 v_lshlrev_b32 v204, 4, v1
 s_add_u32 s45, s61, 81920
 v_add_u32 v202, s45, v204
 v_xor_b32 v203, 0x1000, v202
 v_xor_b32 v5, 0, v2
 v_lshrrev_b32 v6, 3, v5
 v_lshl_add_u32 v6, v6, 5, v3
 v_mul_u32_u24 v6, 896, v6
 v_and_b32 v5, 7, v5
 v_lshl_add_u32 v252, v5, 4, v6
 v_xor_b32 v5, 4, v2
 v_lshrrev_b32 v6, 3, v5
 v_lshl_add_u32 v6, v6, 5, v3
 v_mul_u32_u24 v6, 896, v6
 v_and_b32 v5, 7, v5
 v_lshl_add_u32 v253, v5, 4, v6
 v_add_u32 v253, 768, v253
 v_xor_b32 v5, 8, v2
 v_lshrrev_b32 v6, 3, v5
 v_lshl_add_u32 v6, v6, 5, v3
 v_mul_u32_u24 v6, 896, v6
 v_and_b32 v5, 7, v5
 v_lshl_add_u32 v254, v5, 4, v6
 v_add_u32 v254, 1536, v254
 v_xor_b32 v5, 12, v2
 v_lshrrev_b32 v6, 3, v5
 v_lshl_add_u32 v6, v6, 5, v3
 v_mul_u32_u24 v6, 896, v6
 v_and_b32 v5, 7, v5
 v_lshl_add_u32 v255, v5, 4, v6
 v_add_u32 v255, 2304, v255
 s_lshl_b32 s45, s3, 8
 s_lshr_b32 s32, s33, 9
 s_add_u32 s45, s45, s32
 s_mul_i32 s45, s45, 896
 s_add_u32 s20, s56, s45
 s_addc_u32 s21, s57, 0
 s_mul_i32 s32, s32, 896
 s_sub_u32 s22, 229376, s32
 s_mov_b32 s23, 0x00020000
 s_lshl_b32 s45, s39, 3
 s_add_u32 s45, s45, s44
 s_lshl_b32 s45, s45, 4
 s_add_u32 s88, s94, s45
 s_addc_u32 s89, s95, 0
 s_mov_b32 s90, 16
 s_mov_b32 s91, 0x00020000
 s_mul_i32 s32, s45, 16
 s_add_u32 s32, s32, 41943040
 s_add_u32 s84, s58, s32
 s_addc_u32 s85, s59, 0
 s_mov_b32 s86, 64
 s_mov_b32 s87, 0x00020000
 s_add_u32 s45, s45, s3
 s_mul_i32 s45, s45, 143360
 s_add_u32 s24, s58, s45
 s_addc_u32 s25, s59, 0
 s_mov_b32 s26, 143360
 s_mov_b32 s27, 0x00020000
 s_add_u32 s46, s3, s33
 s_lshl_b32 s47, s46, 2
 s_mul_i32 s68, s60, 5120
 s_mov_b32 s34, 0x3db8aa3b
 s_mov_b32 s36, 0x4e800000
 s_lshl_b32 s67, s38, 1
 s_add_u32 s67, s67, s60
 s_lshl_b32 s67, s67, 11
 s_mul_i32 s64, s44, 286720
 s_mul_i32 s45, s39, 896
 s_add_u32 s64, s64, s45
 s_lshl_b32 s78, s60, 2
 s_sub_u32 s78, s3, s78
 s_and_b32 s78, s78, 15
 s_mov_b32 s80, 143360
 s_mov_b32 s81, 286720
 s_add_u32 s79, s78, 0
 s_mul_hi_u32 s45, s79, 858993460
 s_mul_i32 s66, s45, 15
 s_add_u32 s66, s66, s79
 s_mul_i32 s45, s60, 5
 s_add_u32 s66, s66, s45
 s_add_u32 s66, s66, 0
 s_mul_hi_u32 s45, s66, 858993460
 s_mul_i32 s32, s45, 5
 s_sub_u32 s32, s66, s32
 s_and_b32 s63, s45, 3
 s_lshr_b32 s45, s45, 2
 s_lshl_b32 s69, s63, 2
 s_add_u32 s69, s69, s32
 s_add_u32 s63, s63, 16
 s_cmp_eq_u32 s32, 4
 s_cselect_b32 s69, s63, s69
 s_lshr_b32 s32, s69, 1
 s_mul_i32 s74, s32, 28672
 s_and_b32 s69, s69, 1
 s_lshl_b32 s45, s45, 1
 s_add_u32 s45, s45, s69
 s_lshl_b32 s45, s45, 6
 s_add_u32 s74, s74, s45
 s_add_u32 s74, s74, s64
 s_lshl_b32 s70, s66, 10
 s_cmp_lt_u32 s79, 20
 s_cselect_b32 s70, s70, 0x10000000
 s_cselect_b32 s74, s74, 0x10000000
 s_add_u32 s79, s78, 16
 s_mul_hi_u32 s45, s79, 858993460
 s_mul_i32 s66, s45, 15
 s_add_u32 s66, s66, s79
 s_mul_i32 s45, s60, 5
 s_add_u32 s66, s66, s45
 s_add_u32 s66, s66, 0
 s_mul_hi_u32 s45, s66, 858993460
 s_mul_i32 s32, s45, 5
 s_sub_u32 s32, s66, s32
 s_and_b32 s63, s45, 3
 s_lshr_b32 s45, s45, 2
 s_lshl_b32 s69, s63, 2
 s_add_u32 s69, s69, s32
 s_add_u32 s63, s63, 16
 s_cmp_eq_u32 s32, 4
 s_cselect_b32 s69, s63, s69
 s_lshr_b32 s32, s69, 1
 s_mul_i32 s75, s32, 28672
 s_and_b32 s69, s69, 1
 s_lshl_b32 s45, s45, 1
 s_add_u32 s45, s45, s69
 s_lshl_b32 s45, s45, 6
 s_add_u32 s75, s75, s45
 s_add_u32 s75, s75, s64
 s_lshl_b32 s71, s66, 10
 s_cmp_lt_u32 s79, 20
 s_cselect_b32 s71, s71, 0x10000000
 s_cselect_b32 s75, s75, 0x10000000
 s_add_u32 s79, s78, 0
 s_mul_hi_u32 s45, s79, 858993460
 s_mul_i32 s66, s45, 15
 s_add_u32 s66, s66, s79
 s_mul_i32 s45, s60, 5
 s_add_u32 s66, s66, s45
 s_add_u32 s66, s66, 80
 s_mul_hi_u32 s45, s66, 858993460
 s_mul_i32 s32, s45, 5
 s_sub_u32 s32, s66, s32
 s_and_b32 s63, s45, 3
 s_lshr_b32 s45, s45, 2
 s_lshl_b32 s69, s63, 2
 s_add_u32 s69, s69, s32
 s_add_u32 s63, s63, 16
 s_cmp_eq_u32 s32, 4
 s_cselect_b32 s69, s63, s69
 s_lshr_b32 s32, s69, 1
 s_mul_i32 s76, s32, 28672
 s_and_b32 s69, s69, 1
 s_lshl_b32 s45, s45, 1
 s_add_u32 s45, s45, s69
 s_lshl_b32 s45, s45, 6
 s_add_u32 s76, s76, s45
 s_add_u32 s76, s76, s64
 s_lshl_b32 s72, s66, 10
 s_cmp_lt_u32 s79, 15
 s_cselect_b32 s72, s72, 0x10000000
 s_cselect_b32 s76, s76, 0x10000000
 v_mov_b32 v192, 0xff800000
 v_mov_b32 v193, 0xff800000
 v_mov_b32 v194, 0xff800000
 v_mov_b32 v205, 0
 v_lshlrev_b32 v5, 4, v204
 buffer_store_dword v205, v5, s[84:87], s47 offen sc1
 s_branch L_mainE1
L_restart:
 s_waitcnt vmcnt(0) lgkmcnt(0)
 s_nop 15
 s_barrier
 s_mov_b32 s37, 0
 v_mbcnt_lo_u32_b32 v0, -1, 0
 v_mbcnt_hi_u32_b32 v0, -1, v0
 s_lshl_b32 s45, s60, 6
 v_add_u32 v0, s45, v0
 s_branch L_setup
.p2align 6
L_mainE0:
 s_waitcnt vmcnt(18)
 s_barrier
 R 0,195,0
 R 4,195,2048
 R 8,197,0
 T 192,224,0
 T 194,224,8192
 T 196,228,0
 T 198,228,8192
 T 200,225,0
 T 202,225,8192
 T 204,229,0
 T 206,229,8192
 s_waitcnt lgkmcnt(6)
 Mvaaz 0,192,0
 s_add_u32 m0, s33, 98304
 T 208,226,0
 T 210,226,8192
 Mvaaz 64,192,4
 s_mov_b32 s32, 524288
 T 212,230,0
 T 214,230,8192
 Mvaaz 128,192,8
 s_waitcnt lgkmcnt(8)
 buffer_load_dwordx4 v248, s[8:11], s32 offen lds
 Mvaaz 16,196,0
 T 216,227,0
 T 218,227,8192
 Mvaaz 80,196,4
 s_waitcnt lgkmcnt(8)
 T 220,231,0
 T 222,231,8192
 Mvaaz 4,200,0
 buffer_load_dwordx4 v249, s[8:11], s32 offen offset:1024 lds
 Mvaaz 68,200,4
 T 224,224,256
 T 226,224,8448
 Mvaaz 132,200,8
 s_waitcnt lgkmcnt(8)
 buffer_load_dwordx4 v250, s[8:11], s32 offen offset:2048 lds
 Mvaaz 20,204,0
 T 228,228,256
 T 230,228,8448
 Mvaaz 84,204,4
 buffer_load_dwordx4 v251, s[8:11], s32 offen offset:3072 lds
 Mvaaz 8,208,0
 s_add_u32 m0, s33, 106496
 T 232,225,256
 T 234,225,8448
 Mvaaz 72,208,4
 s_mov_b32 s32, 557056
 buffer_load_dwordx4 v248, s[8:11], s32 offen lds
 Mvaaz 136,208,8
 s_waitcnt lgkmcnt(6)
 R 12,196,0
 Mvaaz 24,212,0
 buffer_load_dwordx4 v249, s[8:11], s32 offen offset:1024 lds
 Mvaaz 88,212,4
 R 16,196,2048
 Mvaaz 12,216,0
 R 20,207,0
 Mvaaz 76,216,4
 T 236,229,256
 T 238,229,8448
 Mvaaz 140,216,8
 s_waitcnt lgkmcnt(5)
 T 240,226,256
 T 242,226,8448
 T 244,230,256
 T 246,230,8448
 T 248,227,256
 T 250,227,8448
 T 252,231,256
 T 254,231,8448
 Mvaaz 28,220,0
 buffer_load_dwordx4 v250, s[8:11], s32 offen offset:2048 lds
 Mvaaz 92,220,4
 s_waitcnt lgkmcnt(12)
 buffer_load_dwordx4 v251, s[8:11], s32 offen offset:3072 lds
 Mvaaz 32,224,0
 Mvaaz 96,224,4
 s_add_u32 m0, s33, 114688
 Mvaaz 160,224,8
 s_waitcnt lgkmcnt(10)
 Mvaaz 48,228,0
 s_mov_b32 s32, 786432
 buffer_load_dwordx4 v248, s[8:11], s32 offen lds
 Mvaaz 112,228,4
 s_waitcnt vmcnt(9) lgkmcnt(0)
 s_barrier
 T 192,224,16384
 Mvaaz 36,232,0
 buffer_load_dwordx4 v249, s[8:11], s32 offen offset:1024 lds
 Mvaaz 100,232,4
 T 194,224,24576
 T 196,228,16384
 Mvaaz 164,232,8
 buffer_load_dwordx4 v250, s[8:11], s32 offen offset:2048 lds
 Mvaaz 52,236,0
 T 198,228,24576
 T 200,225,16384
 Mvaaz 116,236,4
 buffer_load_dwordx4 v251, s[8:11], s32 offen offset:3072 lds
 Mvaaz 40,240,0
 T 202,225,24576
 T 204,229,16384
 Mvaaz 104,240,4
 T 206,229,24576
 Mvaaz 168,240,8
 T 208,226,16384
 T 210,226,24576
 Mvaaz 56,244,0
 s_add_u32 m0, s33, 122880
 R 24,195,20480
 Mvaaz 120,244,4
 s_waitcnt lgkmcnt(8)
 T 212,230,16384
 T 214,230,24576
 Mvaaz 44,248,0
 s_mov_b32 s32, 819200
 buffer_load_dwordx4 v248, s[8:11], s32 offen lds
 Mvaaz 108,248,4
 buffer_load_dwordx4 v249, s[8:11], s32 offen offset:1024 lds
 Mvaaz 172,248,8
 buffer_load_dwordx4 v250, s[8:11], s32 offen offset:2048 lds
 Mvaaz 60,252,0
 T 216,227,16384
 T 218,227,24576
 Mvaaz 124,252,4
 s_waitcnt lgkmcnt(5)
 T 220,231,16384
 T 222,231,24576
 Mvaa 0,192,12
 Mvaa 64,192,16
 Mvaa 128,192,20
 buffer_load_dwordx4 v251, s[8:11], s32 offen offset:3072 lds
 T 224,224,16640
 T 226,224,24832
 Mvaa 16,196,12
 s_add_u32 m0, s41, 49152
 Mvaa 80,196,16
 T 228,228,16640
 T 230,228,24832
 T 232,225,16640
 T 234,225,24832
 Mvaa 4,200,12
 s_mov_b32 s32, 256
 Mvaa 68,200,16
 buffer_load_dwordx4 v205, s[4:7], s32 offen lds
 buffer_load_dwordx4 v206, s[4:7], s32 offen offset:1024 lds
 Mvaa 132,200,20
 s_waitcnt lgkmcnt(6)
 Mvaa 20,204,12
 s_add_u32 m0, s41, 51200
 Mvaa 84,204,16
 T 236,229,16640
 T 238,229,24832
 T 240,226,16640
 T 242,226,24832
 Mvaa 8,208,12
 s_mov_b32 s32, 14592
 Mvaa 72,208,16
 buffer_load_dwordx4 v205, s[4:7], s32 offen lds
 T 244,230,16640
 T 246,230,24832
 Mvaa 136,208,20
 s_waitcnt lgkmcnt(6)
 Mvaa 24,212,12
 T 248,227,16640
 T 250,227,24832
 buffer_load_dwordx4 v206, s[4:7], s32 offen offset:1024 lds
 Mvaa 88,212,16
 Mvaa 12,216,12
 s_add_u32 m0, s41, 53248
 T 252,231,16640
 T 254,231,24832
 R 28,195,22528
 Mvaa 76,216,16
 s_mov_b32 s32, 28928
 Mvaa 140,216,20
 s_waitcnt lgkmcnt(7)
 R 32,197,20480
 R 36,196,20480
 R 40,196,22528
 R 44,207,20480
 Mvaa 28,220,12
 Mvaa 92,220,16
 s_waitcnt lgkmcnt(9)
 buffer_load_dwordx4 v205, s[4:7], s32 offen lds
 buffer_load_dwordx4 v206, s[4:7], s32 offen offset:1024 lds
 Mvaa 32,224,12
 s_add_u32 m0, s41, 55296
 Mvaa 96,224,16
 s_mov_b32 s32, 43264
 Mvaa 160,224,20
 buffer_load_dwordx4 v205, s[4:7], s32 offen lds
 buffer_load_dwordx4 v206, s[4:7], s32 offen offset:1024 lds
 Mvaa 48,228,12
 Mvaa 112,228,16
 s_waitcnt vmcnt(16) lgkmcnt(0)
 s_barrier
 T 192,216,32768
 T 194,216,40960
 Mvaa 36,232,12
 s_add_u32 m0, s41, 57344
 Mvaa 100,232,16
 s_mov_b32 s32, 57600
 buffer_load_dwordx4 v205, s[4:7], s32 offen lds
 T 196,220,32768
 T 198,220,40960
 Mvaa 164,232,20
 buffer_load_dwordx4 v206, s[4:7], s32 offen offset:1024 lds
 Mvaa 52,236,12
 Mvaa 116,236,16
 T 200,217,32768
 T 202,217,40960
 Mvaa 40,240,12
 s_add_u32 m0, s33, 131072
 T 204,221,32768
 T 206,221,40960
 Mvaa 104,240,16
 s_mov_b32 s32, 1048576
 buffer_load_dwordx4 v248, s[8:11], s32 offen lds
 Mvaa 168,240,20
 buffer_load_dwordx4 v249, s[8:11], s32 offen offset:1024 lds
 T 208,218,32768
 T 210,218,40960
 Mvaa 56,244,12
 Mvaa 120,244,16
 T 212,222,32768
 T 214,222,40960
 Mvaa 44,248,12
 buffer_load_dwordx4 v250, s[8:11], s32 offen offset:2048 lds
 Mvaa 108,248,16
 Mvaa 172,248,20
 s_waitcnt lgkmcnt(4)
 T 216,219,32768
 T 218,219,40960
 Mvaa 60,252,12
 buffer_load_dwordx4 v251, s[8:11], s32 offen offset:3072 lds
 T 220,223,32768
 T 222,223,40960
 Mvaa 124,252,16
 Mvaa 0,192,24
 T 224,216,33024
 T 226,216,41216
 Mvaa 64,192,28
 s_add_u32 m0, s33, 139264
 Mvaa 128,192,32
 T 228,220,33024
 T 230,220,41216
 Mvaa 16,196,24
 s_mov_b32 s32, 1081344
 buffer_load_dwordx4 v248, s[8:11], s32 offen lds
 buffer_load_dwordx4 v249, s[8:11], s32 offen offset:1024 lds
 Mvaa 80,196,28
 s_waitcnt lgkmcnt(6)
 Mvaa 4,200,24
 T 232,217,33024
 T 234,217,41216
 Mvaa 68,200,28
 buffer_load_dwordx4 v250, s[8:11], s32 offen offset:2048 lds
 T 236,221,33024
 T 238,221,41216
 Mvaa 132,200,32
 Mvaa 20,204,24
 T 240,218,33024
 T 242,218,41216
 Mvaa 84,204,28
 s_waitcnt lgkmcnt(6)
 buffer_load_dwordx4 v251, s[8:11], s32 offen offset:3072 lds
 Mvaa 8,208,24
 T 244,222,33024
 T 246,222,41216
 Mvaa 72,208,28
 s_add_u32 m0, s33, 147456
 Mvaa 136,208,32
 T 248,219,33024
 T 250,219,41216
 Mvaa 24,212,24
 s_mov_b32 s32, 1310720
 buffer_load_dwordx4 v248, s[8:11], s32 offen lds
 Mvaa 88,212,28
 T 252,223,33024
 T 254,223,41216
 buffer_load_dwordx4 v249, s[8:11], s32 offen offset:1024 lds
 Mvaa 12,216,24
 Mvaa 76,216,28
 Mvaa 140,216,32
 s_waitcnt lgkmcnt(4)
 buffer_load_dwordx4 v250, s[8:11], s32 offen offset:2048 lds
 Mvaa 28,220,24
 Mvaa 92,220,28
 buffer_load_dwordx4 v251, s[8:11], s32 offen offset:3072 lds
 Mvaa 32,224,24
 Mvaa 96,224,28
 Mvaa 160,224,32
 Mvaa 48,228,24
 s_add_u32 m0, s33, 155648
 Mvaa 112,228,28
 s_waitcnt vmcnt(12) lgkmcnt(0)
 s_barrier
 T 192,216,49152
 T 194,216,57344
 R 48,195,0
 Mvaa 36,232,24
 s_mov_b32 s32, 1343488
 buffer_load_dwordx4 v248, s[8:11], s32 offen lds
 buffer_load_dwordx4 v249, s[8:11], s32 offen offset:1024 lds
 Mvaa 100,232,28
 T 196,220,49152
 T 198,220,57344
 R 52,195,2048
 Mvaa 164,232,32
 Mvaa 52,236,24
 buffer_load_dwordx4 v250, s[8:11], s32 offen offset:2048 lds
 T 200,217,49152
 T 202,217,57344
 Mvaa 116,236,28
 Mvaa 40,240,24
 buffer_load_dwordx4 v251, s[8:11], s32 offen offset:3072 lds
 T 204,221,49152
 T 206,221,57344
 Mvaa 104,240,28
 Mvaa 168,240,32
 T 208,218,49152
 T 210,218,57344
 R 56,197,0
 Mvaa 56,244,24
 s_add_u32 m0, s41, 69632
 Mvaa 120,244,28
 s_waitcnt lgkmcnt(7)
 T 212,222,49152
 T 214,222,57344
 R 60,196,0
 Mvaa 44,248,24
 s_mov_b32 s32, 384
 Mvaa 108,248,28
 buffer_load_dwordx4 v205, s[4:7], s32 offen lds
 buffer_load_dwordx4 v206, s[4:7], s32 offen offset:1024 lds
 Mvaa 172,248,32
 Mvaa 60,252,24
 s_add_u32 m0, s41, 71680
 T 216,219,49152
 T 218,219,57344
 T 220,223,49152
 T 222,223,57344
 Mvaa 124,252,28
 s_waitcnt lgkmcnt(7)
 Mvaa 0,192,36
 s_mov_b32 s32, 14720
 buffer_load_dwordx4 v205, s[4:7], s32 offen lds
 T 224,216,49408
 T 226,216,57600
 Mvaa 64,192,40
 Mvaa 128,192,44
 Mvaa 16,196,36
 buffer_load_dwordx4 v206, s[4:7], s32 offen offset:1024 lds
 T 228,220,49408
 T 230,220,57600
 Mvaa 80,196,40
 s_waitcnt lgkmcnt(8)
 Mvaa 4,200,36
 s_add_u32 m0, s41, 73728
 T 232,217,49408
 T 234,217,57600
 R 64,196,2048
 Mvaa 68,200,40
 s_mov_b32 s32, 29056
 Mvaa 132,200,44
 s_waitcnt lgkmcnt(5)
 buffer_load_dwordx4 v205, s[4:7], s32 offen lds
 buffer_load_dwordx4 v206, s[4:7], s32 offen offset:1024 lds
 Mvaa 20,204,36
 Mvaa 84,204,40
 T 236,221,49408
 T 238,221,57600
 T 240,218,49408
 T 242,218,57600
 Mvaa 8,208,36
 s_add_u32 m0, s41, 75776
 Mvaa 72,208,40
 s_mov_b32 s32, 43392
 buffer_load_dwordx4 v205, s[4:7], s32 offen lds
 T 244,222,49408
 T 246,222,57600
 Mvaa 136,208,44
 s_waitcnt lgkmcnt(6)
 Mvaa 24,212,36
 Mvaa 88,212,40
 T 248,219,49408
 T 250,219,57600
 T 252,223,49408
 T 254,223,57600
 Mvaa 12,216,36
 Mvaa 76,216,40
 R 68,207,0
 buffer_load_dwordx4 v206, s[4:7], s32 offen offset:1024 lds
 Mvaa 140,216,44
 s_waitcnt lgkmcnt(7)
 Mvaa 28,220,36
 s_add_u32 m0, s41, 77824
 Mvaa 92,220,40
 s_mov_b32 s32, 57728
 buffer_load_dwordx4 v205, s[4:7], s32 offen lds
 Mvaa 32,224,36
 buffer_load_dwordx4 v206, s[4:7], s32 offen offset:1024 lds
 Mvaa 96,224,40
 s_add_u32 m0, s33, 98304
 Mvaa 160,224,44
 Mvaa 48,228,36
 s_mov_b32 s32, 1572864
 buffer_load_dwordx4 v248, s[8:11], s32 offen lds
 buffer_load_dwordx4 v249, s[8:11], s32 offen offset:1024 lds
 Mvaa 112,228,40
 s_waitcnt vmcnt(20) lgkmcnt(0)
 s_barrier
 T 192,224,0
 T 194,224,8192
 Mvaa 36,232,36
 buffer_load_dwordx4 v250, s[8:11], s32 offen offset:2048 lds
 Mvaa 100,232,40
 T 196,228,0
 T 198,228,8192
 Mvaa 164,232,44
 Mvaa 52,236,36
 buffer_load_dwordx4 v251, s[8:11], s32 offen offset:3072 lds
 T 200,225,0
 T 202,225,8192
 Mvaa 116,236,40
 Mvaa 40,240,36
 T 204,229,0
 T 206,229,8192
 Mvaa 104,240,40
 s_add_u32 m0, s33, 106496
 Mvaa 168,240,44
 T 208,226,0
 T 210,226,8192
 Mvaa 56,244,36
 s_mov_b32 s32, 1605632
 buffer_load_dwordx4 v248, s[8:11], s32 offen lds
 buffer_load_dwordx4 v249, s[8:11], s32 offen offset:1024 lds
 Mvaa 120,244,40
 T 212,230,0
 T 214,230,8192
 Mvaa 44,248,36
 Mvaa 108,248,40
 buffer_load_dwordx4 v250, s[8:11], s32 offen offset:2048 lds
 T 216,227,0
 T 218,227,8192
 Mvaa 172,248,44
 s_waitcnt lgkmcnt(6)
 Mvaa 60,252,36
 T 220,231,0
 T 222,231,8192
 Mvaa 124,252,40
 buffer_load_dwordx4 v251, s[8:11], s32 offen offset:3072 lds
 Mvaa 0,192,48
 T 224,224,256
 T 226,224,8448
 Mvaa 64,192,52
 Mvaa 128,192,56
 T 228,228,256
 T 230,228,8448
 Mvaa 16,196,48
 s_add_u32 m0, s33, 114688
 Mvaa 80,196,52
 s_waitcnt lgkmcnt(6)
 T 232,225,256
 T 234,225,8448
 Mvaa 4,200,48
 s_mov_b32 s32, 1835008
 buffer_load_dwordx4 v248, s[8:11], s32 offen lds
 buffer_load_dwordx4 v249, s[8:11], s32 offen offset:1024 lds
 Mvaa 68,200,52
 T 236,229,256
 T 238,229,8448
 Mvaa 132,200,56
 buffer_load_dwordx4 v250, s[8:11], s32 offen offset:2048 lds
 Mvaa 20,204,48
 T 240,226,256
 T 242,226,8448
 Mvaa 84,204,52
 s_waitcnt lgkmcnt(6)
 Mvaa 8,208,48
 buffer_load_dwordx4 v251, s[8:11], s32 offen offset:3072 lds
 T 244,230,256
 T 246,230,8448
 Mvaa 72,208,52
 Mvaa 136,208,56
 T 248,227,256
 T 250,227,8448
 Mvaa 24,212,48
 s_add_u32 m0, s33, 122880
 Mvaa 88,212,52
 T 252,231,256
 T 254,231,8448
 Mvaa 12,216,48
 s_mov_b32 s32, 1867776
 buffer_load_dwordx4 v248, s[8:11], s32 offen lds
 buffer_load_dwordx4 v249, s[8:11], s32 offen offset:1024 lds
 Mvaa 76,216,52
 Mvaa 140,216,56
 s_waitcnt lgkmcnt(4)
 Mvaa 28,220,48
 buffer_load_dwordx4 v250, s[8:11], s32 offen offset:2048 lds
 Mvaa 92,220,52
 Mvaa 32,224,48
 buffer_load_dwordx4 v251, s[8:11], s32 offen offset:3072 lds
 Mvaa 96,224,52
 Mvaa 160,224,56
 Mvaa 48,228,48
 s_add_u32 m0, s41, 49152
 Mvaa 112,228,52
 s_waitcnt vmcnt(16) lgkmcnt(0)
 s_barrier
 T 192,224,16384
 T 194,224,24576
 R 72,195,20480
 Mvaa 36,232,48
 s_mov_b32 s32, 512
 buffer_load_dwordx4 v205, s[4:7], s32 offen lds
 R 76,195,22528
 R 80,197,20480
 Mvaa 100,232,52
 buffer_load_dwordx4 v206, s[4:7], s32 offen offset:1024 lds
 T 196,228,16384
 T 198,228,24576
 Mvaa 164,232,56
 Mvaa 52,236,48
 s_add_u32 m0, s41, 51200
 Mvaa 116,236,52
 T 200,225,16384
 T 202,225,24576
 R 84,196,20480
 Mvaa 40,240,48
 s_mov_b32 s32, 14848
 buffer_load_dwordx4 v205, s[4:7], s32 offen lds
 T 204,229,16384
 T 206,229,24576
 Mvaa 104,240,52
 Mvaa 168,240,56
 s_waitcnt lgkmcnt(7)
 Mvaa 56,244,48
 buffer_load_dwordx4 v206, s[4:7], s32 offen offset:1024 lds
 T 208,226,16384
 T 210,226,24576
 Mvaa 120,244,52
 Mvaa 44,248,48
 s_add_u32 m0, s41, 53248
 T 212,230,16384
 T 214,230,24576
 R 88,196,22528
 Mvaa 108,248,52
 s_mov_b32 s32, 29184
 Mvaa 172,248,56
 s_waitcnt lgkmcnt(5)
 buffer_load_dwordx4 v205, s[4:7], s32 offen lds
 buffer_load_dwordx4 v206, s[4:7], s32 offen offset:1024 lds
 Mvaa 60,252,48
 Mvaa 124,252,52
 T 216,227,16384
 T 218,227,24576
 T 220,231,16384
 T 222,231,24576
 Mvaa 0,192,60
 s_add_u32 m0, s41, 55296
 Mvaa 64,192,64
 s_mov_b32 s32, 43520
 buffer_load_dwordx4 v205, s[4:7], s32 offen lds
 T 224,224,16640
 T 226,224,24832
 Mvaa 128,192,68
 s_waitcnt lgkmcnt(6)
 Mvaa 16,196,60
 Mvaa 80,196,64
 buffer_load_dwordx4 v206, s[4:7], s32 offen offset:1024 lds
 T 228,228,16640
 T 230,228,24832
 Mvaa 4,200,60
 s_add_u32 m0, s41, 57344
 Mvaa 68,200,64
 s_mov_b32 s32, 57856
 buffer_load_dwordx4 v205, s[4:7], s32 offen lds
 T 232,225,16640
 T 234,225,24832
 Mvaa 132,200,68
 Mvaa 20,204,60
 buffer_load_dwordx4 v206, s[4:7], s32 offen offset:1024 lds
 T 236,229,16640
 T 238,229,24832
 Mvaa 84,204,64
 s_waitcnt lgkmcnt(6)
 Mvaa 8,208,60
 s_add_u32 m0, s33, 131072
 Mvaa 72,208,64
 s_mov_b32 s32, 2097152
 buffer_load_dwordx4 v248, s[8:11], s32 offen lds
 T 240,226,16640
 T 242,226,24832
 Mvaa 136,208,68
 Mvaa 24,212,60
 T 244,230,16640
 T 246,230,24832
 T 248,227,16640
 T 250,227,24832
 Mvaa 88,212,64
 s_waitcnt lgkmcnt(8)
 Mvaa 12,216,60
 T 252,231,16640
 T 254,231,24832
 R 92,207,20480
 Mvaa 76,216,64
 Mvaa 140,216,68
 s_waitcnt lgkmcnt(9)
 buffer_load_dwordx4 v249, s[8:11], s32 offen offset:1024 lds
 buffer_load_dwordx4 v250, s[8:11], s32 offen offset:2048 lds
 Mvaa 28,220,60
 Mvaa 92,220,64
 buffer_load_dwordx4 v251, s[8:11], s32 offen offset:3072 lds
 Mvaa 32,224,60
 Mvaa 96,224,64
 s_add_u32 m0, s33, 139264
 Mvaa 160,224,68
 Mvaa 48,228,60
 s_mov_b32 s32, 2129920
 buffer_load_dwordx4 v248, s[8:11], s32 offen lds
 Mvaa 112,228,64
 s_waitcnt vmcnt(23) lgkmcnt(0)
 s_barrier
 T 192,216,32768
 T 194,216,40960
 buffer_load_dwordx4 v249, s[8:11], s32 offen offset:1024 lds
 Mvaa 36,232,60
 Mvaa 100,232,64
 buffer_load_dwordx4 v250, s[8:11], s32 offen offset:2048 lds
 T 196,220,32768
 T 198,220,40960
 Mvaa 164,232,68
 Mvaa 52,236,60
 T 200,217,32768
 T 202,217,40960
 Mvaa 116,236,64
 buffer_load_dwordx4 v251, s[8:11], s32 offen offset:3072 lds
 Mvaa 40,240,60
 T 204,221,32768
 T 206,221,40960
 Mvaa 104,240,64
 Mvaa 168,240,68
 T 208,218,32768
 T 210,218,40960
 Mvaa 56,244,60
 s_add_u32 m0, s33, 147456
 Mvaa 120,244,64
 T 212,222,32768
 T 214,222,40960
 Mvaa 44,248,60
 s_mov_b32 s32, 2359296
 buffer_load_dwordx4 v248, s[8:11], s32 offen lds
 buffer_load_dwordx4 v249, s[8:11], s32 offen offset:1024 lds
 Mvaa 108,248,64
 T 216,219,32768
 T 218,219,40960
 Mvaa 172,248,68
 s_waitcnt lgkmcnt(6)
 buffer_load_dwordx4 v250, s[8:11], s32 offen offset:2048 lds
 Mvaa 60,252,60
 T 220,223,32768
 T 222,223,40960
 Mvaa 124,252,64
 Mvaa 0,192,72
 buffer_load_dwordx4 v251, s[8:11], s32 offen offset:3072 lds
 T 224,216,33024
 T 226,216,41216
 Mvaa 64,192,76
 Mvaa 128,192,80
 T 228,220,33024
 T 230,220,41216
 Mvaa 16,196,72
 s_add_u32 m0, s33, 155648
 Mvaa 80,196,76
 s_waitcnt lgkmcnt(6)
 T 232,217,33024
 T 234,217,41216
 Mvaa 4,200,72
 s_mov_b32 s32, 2392064
 buffer_load_dwordx4 v248, s[8:11], s32 offen lds
 buffer_load_dwordx4 v249, s[8:11], s32 offen offset:1024 lds
 Mvaa 68,200,76
 T 236,221,33024
 T 238,221,41216
 Mvaa 132,200,80
 Mvaa 20,204,72
 buffer_load_dwordx4 v250, s[8:11], s32 offen offset:2048 lds
 T 240,218,33024
 T 242,218,41216
 Mvaa 84,204,76
 s_waitcnt lgkmcnt(6)
 Mvaa 8,208,72
 T 244,222,33024
 T 246,222,41216
 Mvaa 72,208,76
 buffer_load_dwordx4 v251, s[8:11], s32 offen offset:3072 lds
 Mvaa 136,208,80
 T 248,219,33024
 T 250,219,41216
 Mvaa 24,212,72
 s_add_u32 m0, s41, 69632
 Mvaa 88,212,76
 T 252,223,33024
 T 254,223,41216
 Mvaa 12,216,72
 s_mov_b32 s32, 640
 buffer_load_dwordx4 v205, s[4:7], s32 offen lds
 Mvaa 76,216,76
 buffer_load_dwordx4 v206, s[4:7], s32 offen offset:1024 lds
 Mvaa 140,216,80
 s_waitcnt lgkmcnt(4)
 Mvaa 28,220,72
 Mvaa 92,220,76
 Mvaa 32,224,72
 s_add_u32 m0, s41, 71680
 Mvaa 96,224,76
 s_mov_b32 s32, 14976
 buffer_load_dwordx4 v205, s[4:7], s32 offen lds
 buffer_load_dwordx4 v206, s[4:7], s32 offen offset:1024 lds
 Mvaa 160,224,80
 Mvaa 48,228,72
 Mvaa 112,228,76
 s_waitcnt vmcnt(20) lgkmcnt(0)
 s_barrier
 T 192,216,49152
 T 194,216,57344
 R 96,195,0
 Mvaa 36,232,72
 s_add_u32 m0, s41, 73728
 R 100,195,2048
 R 104,197,0
 Mvaa 100,232,76
 s_mov_b32 s32, 29312
 buffer_load_dwordx4 v205, s[4:7], s32 offen lds
 T 196,220,49152
 T 198,220,57344
 Mvaa 164,232,80
 buffer_load_dwordx4 v206, s[4:7], s32 offen offset:1024 lds
 R 108,196,0
 R 112,196,2048
 Mvaa 52,236,72
 Mvaa 116,236,76
 Mvaa 40,240,72
 s_add_u32 m0, s41, 75776
 T 200,217,49152
 T 202,217,57344
 T 204,221,49152
 T 206,221,57344
 Mvaa 104,240,76
 s_mov_b32 s32, 43648
 Mvaa 168,240,80
 s_waitcnt lgkmcnt(8)
 buffer_load_dwordx4 v205, s[4:7], s32 offen lds
 buffer_load_dwordx4 v206, s[4:7], s32 offen offset:1024 lds
 Mvaa 56,244,72
 Mvaa 120,244,76
 T 208,218,49152
 T 210,218,57344
 T 212,222,49152
 T 214,222,57344
 Mvaa 44,248,72
 s_add_u32 m0, s41, 77824
 Mvaa 108,248,76
 s_mov_b32 s32, 57984
 Mvaa 172,248,80
 s_waitcnt lgkmcnt(4)
 buffer_load_dwordx4 v205, s[4:7], s32 offen lds
 T 216,219,49152
 T 218,219,57344
 Mvaa 60,252,72
 Mvaa 124,252,76
 buffer_load_dwordx4 v206, s[4:7], s32 offen offset:1024 lds
 T 220,223,49152
 T 222,223,57344
 Mvaa 0,192,84
 s_add_u32 m0, s33, 98304
 Mvaa 64,192,88
 s_mov_b32 s32, 2621440
 buffer_load_dwordx4 v248, s[8:11], s32 offen lds
 T 224,216,49408
 T 226,216,57600
 Mvaa 128,192,92
 Mvaa 16,196,84
 Mvaa 80,196,88
 buffer_load_dwordx4 v249, s[8:11], s32 offen offset:1024 lds
 T 228,220,49408
 T 230,220,57600
 Mvaa 4,200,84
 Mvaa 68,200,88
 buffer_load_dwordx4 v250, s[8:11], s32 offen offset:2048 lds
 T 232,217,49408
 T 234,217,57600
 Mvaa 132,200,92
 s_waitcnt lgkmcnt(6)
 Mvaa 20,204,84
 buffer_load_dwordx4 v251, s[8:11], s32 offen offset:3072 lds
 T 236,221,49408
 T 238,221,57600
 Mvaa 84,204,88
 Mvaa 8,208,84
 Mvaa 72,208,88
 s_add_u32 m0, s33, 106496
 T 240,218,49408
 T 242,218,57600
 T 244,222,49408
 T 246,222,57600
 Mvaa 136,208,92
 s_waitcnt lgkmcnt(8)
 Mvaa 24,212,84
 s_mov_b32 s32, 2654208
 T 248,219,49408
 T 250,219,57600
 buffer_load_dwordx4 v248, s[8:11], s32 offen lds
 Mvaa 88,212,88
 Mvaa 12,216,84
 T 252,223,49408
 T 254,223,57600
 R 116,207,0
 Mvaa 76,216,88
 Mvaa 140,216,92
 s_waitcnt lgkmcnt(9)
 buffer_load_dwordx4 v249, s[8:11], s32 offen offset:1024 lds
 buffer_load_dwordx4 v250, s[8:11], s32 offen offset:2048 lds
 Mvaa 28,220,84
 Mvaa 92,220,88
 buffer_load_dwordx4 v251, s[8:11], s32 offen offset:3072 lds
 Mvaa 32,224,84
 Mvaa 96,224,88
 Mvaa 160,224,92
 Mvaa 48,228,84
 Mvaa 112,228,88
 s_waitcnt vmcnt(26) lgkmcnt(0)
 s_barrier
 T 192,224,0
 T 194,224,8192
 Mvaa 36,232,84
 s_add_u32 m0, s33, 114688
 Mvaa 100,232,88
 s_mov_b32 s32, 2883584
 buffer_load_dwordx4 v248, s[8:11], s32 offen lds
 buffer_load_dwordx4 v249, s[8:11], s32 offen offset:1024 lds
 Mvaa 164,232,92
 T 196,228,0
 T 198,228,8192
 Mvaa 52,236,84
 T 200,225,0
 T 202,225,8192
 Mvaa 116,236,88
 buffer_load_dwordx4 v250, s[8:11], s32 offen offset:2048 lds
 Mvaa 40,240,84
 T 204,229,0
 T 206,229,8192
 Mvaa 104,240,88
 Mvaa 168,240,92
 buffer_load_dwordx4 v251, s[8:11], s32 offen offset:3072 lds
 T 208,226,0
 T 210,226,8192
 Mvaa 56,244,84
 Mvaa 120,244,88
 T 212,230,0
 T 214,230,8192
 Mvaa 44,248,84
 s_add_u32 m0, s33, 122880
 Mvaa 108,248,88
 s_mov_b32 s32, 2916352
 buffer_load_dwordx4 v248, s[8:11], s32 offen lds
 T 216,227,0
 T 218,227,8192
 Mvaa 172,248,92
 s_waitcnt lgkmcnt(6)
 buffer_load_dwordx4 v249, s[8:11], s32 offen offset:1024 lds
 Mvaa 60,252,84
 T 220,231,0
 T 222,231,8192
 Mvaa 124,252,88
 Mvaa 0,192,96
 buffer_load_dwordx4 v250, s[8:11], s32 offen offset:2048 lds
 T 224,224,256
 T 226,224,8448
 Mvaa 64,192,100
 Mvaa 128,192,104
 buffer_load_dwordx4 v251, s[8:11], s32 offen offset:3072 lds
 T 228,228,256
 T 230,228,8448
 Mvaa 16,196,96
 Mvaa 80,196,100
 s_waitcnt lgkmcnt(6)
 T 232,225,256
 T 234,225,8448
 Mvaa 4,200,96
 s_add_u32 m0, s41, 49152
 Mvaa 68,200,100
 s_mov_b32 s32, 768
 buffer_load_dwordx4 v205, s[4:7], s32 offen lds
 T 236,229,256
 T 238,229,8448
 Mvaa 132,200,104
 Mvaa 20,204,96
 buffer_load_dwordx4 v206, s[4:7], s32 offen offset:1024 lds
 T 240,226,256
 T 242,226,8448
 Mvaa 84,204,100
 s_waitcnt lgkmcnt(6)
 Mvaa 8,208,96
 T 244,230,256
 T 246,230,8448
 Mvaa 72,208,100
 s_add_u32 m0, s41, 51200
 Mvaa 136,208,104
 T 248,227,256
 T 250,227,8448
 Mvaa 24,212,96
 s_mov_b32 s32, 15104
 buffer_load_dwordx4 v205, s[4:7], s32 offen lds
 buffer_load_dwordx4 v206, s[4:7], s32 offen offset:1024 lds
 Mvaa 88,212,100
 Mvaa 12,216,96
 T 252,231,256
 T 254,231,8448
 Mvaa 76,216,100
 s_add_u32 m0, s41, 53248
 Mvaa 140,216,104
 s_waitcnt lgkmcnt(4)
 Mvaa 28,220,96
 s_mov_b32 s32, 29440
 buffer_load_dwordx4 v205, s[4:7], s32 offen lds
 Mvaa 92,220,100
 buffer_load_dwordx4 v206, s[4:7], s32 offen offset:1024 lds
 Mvaa 32,224,96
 Mvaa 96,224,100
 s_add_u32 m0, s41, 55296
 Mvaa 160,224,104
 Mvaa 48,228,96
 s_mov_b32 s32, 43776
 buffer_load_dwordx4 v205, s[4:7], s32 offen lds
 Mvaa 112,228,100
 s_waitcnt vmcnt(23) lgkmcnt(0)
 s_barrier
 T 192,224,16384
 T 194,224,24576
 buffer_load_dwordx4 v206, s[4:7], s32 offen offset:1024 lds
 Mvaa 36,232,96
 R 120,195,20480
 R 124,195,22528
 Mvaa 100,232,100
 T 196,228,16384
 T 198,228,24576
 R 128,197,20480
 Mvaa 164,232,104
 Mvaa 52,236,96
 s_add_u32 m0, s41, 57344
 T 200,225,16384
 T 202,225,24576
 R 132,196,20480
 Mvaa 116,236,100
 Mvaa 40,240,96
 s_mov_b32 s32, 58112
 buffer_load_dwordx4 v205, s[4:7], s32 offen lds
 buffer_load_dwordx4 v206, s[4:7], s32 offen offset:1024 lds
 Mvaa 104,240,100
 Mvaa 168,240,104
 T 204,229,16384
 T 206,229,24576
 T 208,226,16384
 T 210,226,24576
 Mvaa 56,244,96
 s_add_u32 m0, s33, 131072
 Mvaa 120,244,100
 s_waitcnt lgkmcnt(7)
 T 212,230,16384
 T 214,230,24576
 R 136,196,22528
 Mvaa 44,248,96
 s_mov_b32 s32, 3145728
 Mvaa 108,248,100
 buffer_load_dwordx4 v248, s[8:11], s32 offen lds
 buffer_load_dwordx4 v249, s[8:11], s32 offen offset:1024 lds
 Mvaa 172,248,104
 Mvaa 60,252,96
 Mvaa 124,252,100
 buffer_load_dwordx4 v250, s[8:11], s32 offen offset:2048 lds
 T 216,227,16384
 T 218,227,24576
 Mvaa 0,192,108
 Mvaa 64,192,112
 buffer_load_dwordx4 v251, s[8:11], s32 offen offset:3072 lds
 T 220,231,16384
 T 222,231,24576
 Mvaa 128,192,116
 s_waitcnt lgkmcnt(4)
 Mvaa 16,196,108
 s_add_u32 m0, s33, 139264
 Mvaa 80,196,112
 T 224,224,16640
 T 226,224,24832
 T 228,228,16640
 T 230,228,24832
 Mvaa 4,200,108
 s_mov_b32 s32, 3178496
 Mvaa 68,200,112
 Mvaa 132,200,116
 buffer_load_dwordx4 v248, s[8:11], s32 offen lds
 buffer_load_dwordx4 v249, s[8:11], s32 offen offset:1024 lds
 Mvaa 20,204,108
 Mvaa 84,204,112
 Mvaa 8,208,108
 buffer_load_dwordx4 v250, s[8:11], s32 offen offset:2048 lds
 T 232,225,16640
 T 234,225,24832
 Mvaa 72,208,112
 Mvaa 136,208,116
 T 236,229,16640
 T 238,229,24832
 T 240,226,16640
 T 242,226,24832
 Mvaa 24,212,108
 Mvaa 88,212,112
 s_waitcnt lgkmcnt(6)
 Mvaa 12,216,108
 T 244,230,16640
 T 246,230,24832
 T 248,227,16640
 T 250,227,24832
 Mvaa 76,216,112
 Mvaa 140,216,116
 T 252,231,16640
 T 254,231,24832
 R 140,207,20480
 Mvaa 28,220,108
 buffer_load_dwordx4 v251, s[8:11], s32 offen offset:3072 lds
 Mvaa 92,220,112
 s_waitcnt lgkmcnt(7)
 Mvaa 32,224,108
 Mvaa 96,224,112
 Mvaa 160,224,116
 Mvaa 48,228,108
 Mvaa 112,228,112
 s_waitcnt vmcnt(26) lgkmcnt(0)
 s_barrier
 T 192,216,32768
 T 194,216,40960
 Mvaa 36,232,108
 s_add_u32 m0, s33, 147456
 Mvaa 100,232,112
 s_mov_b32 s32, 3407872
 buffer_load_dwordx4 v248, s[8:11], s32 offen lds
 buffer_load_dwordx4 v249, s[8:11], s32 offen offset:1024 lds
 Mvaa 164,232,116
 T 196,220,32768
 T 198,220,40960
 Mvaa 52,236,108
 T 200,217,32768
 T 202,217,40960
 Mvaa 116,236,112
 buffer_load_dwordx4 v250, s[8:11], s32 offen offset:2048 lds
 Mvaa 40,240,108
 Mvaa 104,240,112
 T 204,221,32768
 T 206,221,40960
 Mvaa 168,240,116
 buffer_load_dwordx4 v251, s[8:11], s32 offen offset:3072 lds
 T 208,218,32768
 T 210,218,40960
 Mvaa 56,244,108
 Mvaa 120,244,112
 Mvaa 44,248,108
 s_add_u32 m0, s33, 155648
 T 212,222,32768
 T 214,222,40960
 Mvaa 108,248,112
 s_mov_b32 s32, 3440640
 buffer_load_dwordx4 v248, s[8:11], s32 offen lds
 T 216,219,32768
 T 218,219,40960
 Mvaa 172,248,116
 s_waitcnt lgkmcnt(8)
 Mvaa 60,252,108
 Mvaa 124,252,112
 buffer_load_dwordx4 v249, s[8:11], s32 offen offset:1024 lds
 T 220,223,32768
 T 222,223,40960
 Mvaa 0,192,120
 Mvaa 64,192,124
 Mvaa 128,192,128
 buffer_load_dwordx4 v250, s[8:11], s32 offen offset:2048 lds
 buffer_load_dwordx4 v251, s[8:11], s32 offen offset:3072 lds
 Mvaa 16,196,120
 Mvaa 80,196,124
 Mvaa 4,200,120
 T 224,216,33024
 T 226,216,41216
 T 228,220,33024
 T 230,220,41216
 Mvaa 68,200,124
 Mvaa 132,200,128
 s_waitcnt lgkmcnt(4)
 Mvaa 20,204,120
 T 232,217,33024
 T 234,217,41216
 T 236,221,33024
 T 238,221,41216
 Mvaa 84,204,124
 Mvaa 8,208,120
 Mvaa 72,208,124
 T 240,218,33024
 T 242,218,41216
 T 244,222,33024
 T 246,222,41216
 Mvaa 136,208,128
 s_waitcnt lgkmcnt(8)
 Mvaa 24,212,120
 Mvaa 88,212,124
 T 248,219,33024
 T 250,219,41216
 T 252,223,33024
 T 254,223,41216
 Mvaa 12,216,120
 Mvaa 76,216,124
 Mvaa 140,216,128
 s_waitcnt lgkmcnt(8)
 Mvaa 28,220,120
 Mvaa 92,220,124
 Mvaa 32,224,120
 Mvaa 96,224,124
 Mvaa 160,224,128
 Mvaa 48,228,120
 Mvaa 112,228,124
 s_waitcnt vmcnt(16) lgkmcnt(0)
 s_barrier
 T 192,216,49152
 T 194,216,57344
 R 144,195,0
 Mvaa 36,232,120
 s_add_u32 m0, s33, 98304
 R 148,195,2048
 R 152,197,0
 Mvaa 100,232,124
 s_mov_b32 s32, 32768
 buffer_load_dwordx4 v244, s[12:15], s32 offen nt lds
 T 196,220,49152
 T 198,220,57344
 Mvaa 164,232,128
 Mvaa 52,236,120
 buffer_load_dwordx4 v245, s[12:15], s32 offen offset:1024 nt lds
 T 200,217,49152
 T 202,217,57344
 Mvaa 116,236,124
 Mvaa 40,240,120
 Mvaa 104,240,124
 buffer_load_dwordx4 v246, s[12:15], s32 offen offset:2048 nt lds
 T 204,221,49152
 T 206,221,57344
 Mvaa 168,240,128
 s_waitcnt lgkmcnt(6)
 Mvaa 56,244,120
 Mvaa 120,244,124
 Mvaa 44,248,120
 buffer_load_dwordx4 v247, s[12:15], s32 offen offset:3072 nt lds
 T 208,218,49152
 T 210,218,57344
 Mvaa 108,248,124
 s_add_u32 m0, s33, 106496
 Mvaa 172,248,128
 Mvaa 60,252,120
 s_mov_b32 s32, 40960
 buffer_load_dwordx4 v244, s[12:15], s32 offen nt lds
 buffer_load_dwordx4 v245, s[12:15], s32 offen offset:1024 nt lds
 Mvaa 124,252,124
 Mvaa 0,192,132
 Mvaa 64,192,136
 T 212,222,49152
 T 214,222,57344
 buffer_load_dwordx4 v246, s[12:15], s32 offen offset:2048 nt lds
 Mvaa 128,192,140
 s_waitcnt lgkmcnt(2)
 Mvaa 16,196,132
 Mvaa 80,196,136
 T 216,219,49152
 T 218,219,57344
 buffer_load_dwordx4 v247, s[12:15], s32 offen offset:3072 nt lds
 Mvaa 4,200,132
 Mvaa 68,200,136
 Mvaa 132,200,140
 Mvaa 20,204,132
 T 220,223,49152
 T 222,223,57344
 T 224,216,49408
 T 226,216,57600
 Mvaa 84,204,136
 Mvaa 8,208,132
 Mvaa 72,208,136
 T 228,220,49408
 T 230,220,57600
 T 232,217,49408
 T 234,217,57600
 Mvaa 136,208,140
 s_waitcnt lgkmcnt(8)
 Mvaa 24,212,132
 Mvaa 88,212,136
 Mvaa 12,216,132
 T 236,221,49408
 T 238,221,57600
 T 240,218,49408
 T 242,218,57600
 Mvaa 76,216,136
 Mvaa 140,216,140
 s_waitcnt lgkmcnt(8)
 T 244,222,49408
 T 246,222,57600
 T 248,219,49408
 T 250,219,57600
 T 252,223,49408
 T 254,223,57600
 R 156,196,0
 s_waitcnt lgkmcnt(14)
 R 160,196,2048
 s_waitcnt lgkmcnt(14)
 R 164,207,0
 Mvaa 28,220,132
 Mvaa 92,220,136
 s_waitcnt lgkmcnt(13)
 Mvaa 32,224,132
 Mvaa 96,224,136
 Mvaa 160,224,140
 s_waitcnt lgkmcnt(9)
 Mvaa 48,228,132
 Mvaa 112,228,136
 s_waitcnt vmcnt(16) lgkmcnt(0)
 s_barrier
 Mvaa 36,232,132
 Mvaa 100,232,136
 T 192,224,0
 T 194,224,8192
 T 196,228,0
 T 198,228,8192
 Mvaa 164,232,140
 Mvaa 52,236,132
 Mvaa 116,236,136
 Mvaa 40,240,132
 T 200,225,0
 T 202,225,8192
 T 204,229,0
 T 206,229,8192
 Mvaa 104,240,136
 Mvaa 168,240,140
 Mvaa 56,244,132
 Mvaa 120,244,136
 T 208,226,0
 T 210,226,8192
 T 212,230,0
 T 214,230,8192
 Mvaa 44,248,132
 Mvaa 108,248,136
 Mvaa 172,248,140
 s_waitcnt lgkmcnt(4)
 T 216,227,0
 T 218,227,8192
 Mvaa 60,252,132
 Mvaa 124,252,136
 T 220,231,0
 T 222,231,8192
 Mvaa 0,192,144
 T 224,224,256
 T 226,224,8448
 Mvaa 64,192,148
 Mvaa 128,192,152
 T 228,228,256
 T 230,228,8448
 Mvaa 16,196,144
 Mvaa 80,196,148
 s_waitcnt lgkmcnt(6)
 T 232,225,256
 T 234,225,8448
 Mvaa 4,200,144
 Mvaa 68,200,148
 T 236,229,256
 T 238,229,8448
 Mvaa 132,200,152
 Mvaa 20,204,144
 T 240,226,256
 T 242,226,8448
 Mvaa 84,204,148
 s_waitcnt lgkmcnt(6)
 Mvaa 8,208,144
 T 244,230,256
 T 246,230,8448
 Mvaa 72,208,148
 Mvaa 136,208,152
 T 248,227,256
 T 250,227,8448
 Mvaa 24,212,144
 Mvaa 88,212,148
 T 252,231,256
 T 254,231,8448
 Mvaa 12,216,144
 Mvaa 76,216,148
 Mvaa 140,216,152
 s_waitcnt lgkmcnt(4)
 Mvaa 28,220,144
 Mvaa 92,220,148
 Mvaa 32,224,144
 Mvaa 96,224,148
 Mvaa 160,224,152
 Mvaa 48,228,144
 Mvaa 112,228,148
 s_waitcnt vmcnt(8) lgkmcnt(0)
 s_barrier
 T 192,224,16384
 T 194,224,24576
 Mvaa 36,232,144
 s_add_u32 m0, s33, 65536
 Mvaa 100,232,148
 s_mov_b32 s32, 49152
 buffer_load_dwordx4 v244, s[12:15], s32 offen nt lds
 T 196,225,16384
 T 198,225,24576
 Mvaa 164,232,152
 buffer_load_dwordx4 v245, s[12:15], s32 offen offset:1024 nt lds
 Mvaa 52,236,144
 T 200,226,16384
 T 202,226,24576
 buffer_load_dwordx4 v246, s[12:15], s32 offen offset:2048 nt lds
 Mvaa 116,236,148
 Mvaa 40,240,144
 buffer_load_dwordx4 v247, s[12:15], s32 offen offset:3072 nt lds
 T 204,227,16384
 T 206,227,24576
 Mvaa 104,240,148
 Mvaa 168,240,152
 T 208,224,16640
 T 210,224,24832
 Mvaa 56,244,144
 s_add_u32 m0, s33, 73728
 Mvaa 120,244,148
 T 212,225,16640
 T 214,225,24832
 Mvaa 44,248,144
 s_mov_b32 s32, 57344
 buffer_load_dwordx4 v244, s[12:15], s32 offen nt lds
 buffer_load_dwordx4 v245, s[12:15], s32 offen offset:1024 nt lds
 Mvaa 108,248,148
 buffer_load_dwordx4 v246, s[12:15], s32 offen offset:2048 nt lds
 T 216,226,16640
 T 218,226,24832
 Mvaa 172,248,152
 s_waitcnt lgkmcnt(6)
 Mvaa 60,252,144
 buffer_load_dwordx4 v247, s[12:15], s32 offen offset:3072 nt lds
 T 220,227,16640
 T 222,227,24832
 Mvaa 124,252,148
 Mvaa 0,192,156
 T 224,228,16384
 T 226,228,24576
 Mvaa 64,192,160
 Mvaa 128,192,164
 T 228,229,16384
 T 230,229,24576
 Mvaa 4,196,156
 Mvaa 68,196,160
 T 232,230,16384
 T 234,230,24576
 Mvaa 132,196,164
 s_waitcnt lgkmcnt(6)
 Mvaa 8,200,156
 T 236,231,16384
 T 238,231,24576
 Mvaa 72,200,160
 Mvaa 136,200,164
 T 240,228,16640
 T 242,228,24832
 Mvaa 12,204,156
 v_mul_f32 v128, s34, v128
 v_mul_f32 v129, s34, v129
 Mvaa 76,204,160
 T 244,229,16640
 T 246,229,24832
 Mvaa 140,204,164
 s_waitcnt lgkmcnt(6)
 v_mul_f32 v130, s34, v130
 v_mul_f32 v131, s34, v131
 Mvaa 32,208,156
 T 248,230,16640
 T 250,230,24832
 Mvaa 96,208,160
 v_mul_f32 v132, s34, v132
 v_mul_f32 v133, s34, v133
 Mvaa 160,208,164
 T 252,231,16640
 T 254,231,24832
 Mvaa 36,212,156
 v_mul_f32 v134, s34, v134
 v_mul_f32 v135, s34, v135
 Mvaa 100,212,160
 CV 128,128,129
 CV 129,130,131
 Mvaa 164,212,164
 CV 130,132,133
 CV 131,134,135
 Mvaa 40,216,156
 v_mul_f32 v136, s34, v136
 v_mul_f32 v137, s34, v137
 Mvaa 104,216,160
 v_mul_f32 v138, s34, v138
 v_mul_f32 v139, s34, v139
 Mvaa 168,216,164
 v_mul_f32 v140, s34, v140
 v_mul_f32 v141, s34, v141
 Mvaa 44,220,156
 v_mul_f32 v142, s34, v142
 v_mul_f32 v143, s34, v143
 Mvaa 108,220,160
 CV 136,136,137
 CV 137,138,139
 Mvaa 172,220,164
 CV 138,140,141
 CV 139,142,143
 Mvaa 16,224,156
 v_mul_f32 v160, s34, v160
 v_mul_f32 v161, s34, v161
 Mvaa 80,224,160
 v_mul_f32 v162, s34, v162
 v_mul_f32 v163, s34, v163
 Mvaa 20,228,156
 v_mul_f32 v164, s34, v164
 v_mul_f32 v165, s34, v165
 Mvaa 84,228,160
 s_waitcnt lgkmcnt(0)
 s_barrier
 v_mul_f32 v166, s34, v166
 Mvaa 24,232,156
 v_mul_f32 v167, s34, v167
 CV 160,160,161
 CV 161,162,163
 CV 162,164,165
 CV 163,166,167
 v_mul_f32 v168, s34, v168
 v_mul_f32 v169, s34, v169
 v_mul_f32 v170, s34, v170
 v_mul_f32 v171, s34, v171
 v_mul_f32 v172, s34, v172
 v_mul_f32 v173, s34, v173
 v_mul_f32 v174, s34, v174
 v_mul_f32 v175, s34, v175
 CV 168,168,169
 CV 169,170,171
 CV 170,172,173
 CV 171,174,175
 Mvaa 88,232,160
 v_permlane16_swap_b32 v128, v130
 v_permlane16_swap_b32 v129, v131
 v_permlane16_swap_b32 v136, v138
 v_permlane16_swap_b32 v137, v139
 v_permlane16_swap_b32 v160, v162
 v_permlane16_swap_b32 v161, v163
 v_permlane16_swap_b32 v168, v170
 v_permlane16_swap_b32 v169, v171
 Mvaa 28,236,156
 R 192,232,0
 v_mul_f32 v0, s34, v0
 Mvaa 92,236,160
 ds_write_b128 v202, v[128:131]
 ds_write_b128 v202, v[136:139] offset:1024
 ds_write_b128 v202, v[160:163] offset:2048
 ds_write_b128 v202, v[168:171] offset:3072
 Mvaa 48,240,156
 R 196,232,8192
 v_mul_f32 v1, s34, v1
 Mvaa 112,240,160
 s_waitcnt lgkmcnt(0)
 s_barrier
 R 200,233,0
 Mvaa 52,244,156
 v_mul_f32 v2, s34, v2
 v_mul_f32 v3, s34, v3
 Mvaa 116,244,160
 v_mul_f32 v4, s34, v4
 v_mul_f32 v5, s34, v5
 Mvaa 56,248,156
 v_mul_f32 v6, s34, v6
 v_mul_f32 v7, s34, v7
 Mvaa 120,248,160
 CV 0,0,1
 CV 1,2,3
 CV 2,4,5
 CV 3,6,7
 v_mul_f32 v64, s34, v64
 v_mul_f32 v65, s34, v65
 v_mul_f32 v66, s34, v66
 v_mul_f32 v67, s34, v67
 v_mul_f32 v68, s34, v68
 v_mul_f32 v69, s34, v69
 v_mul_f32 v70, s34, v70
 v_mul_f32 v71, s34, v71
 CV 64,64,65
 CV 65,66,67
 CV 66,68,69
 CV 67,70,71
 v_mul_f32 v8, s34, v8
 v_mul_f32 v9, s34, v9
 v_mul_f32 v10, s34, v10
 v_mul_f32 v11, s34, v11
 v_mul_f32 v12, s34, v12
 v_mul_f32 v13, s34, v13
 v_mul_f32 v14, s34, v14
 v_mul_f32 v15, s34, v15
 CV 8,8,9
 CV 9,10,11
 CV 10,12,13
 CV 11,14,15
 v_mul_f32 v72, s34, v72
 v_mul_f32 v73, s34, v73
 v_mul_f32 v74, s34, v74
 v_mul_f32 v75, s34, v75
 v_mul_f32 v76, s34, v76
 v_mul_f32 v77, s34, v77
 v_mul_f32 v78, s34, v78
 v_mul_f32 v79, s34, v79
 CV 72,72,73
 CV 73,74,75
 CV 74,76,77
 CV 75,78,79
 Mvaa 60,252,156
 v_permlane16_swap_b32 v0, v2
 v_permlane16_swap_b32 v1, v3
 v_permlane16_swap_b32 v64, v66
 v_permlane16_swap_b32 v65, v67
 v_permlane16_swap_b32 v8, v10
 v_permlane16_swap_b32 v9, v11
 v_permlane16_swap_b32 v72, v74
 v_permlane16_swap_b32 v73, v75
 Mvaa 124,252,160
 R 204,233,8192
 v_mul_f32 v32, s34, v32
 Mvavz 4,192,0
 R 208,232,256
 v_mul_f32 v33, s34, v33
 Mvavz 68,192,64
 R 212,232,8448
 v_mul_f32 v34, s34, v34
 Mvavz 132,192,128
 R 216,233,256
 v_mul_f32 v35, s34, v35
 Mvavz 12,196,0
 v_mul_f32 v36, s34, v36
 v_mul_f32 v37, s34, v37
 Mvavz 76,196,64
 v_mul_f32 v38, s34, v38
 v_mul_f32 v39, s34, v39
 Mvavz 140,196,128
 s_waitcnt lgkmcnt(4)
 CV 32,32,33
 CV 33,34,35
 Mvav 4,200,8
 CV 34,36,37
 CV 35,38,39
 Mvav 68,200,72
 v_mul_f32 v96, s34, v96
 v_mul_f32 v97, s34, v97
 Mvav 132,200,136
 s_waitcnt lgkmcnt(1)
 v_mul_f32 v98, s34, v98
 v_mul_f32 v99, s34, v99
 Mvav 12,204,8
 v_mul_f32 v100, s34, v100
 v_mul_f32 v101, s34, v101
 v_mul_f32 v102, s34, v102
 v_mul_f32 v103, s34, v103
 CV 96,96,97
 CV 97,98,99
 CV 98,100,101
 CV 99,102,103
 Mvav 76,204,72
 s_add_u32 m0, s33, 131072
 v_permlane16_swap_b32 v32, v34
 v_permlane16_swap_b32 v33, v35
 v_permlane16_swap_b32 v96, v98
 v_permlane16_swap_b32 v97, v99
 Mvav 140,204,136
 R 220,233,8448
 v_mul_f32 v40, s34, v40
 Mvav 4,208,32
 s_mov_b32 s32, 65536
 R 224,234,0
 v_mul_f32 v41, s34, v41
 Mvav 68,208,96
 ds_read_b128 v[144:147], v203
 v_mul_f32 v42, s34, v42
 Mvav 132,208,160
 v_mul_f32 v43, s34, v43
 v_mul_f32 v44, s34, v44
 Mvav 12,212,32
 v_mul_f32 v45, s34, v45
 v_mul_f32 v46, s34, v46
 v_mul_f32 v47, s34, v47
 CV 40,40,41
 CV 41,42,43
 CV 42,44,45
 CV 43,46,47
 v_mul_f32 v104, s34, v104
 v_mul_f32 v105, s34, v105
 v_mul_f32 v106, s34, v106
 v_mul_f32 v107, s34, v107
 v_mul_f32 v108, s34, v108
 v_mul_f32 v109, s34, v109
 v_mul_f32 v110, s34, v110
 v_mul_f32 v111, s34, v111
 CV 104,104,105
 CV 105,106,107
 CV 106,108,109
 CV 107,110,111
 Mvav 76,212,96
 v_permlane16_swap_b32 v40, v42
 v_permlane16_swap_b32 v41, v43
 v_permlane16_swap_b32 v104, v106
 v_permlane16_swap_b32 v105, v107
 Mvav 140,212,160
 s_waitcnt lgkmcnt(3)
 R 228,234,8192
 v_mul_f32 v16, s34, v16
 Mvav 4,216,40
 buffer_load_dwordx4 v244, s[12:15], s32 offen nt lds
 Mvav 68,216,104
 R 232,235,0
 v_mul_f32 v17, s34, v17
 Mvav 132,216,168
 s_waitcnt lgkmcnt(2)
 ds_read_b128 v[152:155], v203 offset:1024
 v_mul_f32 v18, s34, v18
 Mvav 12,220,40
 buffer_load_dwordx4 v245, s[12:15], s32 offen offset:1024 nt lds
 v_mul_f32 v19, s34, v19
 v_mul_f32 v20, s34, v20
 v_mul_f32 v21, s34, v21
 v_mul_f32 v22, s34, v22
 v_mul_f32 v23, s34, v23
 CV 16,16,17
 CV 17,18,19
 CV 18,20,21
 CV 19,22,23
 v_mul_f32 v80, s34, v80
 v_mul_f32 v81, s34, v81
 v_mul_f32 v82, s34, v82
 v_mul_f32 v83, s34, v83
 v_mul_f32 v84, s34, v84
 v_mul_f32 v85, s34, v85
 v_mul_f32 v86, s34, v86
 v_mul_f32 v87, s34, v87
 CV 80,80,81
 CV 81,82,83
 CV 82,84,85
 CV 83,86,87
 Mvav 76,220,104
 R 236,235,8192
 R 240,234,256
 R 244,234,8448
 R 248,235,256
 R 252,235,8448
 ds_read_b128 v[176:179], v203 offset:2048
 ds_read_b128 v[184:187], v203 offset:3072
 v_permlane16_swap_b32 v16, v18
 v_permlane16_swap_b32 v17, v19
 v_permlane16_swap_b32 v80, v82
 v_permlane16_swap_b32 v81, v83
 Mvav 140,220,168
 buffer_load_dwordx4 v246, s[12:15], s32 offen offset:2048 nt lds
 Mvav 4,224,16
 buffer_load_dwordx4 v247, s[12:15], s32 offen offset:3072 nt lds
 Mvav 68,224,80
 s_add_u32 m0, s33, 139264
 s_mov_b32 s32, 73728
 v_mul_f32 v24, s34, v24
 Mvav 132,224,144
 s_waitcnt lgkmcnt(8)
 buffer_load_dwordx4 v244, s[12:15], s32 offen nt lds
 Mvav 12,228,16
 v_mul_f32 v25, s34, v25
 v_mul_f32 v26, s34, v26
 v_mul_f32 v27, s34, v27
 v_mul_f32 v28, s34, v28
 v_mul_f32 v29, s34, v29
 v_mul_f32 v30, s34, v30
 v_mul_f32 v31, s34, v31
 CV 24,24,25
 CV 25,26,27
 CV 26,28,29
 CV 27,30,31
 v_mul_f32 v88, s34, v88
 v_mul_f32 v89, s34, v89
 v_mul_f32 v90, s34, v90
 v_mul_f32 v91, s34, v91
 v_mul_f32 v92, s34, v92
 v_mul_f32 v93, s34, v93
 v_mul_f32 v94, s34, v94
 v_mul_f32 v95, s34, v95
 CV 88,88,89
 CV 89,90,91
 CV 90,92,93
 CV 91,94,95
 Mvav 76,228,80
 v_permlane16_swap_b32 v24, v26
 v_permlane16_swap_b32 v25, v27
 v_permlane16_swap_b32 v88, v90
 v_permlane16_swap_b32 v89, v91
 Mvav 140,228,144
 s_waitcnt lgkmcnt(0)
 s_barrier
 buffer_load_dwordx4 v245, s[12:15], s32 offen offset:1024 nt lds
 Mvav 4,232,24
 buffer_load_dwordx4 v246, s[12:15], s32 offen offset:2048 nt lds
 Mvav 68,232,88
 buffer_load_dwordx4 v247, s[12:15], s32 offen offset:3072 nt lds
 Mvav 132,232,152
 v_mul_f32 v48, s34, v48
 v_mul_f32 v49, s34, v49
 Mvav 12,236,24
 v_mul_f32 v50, s34, v50
 v_mul_f32 v51, s34, v51
 v_mul_f32 v52, s34, v52
 v_mul_f32 v53, s34, v53
 v_mul_f32 v54, s34, v54
 v_mul_f32 v55, s34, v55
 CV 48,48,49
 CV 49,50,51
 CV 50,52,53
 CV 51,54,55
 v_mul_f32 v112, s34, v112
 v_mul_f32 v113, s34, v113
 v_mul_f32 v114, s34, v114
 v_mul_f32 v115, s34, v115
 v_mul_f32 v116, s34, v116
 v_mul_f32 v117, s34, v117
 v_mul_f32 v118, s34, v118
 v_mul_f32 v119, s34, v119
 CV 112,112,113
 CV 113,114,115
 CV 114,116,117
 CV 115,118,119
 Mvav 76,236,88
 v_permlane16_swap_b32 v48, v50
 v_permlane16_swap_b32 v49, v51
 v_permlane16_swap_b32 v112, v114
 v_permlane16_swap_b32 v113, v115
 Mvav 140,236,152
 R 192,232,16384
 v_mul_f32 v56, s34, v56
 Mvav 4,240,48
 v_mul_f32 v57, s34, v57
 v_mul_f32 v58, s34, v58
 Mvav 68,240,112
 v_mul_f32 v59, s34, v59
 v_mul_f32 v60, s34, v60
 Mvav 132,240,176
 v_mul_f32 v61, s34, v61
 v_mul_f32 v62, s34, v62
 Mvav 12,244,48
 v_mul_f32 v63, s34, v63
 CV 56,56,57
 CV 57,58,59
 CV 58,60,61
 CV 59,62,63
 v_mul_f32 v120, s34, v120
 v_mul_f32 v121, s34, v121
 v_mul_f32 v122, s34, v122
 v_mul_f32 v123, s34, v123
 v_mul_f32 v124, s34, v124
 v_mul_f32 v125, s34, v125
 v_mul_f32 v126, s34, v126
 v_mul_f32 v127, s34, v127
 CV 120,120,121
 CV 121,122,123
 CV 122,124,125
 CV 123,126,127
 Mvav 76,244,112
 v_permlane16_swap_b32 v56, v58
 v_permlane16_swap_b32 v57, v59
 v_permlane16_swap_b32 v120, v122
 v_permlane16_swap_b32 v121, v123
 Mvav 140,244,176
 R 196,232,24576
 Mvav 4,248,56
 R 200,233,16384
 Mvav 68,248,120
 R 204,233,24576
 Mvav 132,248,184
 R 208,232,16640
 Mvav 12,252,56
 R 212,232,24832
 Mvav 76,252,120
 R 216,233,16640
 Mvav 140,252,184
 s_cmp_eq_u32 s37, 0
 s_cbranch_scc1 LE0_maxpass
LE0_maxback:
 s_waitcnt lgkmcnt(6)
 R 220,233,24832
 Mvavz 36,192,0
 R 224,234,16384
 Mvavz 100,192,64
 R 228,234,24576
 Mvavz 164,192,128
 s_waitcnt lgkmcnt(6)
 R 232,235,16384
 Mvavz 44,196,0
 R 236,235,24576
 v_max3_f32 v192, v192, v4, v5
 Mvavz 108,196,64
 v_max3_f32 v192, v192, v6, v7
 v_max3_f32 v192, v192, v12, v13
 Mvav 36,200,8
 R 240,234,16640
 v_max3_f32 v192, v192, v14, v15
 Mvav 100,200,72
 v_mov_b32 v198, v192
 v_max3_f32 v193, v193, v68, v69
 Mvav 164,200,136
 R 244,234,24832
 v_max3_f32 v193, v193, v70, v71
 Mvav 44,204,8
 v_max3_f32 v193, v193, v76, v77
 v_max3_f32 v193, v193, v78, v79
 Mvav 108,204,72
 s_waitcnt lgkmcnt(3)
 R 248,235,16640
 v_mov_b32 v199, v193
 Mvav 36,208,32
 v_max3_f32 v194, v194, v132, v133
 v_max3_f32 v194, v194, v134, v135
 Mvav 100,208,96
 R 252,235,24832
 v_max3_f32 v194, v194, v140, v141
 Mvav 164,208,160
 v_max3_f32 v194, v194, v142, v143
 v_mov_b32 v200, v194
 Mvav 44,212,32
 v_permlane16_swap_b32 v192, v198
 v_max_f32 v192, v192, v198
 Mvav 108,212,96
 v_mov_b32 v198, v192
 v_permlane16_swap_b32 v193, v199
 Mvav 36,216,40
 s_add_u32 m0, s33, 0
 v_max_f32 v193, v193, v199
 v_mov_b32 v199, v193
 Mvav 100,216,104
 s_mov_b32 s32, 81920
 buffer_load_dwordx4 v244, s[12:15], s32 offen nt lds
 Mvav 164,216,168
 buffer_load_dwordx4 v245, s[12:15], s32 offen offset:1024 nt lds
 Mvav 44,220,40
 buffer_load_dwordx4 v246, s[12:15], s32 offen offset:2048 nt lds
 Mvav 108,220,104
 v_permlane16_swap_b32 v194, v200
 v_max_f32 v194, v194, v200
 Mvav 36,224,16
 buffer_load_dwordx4 v247, s[12:15], s32 offen offset:3072 nt lds
 Mvav 100,224,80
 v_mov_b32 v200, v194
 v_permlane32_swap_b32 v192, v198
 Mvav 164,224,144
 v_max_f32 v192, v192, v198
 v_sub_f32 v52, 0, v192
 Mvav 44,228,16
 s_add_u32 m0, s33, 8192
 v_permlane32_swap_b32 v193, v199
 v_max_f32 v193, v193, v199
 Mvav 108,228,80
 s_waitcnt lgkmcnt(0)
 s_barrier
 T 192,208,32768
 Mvav 36,232,24
 s_mov_b32 s32, 90112
 T 194,208,40960
 v_sub_f32 v116, 0, v193
 Mvav 100,232,88
 buffer_load_dwordx4 v244, s[12:15], s32 offen nt lds
 Mvav 164,232,152
 buffer_load_dwordx4 v245, s[12:15], s32 offen offset:1024 nt lds
 Mvav 44,236,24
 T 196,212,32768
 T 198,212,40960
 Mvav 108,236,88
 buffer_load_dwordx4 v246, s[12:15], s32 offen offset:2048 nt lds
 Mvav 36,240,48
 T 200,209,32768
 T 202,209,40960
 Mvav 100,240,112
 buffer_load_dwordx4 v247, s[12:15], s32 offen offset:3072 nt lds
 Mvav 164,240,176
 v_permlane32_swap_b32 v194, v200
 v_max_f32 v194, v194, v200
 Mvav 44,244,48
 v_sub_f32 v180, 0, v194
 v_add_f32 v132, v132, v180
 Mvav 108,244,112
 EX 132
 Mvav 36,248,56
 v_add_f32 v133, v133, v180
 v_add_f32 v134, v134, v180
 Mvav 100,248,120
 EX 133
 Mvav 164,248,184
 v_add_f32 v135, v135, v180
 v_add_f32 v140, v140, v180
 v_add_f32 v141, v141, v180
 v_add_f32 v142, v142, v180
 v_add_f32 v143, v143, v180
 v_add_f32 v4, v4, v52
 v_add_f32 v5, v5, v52
 v_add_f32 v6, v6, v52
 v_add_f32 v7, v7, v52
 v_add_f32 v12, v12, v52
 v_add_f32 v13, v13, v52
 v_add_f32 v14, v14, v52
 v_add_f32 v15, v15, v52
 v_add_f32 v68, v68, v116
 v_add_f32 v69, v69, v116
 v_add_f32 v70, v70, v116
 v_add_f32 v71, v71, v116
 v_add_f32 v76, v76, v116
 v_add_f32 v77, v77, v116
 v_add_f32 v78, v78, v116
 v_add_f32 v79, v79, v116
 EX 134
 EX 135
 EX 140
 EX 141
 EX 142
 EX 143
 EX 4
 EX 5
 EX 6
 EX 7
 EX 12
 EX 13
 EX 14
 EX 15
 EX 68
 EX 69
 EX 70
 EX 71
 EX 76
 EX 77
 EX 78
 EX 79
 Mvav 44,252,56
 T 204,213,32768
 T 206,213,40960
 CV 148,132,133
 CV 149,134,135
 CV 150,140,141
 CV 151,142,143
 CV 20,4,5
 CV 21,6,7
 CV 22,12,13
 CV 23,14,15
 CV 84,68,69
 CV 85,70,71
 CV 86,76,77
 CV 87,78,79
 Mvav 108,252,120
 s_waitcnt lgkmcnt(2)
 T 208,210,32768
 T 210,210,40960
 Maavz 0,192,20
 T 212,214,32768
 T 214,214,40960
 Maavz 64,192,84
 T 216,211,32768
 T 218,211,40960
 Maavz 128,192,148
 T 220,215,32768
 T 222,215,40960
 Maavz 16,196,20
 T 224,208,33024
 T 226,208,41216
 Maavz 80,196,84
 T 228,212,33024
 T 230,212,41216
 Maavz 4,200,20
 T 232,209,33024
 s_waitcnt lgkmcnt(14)
 T 234,209,41216
 Maavz 68,200,84
 s_waitcnt lgkmcnt(14)
 T 236,213,33024
 s_waitcnt lgkmcnt(14)
 T 238,213,41216
 Maavz 132,200,148
 s_waitcnt lgkmcnt(12)
 v_mov_b32 v195, v4
 v_mov_b32 v196, v68
 Maavz 20,204,20
 T 240,210,33024
 T 242,210,41216
 Maavz 84,204,84
 s_waitcnt lgkmcnt(10)
 v_add_f32 v195, v195, v5
 v_add_f32 v196, v196, v69
 Maavz 8,208,20
 T 244,214,33024
 T 246,214,41216
 Maavz 72,208,84
 v_add_f32 v195, v195, v6
 v_add_f32 v196, v196, v70
 Maavz 136,208,148
 s_waitcnt lgkmcnt(6)
 T 248,211,33024
 T 250,211,41216
 Maavz 24,212,20
 v_add_f32 v195, v195, v7
 v_add_f32 v196, v196, v71
 Maavz 88,212,84
 T 252,215,33024
 T 254,215,41216
 Maavz 12,216,20
 v_mov_b32 v197, v132
 v_add_f32 v195, v195, v12
 Maavz 76,216,84
 v_add_f32 v196, v196, v76
 v_sub_f32 v53, 0, v192
 Maavz 140,216,148
 v_sub_f32 v54, 0, v192
 v_sub_f32 v55, 0, v192
 Maavz 28,220,20
 v_sub_f32 v117, 0, v193
 v_sub_f32 v118, 0, v193
 Maavz 92,220,84
 v_sub_f32 v119, 0, v193
 v_sub_f32 v181, 0, v194
 Maavz 32,224,20
 v_sub_f32 v182, 0, v194
 v_sub_f32 v183, 0, v194
 Maavz 96,224,84
 v_add_f32 v197, v197, v133
 v_add_f32 v195, v195, v13
 Maavz 160,224,148
 v_add_f32 v196, v196, v77
 v_add_f32 v197, v197, v134
 Maavz 48,228,20
 v_add_f32 v195, v195, v14
 v_add_f32 v196, v196, v78
 Maavz 112,228,84
 s_waitcnt vmcnt(24) lgkmcnt(0)
 s_barrier
 R 192,236,32768
 Maavz 36,232,20
 v_add_f32 v197, v197, v135
 v_add_f32 v195, v195, v15
 Maavz 100,232,84
 R 196,236,40960
 v_add_f32 v196, v196, v79
 Maavz 164,232,148
 v_add_f32 v164, v164, v180
 v_add_f32 v165, v165, v180
 Maavz 52,236,20
 R 200,237,32768
 v_add_f32 v166, v166, v180
 Maavz 116,236,84
 EX 164
 Maavz 40,240,20
 R 204,237,40960
 v_add_f32 v167, v167, v180
 Maavz 104,240,84
 EX 165
 Maavz 168,240,148
 R 208,236,33024
 CV 156,164,165
 Maavz 56,244,20
 EX 166
 Maavz 120,244,84
 R 212,236,41216
 v_lshrrev_b32 v207, 4, v204
 Maavz 44,248,20
 EX 167
 Maavz 108,248,84
 R 216,237,33024
 CV 157,166,167
 Maavz 172,248,148
 v_lshrrev_b32 v205, 2, v204
 v_mov_b32 v201, 1
 Maavz 60,252,20
 R 220,237,41216
 v_add_f32 v36, v36, v52
 Maavz 124,252,84
 s_waitcnt lgkmcnt(3)
 ds_write_b64 v202, v[156:157] offset:8
 v_add_f32 v37, v37, v52
 Mc 4,192,0,52
 R 224,238,32768
 EX 36
 EX 37
 v_add_f32 v38, v38, v52
 Mc 68,192,64,116
 Mc 132,192,128,180
 Mc 12,196,0,52
 R 228,238,40960
 EX 38
 v_add_f32 v39, v39, v52
 EX 39
 Mc 76,196,64,116
 Mvav 4,200,8
 Mvav 68,200,72
 R 232,239,32768
 v_add_f32 v44, v44, v52
 EX 44
 v_add_f32 v45, v45, v52
 v_add_f32 v46, v46, v52
 Mvav 132,200,136
 Mvav 12,204,8
 Mvav 76,204,72
 Mvav 4,208,32
 R 236,239,40960
 EX 45
 EX 46
 v_add_f32 v47, v47, v52
 Mvav 68,208,96
 Mvav 132,208,160
 s_waitcnt lgkmcnt(2)
 Mvav 12,212,32
 s_add_u32 m0, s33, 32768
 R 240,238,33024
 EX 47
 v_add_f32 v100, v100, v116
 EX 100
 Mvav 76,212,96
 Mvav 4,216,40
 s_mov_b32 s32, 98304
 Mvav 68,216,104
 Mvav 132,216,168
 R 244,238,41216
 R 248,239,33024
 R 252,239,41216
 Mvav 12,220,40
 Mvav 76,220,104
 buffer_load_dwordx4 v244, s[12:15], s32 offen nt lds
 buffer_load_dwordx4 v245, s[12:15], s32 offen offset:1024 nt lds
 buffer_load_dwordx4 v246, s[12:15], s32 offen offset:2048 nt lds
 Mvav 4,224,16
 Mvav 68,224,80
 Mvav 132,224,144
 buffer_load_dwordx4 v247, s[12:15], s32 offen offset:3072 nt lds
 v_add_f32 v101, v101, v116
 EX 101
 v_add_f32 v102, v102, v116
 Mvav 12,228,16
 s_add_u32 m0, s33, 40960
 Mvav 76,228,80
 s_waitcnt lgkmcnt(0)
 s_barrier
 Mvav 4,232,24
 s_mov_b32 s32, 106496
 Mvav 68,232,88
 buffer_load_dwordx4 v244, s[12:15], s32 offen nt lds
 T 192,208,49152
 T 194,208,57344
 buffer_load_dwordx4 v245, s[12:15], s32 offen offset:1024 nt lds
 Mvav 132,232,152
 Mvav 12,236,24
 Mvav 76,236,88
 ds_read_b64 v[158:159], v203 offset:8
 buffer_load_dwordx4 v246, s[12:15], s32 offen offset:2048 nt lds
 T 196,212,49152
 buffer_load_dwordx4 v247, s[12:15], s32 offen offset:3072 nt lds
 Mvav 4,240,48
 Mvav 68,240,112
 Mvav 132,240,176
 Mvav 12,244,48
 T 198,212,57344
 T 200,209,49152
 EX 102
 v_add_f32 v103, v103, v116
 v_add_f32 v108, v108, v116
 Mvav 76,244,112
 Mvav 4,248,56
 T 202,209,57344
 Mvav 68,248,120
 Mvav 132,248,184
 v_add_f32 v109, v109, v116
 v_add_f32 v110, v110, v116
 v_add_f32 v111, v111, v116
 EX 103
 EX 108
 EX 109
 EX 110
 EX 111
 Mvav 12,252,56
 T 204,213,49152
 T 206,213,57344
 CV 28,36,37
 CV 29,38,39
 CV 30,44,45
 CV 31,46,47
 CV 92,100,101
 CV 93,102,103
 CV 94,108,109
 CV 95,110,111
 Mvav 76,252,120
 s_waitcnt lgkmcnt(5)
 Maav 0,192,28
 T 208,210,49152
 T 210,210,57344
 Maav 64,192,92
 Maav 128,192,156
 s_waitcnt lgkmcnt(4)
 Maav 16,196,28
 T 212,214,49152
 T 214,214,57344
 Maav 80,196,92
 Maav 4,200,28
 T 216,211,49152
 T 218,211,57344
 Maav 68,200,92
 Maav 132,200,156
 s_waitcnt lgkmcnt(4)
 Maav 20,204,28
 T 220,215,49152
 T 222,215,57344
 Maav 84,204,92
 Maav 8,208,28
 T 224,208,49408
 T 226,208,57600
 Maav 72,208,92
 Maav 136,208,156
 s_waitcnt lgkmcnt(4)
 Maav 24,212,28
 T 228,212,49408
 T 230,212,57600
 Maav 88,212,92
 Maav 12,216,28
 T 232,209,49408
 T 234,209,57600
 Maav 76,216,92
 Maav 140,216,156
 s_waitcnt lgkmcnt(4)
 T 236,213,49408
 T 238,213,57600
 T 240,210,49408
 T 242,210,57600
 T 244,214,49408
 T 246,214,57600
 T 248,211,49408
 T 250,211,57600
 T 252,215,49408
 T 254,215,57600
 Maav 28,220,28
 Maav 92,220,92
 Maav 32,224,28
 Maav 96,224,92
 Maav 160,224,156
 s_waitcnt lgkmcnt(10)
 Maav 48,228,28
 Maav 112,228,92
 s_waitcnt vmcnt(24) lgkmcnt(0)
 s_barrier
 Maav 36,232,28
 R 192,236,0
 v_add_f32 v195, v195, v36
 v_add_f32 v196, v196, v100
 v_add_f32 v197, v197, v164
 EX 132
 Maav 100,232,92
 Maav 164,232,156
 Maav 52,236,28
 R 196,236,8192
 v_add_f32 v195, v195, v37
 v_add_f32 v196, v196, v101
 v_add_f32 v197, v197, v165
 EX 133
 Maav 116,236,92
 Maav 40,240,28
 Maav 104,240,92
 Maav 168,240,156
 v_add_f32 v195, v195, v38
 v_add_f32 v196, v196, v102
 R 200,237,0
 v_add_f32 v197, v197, v166
 EX 134
 Maav 56,244,28
 Maav 120,244,92
 Maav 44,248,28
 v_add_f32 v195, v195, v39
 v_add_f32 v196, v196, v103
 R 204,237,8192
 v_add_f32 v197, v197, v167
 EX 135
 Maav 108,248,92
 v_add_f32 v195, v195, v44
 v_add_f32 v196, v196, v108
 Maav 172,248,156
 v_add_f32 v195, v195, v45
 v_add_f32 v196, v196, v109
 Maav 60,252,28
 v_add_f32 v195, v195, v46
 v_add_f32 v196, v196, v110
 Maav 124,252,92
 s_waitcnt lgkmcnt(1)
 v_add_f32 v195, v195, v47
 v_add_f32 v196, v196, v111
 Mc 36,192,0,52
 R 208,236,256
 Mc 100,192,64,116
 Mc 164,192,128,180
 Mc 44,196,0,52
 R 212,236,8448
 Mc 108,196,64,116
 Mvav 36,200,8
 R 216,237,256
 CV 148,132,133
 CV 149,134,135
 EX 4
 v_add_f32 v197, v197, v132
 Mvav 100,200,72
 Mvav 164,200,136
 s_waitcnt lgkmcnt(2)
 Mvav 44,204,8
 R 220,237,8448
 EX 5
 EX 6
 v_add_f32 v195, v195, v4
 Mvav 108,204,72
 Mvav 36,208,32
 R 224,238,0
 Mvav 100,208,96
 Mvav 164,208,160
 s_waitcnt lgkmcnt(2)
 R 228,238,8192
 EX 7
 EX 12
 CV 20,4,5
 Mvav 44,212,32
 Mvav 108,212,96
 Mvav 36,216,40
 R 232,239,0
 Mvav 100,216,104
 R 236,239,8192
 EX 13
 EX 14
 CV 21,6,7
 Mvav 164,216,168
 s_waitcnt lgkmcnt(3)
 R 240,238,256
 R 244,238,8448
 R 248,239,256
 R 252,239,8448
 Mvav 44,220,40
 Mvav 108,220,104
 Mvav 36,224,16
 ds_write_b64 v202, v[148:149]
 Mvav 100,224,80
 Mvav 164,224,144
 s_waitcnt lgkmcnt(6)
 Mvav 44,228,16
 EX 15
 EX 68
 EX 69
 Mvav 108,228,80
 s_waitcnt lgkmcnt(0)
 s_barrier
 Mvav 36,232,24
 Mvav 100,232,88
 T 192,216,49152
 T 194,216,57344
 EX 70
 EX 71
 Mvav 164,232,152
 Mvav 44,236,24
 Mvav 108,236,88
 Mvav 36,240,48
 ds_read_b64 v[150:151], v203
 T 196,220,49152
 EX 76
 EX 77
 Mvav 100,240,112
 Mvav 164,240,176
 Mvav 44,244,48
 T 198,220,57344
 T 200,217,49152
 EX 78
 EX 79
 Mvav 108,244,112
 Mvav 36,248,56
 T 202,217,57344
 Mvav 100,248,120
 s_add_u32 m0, s33, 49152
 Mvav 164,248,184
 Mvav 44,252,56
 s_mov_b32 s32, 114688
 T 204,221,49152
 T 206,221,57344
 CV 22,12,13
 CV 23,14,15
 CV 84,68,69
 CV 85,70,71
 CV 86,76,77
 CV 87,78,79
 Mvav 108,252,120
 s_waitcnt lgkmcnt(5)
 Maav 0,192,20
 T 208,218,49152
 T 210,218,57344
 Maav 64,192,84
 Maav 128,192,148
 s_waitcnt lgkmcnt(4)
 Maav 16,196,20
 T 212,222,49152
 T 214,222,57344
 buffer_load_dwordx4 v244, s[12:15], s32 offen nt lds
 buffer_load_dwordx4 v245, s[12:15], s32 offen offset:1024 nt lds
 Maav 80,196,84
 Maav 4,200,20
 T 216,219,49152
 T 218,219,57344
 Maav 68,200,84
 Maav 132,200,148
 s_waitcnt lgkmcnt(4)
 Maav 20,204,20
 T 220,223,49152
 T 222,223,57344
 buffer_load_dwordx4 v246, s[12:15], s32 offen offset:2048 nt lds
 buffer_load_dwordx4 v247, s[12:15], s32 offen offset:3072 nt lds
 Maav 84,204,84
 Maav 8,208,20
 s_add_u32 m0, s33, 57344
 T 224,216,49408
 T 226,216,57600
 Maav 72,208,84
 s_mov_b32 s32, 122880
 Maav 136,208,148
 s_waitcnt lgkmcnt(4)
 Maav 24,212,20
 buffer_load_dwordx4 v244, s[12:15], s32 offen nt lds
 T 228,220,49408
 T 230,220,57600
 buffer_load_dwordx4 v245, s[12:15], s32 offen offset:1024 nt lds
 Maav 88,212,84
 Maav 12,216,20
 T 232,217,49408
 T 234,217,57600
 Maav 76,216,84
 Maav 140,216,148
 s_waitcnt lgkmcnt(4)
 buffer_load_dwordx4 v246, s[12:15], s32 offen offset:2048 nt lds
 T 236,221,49408
 T 238,221,57600
 T 240,218,49408
 T 242,218,57600
 T 244,222,49408
 T 246,222,57600
 T 248,219,49408
 T 250,219,57600
 T 252,223,49408
 T 254,223,57600
 Maav 28,220,20
 Maav 92,220,84
 buffer_load_dwordx4 v247, s[12:15], s32 offen offset:3072 nt lds
 Maav 32,224,20
 Maav 96,224,84
 Maav 160,224,148
 s_waitcnt lgkmcnt(10)
 Maav 48,228,20
 Maav 112,228,84
 s_waitcnt vmcnt(24) lgkmcnt(0)
 s_barrier
 Maav 36,232,20
 Maav 100,232,84
 R 192,240,0
 v_add_f32 v196, v196, v68
 v_add_f32 v195, v195, v5
 v_add_f32 v197, v197, v133
 EX 164
 Maav 164,232,148
 Maav 52,236,20
 Maav 116,236,84
 R 196,240,8192
 v_add_f32 v196, v196, v69
 v_add_f32 v195, v195, v6
 v_add_f32 v197, v197, v134
 EX 165
 Maav 40,240,20
 Maav 104,240,84
 Maav 168,240,148
 Maav 56,244,20
 v_add_f32 v196, v196, v70
 R 200,241,0
 v_add_f32 v195, v195, v7
 v_add_f32 v197, v197, v135
 EX 166
 Maav 120,244,84
 Maav 44,248,20
 v_add_f32 v196, v196, v71
 Maav 108,248,84
 v_add_f32 v195, v195, v12
 v_add_f32 v196, v196, v76
 Maav 172,248,148
 v_add_f32 v195, v195, v13
 v_add_f32 v196, v196, v77
 Maav 60,252,20
 R 204,241,8192
 v_add_f32 v195, v195, v14
 v_add_f32 v196, v196, v78
 Maav 124,252,84
 s_waitcnt lgkmcnt(2)
 v_add_f32 v195, v195, v15
 v_add_f32 v196, v196, v79
 Mc 4,192,0,52
 R 208,240,256
 Mc 68,192,64,116
 Mc 132,192,128,180
 Mc 12,196,0,52
 R 212,240,8448
 EX 167
 CV 156,164,165
 EX 36
 Mc 76,196,64,116
 s_waitcnt lgkmcnt(3)
 Mvav 4,200,8
 R 216,241,256
 Mvav 68,200,72
 Mvav 132,200,136
 s_waitcnt lgkmcnt(2)
 R 220,241,8448
 CV 157,166,167
 EX 37
 EX 38
 Mvav 12,204,8
 Mvav 76,204,72
 Mvav 4,208,32
 R 224,242,0
 EX 39
 EX 44
 CV 28,36,37
 Mvav 68,208,96
 Mvav 132,208,160
 s_waitcnt lgkmcnt(2)
 Mvav 12,212,32
 R 228,242,8192
 Mvav 76,212,96
 Mvav 4,216,40
 R 232,243,0
 EX 45
 EX 46
 CV 29,38,39
 Mvav 68,216,104
 Mvav 132,216,168
 s_waitcnt lgkmcnt(2)
 R 236,243,8192
 R 240,242,256
 R 244,242,8448
 R 248,243,256
 R 252,243,8448
 Mvav 12,220,40
 Mvav 76,220,104
 Mvav 4,224,16
 ds_write_b64 v202, v[156:157] offset:8
 Mvav 68,224,80
 Mvav 132,224,144
 s_waitcnt lgkmcnt(6)
 EX 47
 EX 100
 EX 101
 Mvav 12,228,16
 Mvav 76,228,80
 s_waitcnt lgkmcnt(0)
 s_barrier
 Mvav 4,232,24
 T 192,224,16384
 T 194,224,24576
 EX 102
 EX 103
 Mvav 68,232,88
 Mvav 132,232,152
 Mvav 12,236,24
 Mvav 76,236,88
 ds_read_b64 v[158:159], v203 offset:8
 T 196,228,16384
 EX 108
 EX 109
 Mvav 4,240,48
 Mvav 68,240,112
 Mvav 132,240,176
 T 198,228,24576
 T 200,225,16384
 EX 110
 EX 111
 Mvav 12,244,48
 Mvav 76,244,112
 Mvav 4,248,56
 T 202,225,24576
 Mvav 68,248,120
 T 204,229,16384
 T 206,229,24576
 CV 30,44,45
 CV 31,46,47
 CV 92,100,101
 CV 93,102,103
 Mvav 132,248,184
 Mvav 12,252,56
 CV 94,108,109
 CV 95,110,111
 Mvav 76,252,120
 s_waitcnt lgkmcnt(3)
 Maav 0,192,28
 T 208,226,16384
 T 210,226,24576
 Maav 64,192,92
 Maav 128,192,156
 T 212,230,16384
 T 214,230,24576
 v_add_f32 v195, v195, v36
 v_add_f32 v196, v196, v100
 v_add_f32 v197, v197, v164
 Maav 16,196,28
 Maav 80,196,92
 s_waitcnt lgkmcnt(4)
 Maav 4,200,28
 T 216,227,16384
 T 218,227,24576
 v_add_f32 v195, v195, v37
 v_add_f32 v196, v196, v101
 EX 132
 Maav 68,200,92
 Maav 132,200,156
 Maav 20,204,28
 T 220,231,16384
 T 222,231,24576
 Maav 84,204,92
 s_waitcnt lgkmcnt(4)
 Maav 8,208,28
 T 224,224,16640
 T 226,224,24832
 v_add_f32 v195, v195, v38
 v_add_f32 v196, v196, v102
 EX 133
 Maav 72,208,92
 Maav 136,208,156
 Maav 24,212,28
 T 228,228,16640
 T 230,228,24832
 v_add_f32 v195, v195, v39
 v_add_f32 v196, v196, v103
 v_add_f32 v197, v197, v165
 CV 148,132,133
 Maav 88,212,92
 s_waitcnt lgkmcnt(6)
 Maav 12,216,28
 T 232,225,16640
 T 234,225,24832
 Maav 76,216,92
 Maav 140,216,156
 s_waitcnt lgkmcnt(4)
 T 236,229,16640
 T 238,229,24832
 T 240,226,16640
 T 242,226,24832
 T 244,230,16640
 T 246,230,24832
 T 248,227,16640
 T 250,227,24832
 T 252,231,16640
 T 254,231,24832
 Maav 28,220,28
 Maav 92,220,92
 Maav 32,224,28
 s_add_u32 m0, s33, 114688
 Maav 96,224,92
 s_mov_b32 s32, 131072
 Maav 160,224,156
 s_waitcnt lgkmcnt(10)
 Maav 48,228,28
 Maav 112,228,92
 s_waitcnt vmcnt(16) lgkmcnt(0)
 s_barrier
 buffer_load_dwordx4 v244, s[12:15], s32 offen nt lds
 R 192,232,0
 buffer_load_dwordx4 v245, s[12:15], s32 offen offset:1024 nt lds
 v_add_f32 v195, v195, v44
 Maav 36,232,28
 Maav 100,232,92
 Maav 164,232,156
 Maav 52,236,28
 buffer_load_dwordx4 v246, s[12:15], s32 offen offset:2048 nt lds
 R 196,232,8192
 buffer_load_dwordx4 v247, s[12:15], s32 offen offset:3072 nt lds
 v_add_f32 v196, v196, v108
 Maav 116,236,92
 Maav 40,240,28
 s_add_u32 m0, s33, 122880
 Maav 104,240,92
 s_mov_b32 s32, 139264
 R 200,233,0
 buffer_load_dwordx4 v244, s[12:15], s32 offen nt lds
 v_add_f32 v195, v195, v45
 v_add_f32 v196, v196, v109
 v_add_f32 v197, v197, v166
 Maav 168,240,156
 Maav 56,244,28
 Maav 120,244,92
 Maav 44,248,28
 R 204,233,8192
 v_add_f32 v195, v195, v46
 v_add_f32 v196, v196, v110
 buffer_load_dwordx4 v245, s[12:15], s32 offen offset:1024 nt lds
 v_add_f32 v197, v197, v167
 Maav 108,248,92
 Maav 172,248,156
 Maav 60,252,28
 v_add_f32 v195, v195, v47
 v_add_f32 v196, v196, v111
 R 208,232,256
 buffer_load_dwordx4 v246, s[12:15], s32 offen offset:2048 nt lds
 v_add_f32 v197, v197, v132
 Maav 124,252,92
 s_waitcnt lgkmcnt(2)
 Mc 36,192,0,52
 Mc 100,192,64,116
 Mc 164,192,128,180
 buffer_load_dwordx4 v247, s[12:15], s32 offen offset:3072 nt lds
 R 212,232,8448
 EX 134
 v_add_f32 v197, v197, v133
 Mc 44,196,0,52
 Mc 108,196,64,116
 Mvav 36,200,8
 R 216,233,256
 EX 135
 EX 4
 v_add_f32 v197, v197, v134
 Mvav 100,200,72
 Mvav 164,200,136
 s_waitcnt lgkmcnt(2)
 Mvav 44,204,8
 R 220,233,8448
 Mvav 108,204,72
 R 224,234,0
 CV 149,134,135
 EX 5
 EX 6
 Mvav 36,208,32
 Mvav 100,208,96
 Mvav 164,208,160
 s_waitcnt lgkmcnt(2)
 Mvav 44,212,32
 R 228,234,8192
 EX 7
 EX 12
 CV 20,4,5
 Mvav 108,212,96
 Mvav 36,216,40
 R 232,235,0
 Mvav 100,216,104
 Mvav 164,216,168
 s_waitcnt lgkmcnt(2)
 R 236,235,8192
 R 240,234,256
 R 244,234,8448
 R 248,235,256
 R 252,235,8448
 Mvav 44,220,40
 Mvav 108,220,104
 Mvav 36,224,16
 ds_write_b64 v202, v[148:149]
 EX 13
 EX 14
 CV 21,6,7
 Mvav 100,224,80
 Mvav 164,224,144
 s_waitcnt lgkmcnt(6)
 Mvav 44,228,16
 EX 15
 EX 68
 EX 69
 Mvav 108,228,80
 s_waitcnt lgkmcnt(0)
 s_barrier
 Mvav 36,232,24
 Mvav 100,232,88
 Mvav 164,232,152
 T 192,208,16384
 T 194,208,24576
 EX 70
 EX 71
 Mvav 44,236,24
 Mvav 108,236,88
 Mvav 36,240,48
 ds_read_b64 v[150:151], v203
 T 196,212,16384
 EX 76
 EX 77
 Mvav 100,240,112
 Mvav 164,240,176
 Mvav 44,244,48
 T 198,212,24576
 Mvav 108,244,112
 Mvav 36,248,56
 T 200,209,16384
 T 202,209,24576
 EX 78
 EX 79
 Mvav 100,248,120
 Mvav 164,248,184
 Mvav 44,252,56
 T 204,213,16384
 T 206,213,24576
 CV 22,12,13
 CV 23,14,15
 CV 84,68,69
 CV 85,70,71
 CV 86,76,77
 CV 87,78,79
 Mvav 108,252,120
 s_waitcnt lgkmcnt(5)
 Maav 0,192,20
 T 208,210,16384
 T 210,210,24576
 Maav 64,192,84
 Maav 128,192,148
 s_waitcnt lgkmcnt(4)
 Maav 16,196,20
 T 212,214,16384
 T 214,214,24576
 Maav 80,196,84
 Maav 4,200,20
 T 216,211,16384
 T 218,211,24576
 v_add_f32 v195, v195, v4
 v_add_f32 v196, v196, v68
 EX 164
 Maav 68,200,84
 Maav 132,200,148
 s_waitcnt lgkmcnt(4)
 Maav 20,204,20
 T 220,215,16384
 T 222,215,24576
 Maav 84,204,84
 Maav 8,208,20
 T 224,208,16640
 T 226,208,24832
 v_add_f32 v195, v195, v5
 v_add_f32 v196, v196, v69
 EX 165
 Maav 72,208,84
 Maav 136,208,148
 s_waitcnt lgkmcnt(4)
 Maav 24,212,20
 T 228,212,16640
 T 230,212,24832
 v_add_f32 v195, v195, v6
 v_add_f32 v196, v196, v70
 v_add_f32 v197, v197, v135
 CV 156,164,165
 Maav 88,212,84
 Maav 12,216,20
 T 232,209,16640
 T 234,209,24832
 Maav 76,216,84
 Maav 140,216,148
 s_waitcnt lgkmcnt(4)
 T 236,213,16640
 T 238,213,24832
 T 240,210,16640
 T 242,210,24832
 T 244,214,16640
 T 246,214,24832
 T 248,211,16640
 T 250,211,24832
 T 252,215,16640
 T 254,215,24832
 Maav 28,220,20
 Maav 92,220,84
 Maav 32,224,20
 Maav 96,224,84
 Maav 160,224,148
 s_waitcnt lgkmcnt(10)
 Maav 48,228,20
 Maav 112,228,84
 s_waitcnt vmcnt(16) lgkmcnt(0)
 s_barrier
 R 192,232,32768
 v_add_f32 v195, v195, v7
 v_add_f32 v196, v196, v71
 EX 166
 v_add_f32 v197, v197, v164
 Maav 36,232,20
 Maav 100,232,84
 Maav 164,232,148
 Maav 52,236,20
 R 196,232,40960
 v_add_f32 v195, v195, v12
 v_add_f32 v196, v196, v76
 EX 167
 v_add_f32 v197, v197, v165
 Maav 116,236,84
 Maav 40,240,20
 Maav 104,240,84
 R 200,233,32768
 v_add_f32 v195, v195, v13
 v_add_f32 v196, v196, v77
 CV 157,166,167
 EX 36
 Maav 168,240,148
 Maav 56,244,20
 Maav 120,244,84
 Maav 44,248,20
 R 204,233,40960
 v_add_f32 v195, v195, v14
 v_add_f32 v196, v196, v78
 EX 37
 v_add_f32 v197, v197, v166
 Maav 108,248,84
 Maav 172,248,148
 Maav 60,252,20
 v_add_f32 v195, v195, v15
 v_add_f32 v196, v196, v79
 R 208,232,33024
 EX 38
 CV 28,36,37
 Maav 124,252,84
 s_waitcnt lgkmcnt(2)
 Mc 4,192,0,52
 Mc 68,192,64,116
 Mc 132,192,128,180
 R 212,232,41216
 EX 39
 EX 44
 v_add_f32 v195, v195, v36
 Mc 12,196,0,52
 Mc 76,196,64,116
 Mvav 4,200,8
 s_add_u32 m0, s33, 147456
 R 216,233,33024
 EX 45
 EX 46
 CV 29,38,39
 Mvav 68,200,72
 s_mov_b32 s32, 147456
 Mvav 132,200,136
 s_waitcnt lgkmcnt(2)
 Mvav 12,204,8
 R 220,233,41216
 Mvav 76,204,72
 R 224,234,32768
 buffer_load_dwordx4 v244, s[12:15], s32 offen nt lds
 buffer_load_dwordx4 v245, s[12:15], s32 offen offset:1024 nt lds
 CV 30,44,45
 Mvav 4,208,32
 Mvav 68,208,96
 Mvav 132,208,160
 s_waitcnt lgkmcnt(2)
 Mvav 12,212,32
 R 228,234,40960
 buffer_load_dwordx4 v246, s[12:15], s32 offen offset:2048 nt lds
 buffer_load_dwordx4 v247, s[12:15], s32 offen offset:3072 nt lds
 v_add_f32 v195, v195, v37
 Mvav 76,212,96
 Mvav 4,216,40
 s_add_u32 m0, s33, 155648
 R 232,235,32768
 Mvav 68,216,104
 s_mov_b32 s32, 155648
 Mvav 132,216,168
 s_waitcnt lgkmcnt(2)
 R 236,235,40960
 R 240,234,33024
 R 244,234,41216
 R 248,235,33024
 R 252,235,41216
 Mvav 12,220,40
 Mvav 76,220,104
 Mvav 4,224,16
 ds_write_b64 v202, v[156:157] offset:8
 buffer_load_dwordx4 v244, s[12:15], s32 offen nt lds
 buffer_load_dwordx4 v245, s[12:15], s32 offen offset:1024 nt lds
 v_add_f32 v195, v195, v38
 Mvav 68,224,80
 Mvav 132,224,144
 s_waitcnt lgkmcnt(6)
 Mvav 12,228,16
 buffer_load_dwordx4 v246, s[12:15], s32 offen offset:2048 nt lds
 buffer_load_dwordx4 v247, s[12:15], s32 offen offset:3072 nt lds
 EX 47
 Mvav 76,228,80
 s_waitcnt lgkmcnt(0)
 s_barrier
 Mvav 4,232,24
 Mvav 68,232,88
 Mvav 132,232,152
 T 192,216,32768
 T 194,216,40960
 EX 100
 EX 101
 Mvav 12,236,24
 Mvav 76,236,88
 Mvav 4,240,48
 ds_read_b64 v[158:159], v203 offset:8
 T 196,220,32768
 EX 102
 EX 103
 Mvav 68,240,112
 Mvav 132,240,176
 Mvav 12,244,48
 T 198,220,40960
 Mvav 76,244,112
 Mvav 4,248,56
 T 200,217,32768
 T 202,217,40960
 EX 108
 EX 109
 Mvav 68,248,120
 Mvav 132,248,184
 EX 110
 EX 111
 Mvav 12,252,56
 T 204,221,32768
 T 206,221,40960
 CV 31,46,47
 CV 92,100,101
 CV 93,102,103
 CV 94,108,109
 CV 95,110,111
 Mvav 76,252,120
 s_waitcnt lgkmcnt(5)
 Maav 0,192,28
 s_add_u32 m0, s33, 0
 T 208,218,32768
 T 210,218,40960
 Maav 64,192,92
 s_mov_b32 s32, 0
 Maav 128,192,156
 s_waitcnt lgkmcnt(4)
 Maav 16,196,28
 T 212,222,32768
 T 214,222,40960
 Maav 80,196,92
 Maav 4,200,28
 T 216,219,32768
 T 218,219,40960
 Maav 68,200,92
 Maav 132,200,156
 s_waitcnt lgkmcnt(4)
 Maav 20,204,28
 T 220,223,32768
 T 222,223,40960
 buffer_load_dwordx4 v252, s[20:23], s32 offen lds
 buffer_load_dwordx4 v253, s[20:23], s32 offen offset:1024 lds
 Maav 84,204,92
 Maav 8,208,28
 T 224,216,33024
 T 226,216,41216
 Maav 72,208,92
 Maav 136,208,156
 s_waitcnt lgkmcnt(4)
 Maav 24,212,28
 buffer_load_dwordx4 v254, s[20:23], s32 offen offset:2048 lds
 T 228,220,33024
 T 230,220,41216
 buffer_load_dwordx4 v255, s[20:23], s32 offen offset:3072 lds
 Maav 88,212,92
 Maav 12,216,28
 s_add_u32 m0, s33, 8192
 T 232,217,33024
 T 234,217,41216
 Maav 76,216,92
 s_mov_b32 s32, 14336
 Maav 140,216,156
 s_waitcnt lgkmcnt(4)
 buffer_load_dwordx4 v252, s[20:23], s32 offen lds
 T 236,221,33024
 T 238,221,41216
 T 240,218,33024
 T 242,218,41216
 T 244,222,33024
 T 246,222,41216
 T 248,219,33024
 T 250,219,41216
 T 252,223,33024
 T 254,223,41216
 Maav 28,220,28
 Maav 92,220,92
 buffer_load_dwordx4 v253, s[20:23], s32 offen offset:1024 lds
 Maav 32,224,28
 Maav 96,224,92
 buffer_load_dwordx4 v254, s[20:23], s32 offen offset:2048 lds
 Maav 160,224,156
 s_waitcnt lgkmcnt(10)
 Maav 48,228,28
 buffer_load_dwordx4 v255, s[20:23], s32 offen offset:3072 lds
 Maav 112,228,92
 s_waitcnt vmcnt(24) lgkmcnt(0)
 s_barrier
 Maav 36,232,28
 Maav 100,232,92
 Maav 164,232,156
 Maav 52,236,28
 R 192,232,49152
 v_add_f32 v196, v196, v100
 v_add_f32 v195, v195, v39
 v_add_f32 v197, v197, v167
 EX 132
 Maav 116,236,92
 Maav 40,240,28
 Maav 104,240,92
 Maav 168,240,156
 R 196,232,57344
 v_add_f32 v196, v196, v101
 v_add_f32 v195, v195, v44
 EX 133
 v_add_f32 v197, v197, v132
 Maav 56,244,28
 Maav 120,244,92
 v_add_f32 v196, v196, v102
 Maav 44,248,28
 R 200,233,49152
 v_add_f32 v196, v196, v103
 Maav 108,248,92
 v_add_f32 v196, v196, v108
 Maav 172,248,156
 v_add_f32 v195, v195, v45
 v_add_f32 v196, v196, v109
 Maav 60,252,28
 R 204,233,57344
 v_add_f32 v195, v195, v46
 v_add_f32 v196, v196, v110
 Maav 124,252,92
 s_waitcnt lgkmcnt(2)
 v_add_f32 v195, v195, v47
 v_add_f32 v196, v196, v111
 Mc 36,192,0,52
 R 208,232,49408
 Mc 100,192,64,116
 Mc 164,192,128,180
 R 212,232,57600
 EX 134
 EX 135
 CV 148,132,133
 Mc 44,196,0,52
 Mc 108,196,64,116
 s_waitcnt lgkmcnt(3)
 Mvav 36,200,8
 R 216,233,49408
 Mvav 100,200,72
 R 220,233,57600
 CV 149,134,135
 EX 4
 EX 5
 Mvav 164,200,136
 s_waitcnt lgkmcnt(3)
 Mvav 44,204,8
 Mvav 108,204,72
 Mvav 36,208,32
 R 224,234,49152
 EX 6
 EX 7
 CV 20,4,5
 Mvav 100,208,96
 Mvav 164,208,160
 s_waitcnt lgkmcnt(2)
 Mvav 44,212,32
 R 228,234,57344
 EX 12
 EX 13
 CV 21,6,7
 Mvav 108,212,96
 Mvav 36,216,40
 R 232,235,49152
 Mvav 100,216,104
 Mvav 164,216,168
 s_waitcnt lgkmcnt(2)
 R 236,235,57344
 R 240,234,49408
 R 244,234,57600
 R 248,235,49408
 R 252,235,57600
 Mvav 44,220,40
 Mvav 108,220,104
 Mvav 36,224,16
 ds_write_b64 v202, v[148:149]
 EX 14
 EX 15
 CV 22,12,13
 Mvav 100,224,80
 Mvav 164,224,144
 s_waitcnt lgkmcnt(6)
 Mvav 44,228,16
 Mvav 108,228,80
 s_waitcnt lgkmcnt(0)
 s_barrier
 T 192,216,0
 T 194,216,8192
 EX 68
 EX 69
 Mvav 36,232,24
 Mvav 100,232,88
 Mvav 164,232,152
 Mvav 44,236,24
 s_add_u32 m0, s33, 32768
 ds_read_b64 v[150:151], v203
 T 196,220,0
 EX 70
 EX 71
 Mvav 108,236,88
 Mvav 36,240,48
 s_mov_b32 s32, 163840
 Mvav 100,240,112
 T 198,220,8192
 T 200,217,0
 buffer_load_dwordx4 v244, s[12:15], s32 offen nt lds
 EX 76
 Mvav 164,240,176
 Mvav 44,244,48
 Mvav 108,244,112
 Mvav 36,248,56
 T 202,217,8192
 EX 77
 EX 78
 CV 23,14,15
 Mvav 100,248,120
 Mvav 164,248,184
 EX 79
 Mvav 44,252,56
 T 204,221,0
 T 206,221,8192
 CV 84,68,69
 CV 85,70,71
 CV 86,76,77
 CV 87,78,79
 Mvav 108,252,120
 s_waitcnt lgkmcnt(3)
 buffer_load_dwordx4 v245, s[12:15], s32 offen offset:1024 nt lds
 Maav 0,192,20
 T 208,218,0
 T 210,218,8192
 Maav 64,192,84
 buffer_load_dwordx4 v246, s[12:15], s32 offen offset:2048 nt lds
 Maav 128,192,148
 Maav 16,196,20
 buffer_load_dwordx4 v247, s[12:15], s32 offen offset:3072 nt lds
 T 212,222,0
 T 214,222,8192
 Maav 80,196,84
 s_waitcnt lgkmcnt(6)
 Maav 4,200,20
 s_add_u32 m0, s33, 40960
 s_mov_b32 s32, 172032
 buffer_load_dwordx4 v244, s[12:15], s32 offen nt lds
 T 216,219,0
 T 218,219,8192
 Maav 68,200,84
 Maav 132,200,148
 s_waitcnt lgkmcnt(4)
 buffer_load_dwordx4 v245, s[12:15], s32 offen offset:1024 nt lds
 Maav 20,204,20
 T 220,223,0
 T 222,223,8192
 Maav 84,204,84
 buffer_load_dwordx4 v246, s[12:15], s32 offen offset:2048 nt lds
 Maav 8,208,20
 T 224,216,256
 T 226,216,8448
 Maav 72,208,84
 buffer_load_dwordx4 v247, s[12:15], s32 offen offset:3072 nt lds
 Maav 136,208,148
 s_waitcnt lgkmcnt(4)
 Maav 24,212,20
 T 228,220,256
 T 230,220,8448
 Maav 88,212,84
 Maav 12,216,20
 T 232,217,256
 T 234,217,8448
 Maav 76,216,84
 Maav 140,216,148
 s_waitcnt lgkmcnt(4)
 T 236,221,256
 T 238,221,8448
 T 240,218,256
 T 242,218,8448
 T 244,222,256
 T 246,222,8448
 T 248,219,256
 T 250,219,8448
 T 252,223,256
 T 254,223,8448
 Maav 28,220,20
 Maav 92,220,84
 Maav 32,224,20
 Maav 96,224,84
 Maav 160,224,148
 s_waitcnt lgkmcnt(10)
 Maav 48,228,20
 Maav 112,228,84
 s_waitcnt vmcnt(24) lgkmcnt(0)
 s_barrier
 Maav 36,232,20
 R 192,236,49152
 v_add_f32 v195, v195, v4
 v_add_f32 v196, v196, v68
 v_add_f32 v197, v197, v133
 EX 164
 Maav 100,232,84
 Maav 164,232,148
 Maav 52,236,20
 Maav 116,236,84
 R 196,236,57344
 v_add_f32 v195, v195, v5
 v_add_f32 v196, v196, v69
 v_add_f32 v197, v197, v134
 EX 165
 Maav 40,240,20
 Maav 104,240,84
 Maav 168,240,148
 v_add_f32 v195, v195, v6
 v_add_f32 v196, v196, v70
 R 200,237,49152
 v_add_f32 v197, v197, v135
 EX 166
 Maav 56,244,20
 Maav 120,244,84
 Maav 44,248,20
 v_add_f32 v195, v195, v7
 v_add_f32 v196, v196, v71
 Maav 108,248,84
 v_add_f32 v195, v195, v12
 v_add_f32 v196, v196, v76
 Maav 172,248,148
 v_add_f32 v195, v195, v13
 v_add_f32 v196, v196, v77
 Maav 60,252,20
 R 204,237,57344
 v_add_f32 v195, v195, v14
 v_add_f32 v196, v196, v78
 Maav 124,252,84
 s_waitcnt lgkmcnt(1)
 v_add_f32 v195, v195, v15
 v_add_f32 v196, v196, v79
 Mc 4,192,0,52
 R 208,236,49408
 Mc 68,192,64,116
 Mc 132,192,128,180
 Mc 12,196,0,52
 R 212,236,57600
 EX 167
 CV 156,164,165
 EX 36
 Mc 76,196,64,116
 Mvav 4,200,8
 R 216,237,49408
 Mvav 68,200,72
 Mvav 132,200,136
 s_waitcnt lgkmcnt(2)
 R 220,237,57600
 CV 157,166,167
 EX 37
 EX 38
 Mvav 12,204,8
 Mvav 76,204,72
 Mvav 4,208,32
 R 224,238,49152
 EX 39
 EX 44
 CV 28,36,37
 Mvav 68,208,96
 Mvav 132,208,160
 s_waitcnt lgkmcnt(2)
 Mvav 12,212,32
 R 228,238,57344
 Mvav 76,212,96
 Mvav 4,216,40
 R 232,239,49152
 EX 45
 EX 46
 CV 29,38,39
 Mvav 68,216,104
 Mvav 132,216,168
 s_waitcnt lgkmcnt(2)
 R 236,239,57344
 R 240,238,49408
 R 244,238,57600
 R 248,239,49408
 R 252,239,57600
 Mvav 12,220,40
 Mvav 76,220,104
 Mvav 4,224,16
 ds_write_b64 v202, v[156:157] offset:8
 Mvav 68,224,80
 Mvav 132,224,144
 s_waitcnt lgkmcnt(6)
 EX 47
 EX 100
 EX 101
 Mvav 12,228,16
 Mvav 76,228,80
 s_waitcnt lgkmcnt(0)
 s_barrier
 Mvav 4,232,24
 T 192,224,0
 T 194,224,8192
 EX 102
 EX 103
 Mvav 68,232,88
 Mvav 132,232,152
 Mvav 12,236,24
 Mvav 76,236,88
 ds_read_b64 v[158:159], v203 offset:8
 T 196,228,0
 EX 108
 EX 109
 Mvav 4,240,48
 Mvav 68,240,112
 Mvav 132,240,176
 T 198,228,8192
 T 200,225,0
 EX 110
 EX 111
 Mvav 12,244,48
 Mvav 76,244,112
 Mvav 4,248,56
 T 202,225,8192
 Mvav 68,248,120
 T 204,229,0
 T 206,229,8192
 CV 30,44,45
 CV 31,46,47
 CV 92,100,101
 CV 93,102,103
 Mvav 132,248,184
 Mvav 12,252,56
 CV 94,108,109
 CV 95,110,111
 Mvav 76,252,120
 s_waitcnt lgkmcnt(3)
 Maav 0,192,28
 T 208,226,0
 T 210,226,8192
 Maav 64,192,92
 Maav 128,192,156
 T 212,230,0
 T 214,230,8192
 v_add_f32 v195, v195, v36
 v_add_f32 v196, v196, v100
 v_add_f32 v197, v197, v164
 Maav 16,196,28
 Maav 80,196,92
 s_waitcnt lgkmcnt(4)
 Maav 4,200,28
 T 216,227,0
 T 218,227,8192
 v_add_f32 v195, v195, v37
 v_add_f32 v196, v196, v101
 EX 132
 Maav 68,200,92
 Maav 132,200,156
 Maav 20,204,28
 T 220,231,0
 T 222,231,8192
 Maav 84,204,92
 s_waitcnt lgkmcnt(4)
 Maav 8,208,28
 T 224,224,256
 T 226,224,8448
 v_add_f32 v195, v195, v38
 v_add_f32 v196, v196, v102
 EX 133
 Maav 72,208,92
 Maav 136,208,156
 Maav 24,212,28
 s_add_u32 m0, s33, 65536
 T 228,228,256
 T 230,228,8448
 v_add_f32 v195, v195, v39
 v_add_f32 v196, v196, v103
 v_add_f32 v197, v197, v165
 CV 148,132,133
 Maav 88,212,92
 s_waitcnt lgkmcnt(6)
 Maav 12,216,28
 s_mov_b32 s32, 180224
 T 232,225,256
 T 234,225,8448
 Maav 76,216,92
 Maav 140,216,156
 s_waitcnt lgkmcnt(4)
 T 236,229,256
 T 238,229,8448
 T 240,226,256
 T 242,226,8448
 T 244,230,256
 T 246,230,8448
 T 248,227,256
 T 250,227,8448
 T 252,231,256
 T 254,231,8448
 Maav 28,220,28
 Maav 92,220,92
 Maav 32,224,28
 Maav 96,224,92
 buffer_load_dwordx4 v244, s[12:15], s32 offen nt lds
 Maav 160,224,156
 s_waitcnt lgkmcnt(10)
 Maav 48,228,28
 buffer_load_dwordx4 v245, s[12:15], s32 offen offset:1024 nt lds
 Maav 112,228,92
 s_waitcnt vmcnt(18) lgkmcnt(0)
 s_barrier
 Maav 36,232,28
 buffer_load_dwordx4 v246, s[12:15], s32 offen offset:2048 nt lds
 Maav 100,232,92
 Maav 164,232,156
 buffer_load_dwordx4 v247, s[12:15], s32 offen offset:3072 nt lds
 Maav 52,236,28
 s_add_u32 m0, s33, 73728
 Maav 116,236,92
 s_mov_b32 s32, 188416
 buffer_load_dwordx4 v244, s[12:15], s32 offen nt lds
 R 192,240,16384
 buffer_load_dwordx4 v245, s[12:15], s32 offen offset:1024 nt lds
 Maav 40,240,28
 Maav 104,240,92
 Maav 168,240,156
 buffer_load_dwordx4 v246, s[12:15], s32 offen offset:2048 nt lds
 R 196,240,24576
 buffer_load_dwordx4 v247, s[12:15], s32 offen offset:3072 nt lds
 v_add_f32 v195, v195, v44
 Maav 56,244,28
 Maav 120,244,92
 Maav 44,248,28
 R 200,241,16384
 v_add_f32 v196, v196, v108
 v_add_f32 v195, v195, v45
 v_add_f32 v197, v197, v166
 EX 134
 Maav 108,248,92
 Maav 172,248,156
 v_add_f32 v196, v196, v109
 Maav 60,252,28
 R 204,241,24576
 v_add_f32 v195, v195, v46
 v_add_f32 v196, v196, v110
 Maav 124,252,92
 s_waitcnt lgkmcnt(2)
 v_add_f32 v197, v197, v167
 v_add_f32 v195, v195, v47
 v_add_f32 v196, v196, v111
 Mc 36,192,0,52
 R 208,240,16640
 Mc 100,192,64,116
 Mc 164,192,128,180
 Mc 44,196,0,52
 R 212,240,24832
 EX 135
 EX 4
 v_add_f32 v197, v197, v132
 Mc 108,196,64,116
 s_waitcnt lgkmcnt(3)
 Mvav 36,200,8
 R 216,241,16640
 Mvav 100,200,72
 Mvav 164,200,136
 s_waitcnt lgkmcnt(2)
 Mvav 44,204,8
 R 220,241,24832
 CV 149,134,135
 EX 5
 EX 6
 Mvav 108,204,72
 Mvav 36,208,32
 R 224,242,16384
 Mvav 100,208,96
 Mvav 164,208,160
 s_waitcnt lgkmcnt(2)
 R 228,242,24576
 EX 7
 EX 12
 CV 20,4,5
 Mvav 44,212,32
 Mvav 108,212,96
 Mvav 36,216,40
 R 232,243,16384
 EX 13
 EX 14
 CV 21,6,7
 Mvav 100,216,104
 Mvav 164,216,168
 s_waitcnt lgkmcnt(2)
 R 236,243,24576
 R 240,242,16640
 R 244,242,24832
 R 248,243,16640
 R 252,243,24832
 Mvav 44,220,40
 Mvav 108,220,104
 Mvav 36,224,16
 ds_write_b64 v202, v[148:149]
 Mvav 100,224,80
 Mvav 164,224,144
 s_waitcnt lgkmcnt(6)
 EX 15
 EX 68
 EX 69
 Mvav 44,228,16
 Mvav 108,228,80
 s_waitcnt lgkmcnt(0)
 s_barrier
 Mvav 36,232,24
 Mvav 100,232,88
 T 192,208,16384
 T 194,208,24576
 EX 70
 EX 71
 Mvav 164,232,152
 Mvav 44,236,24
 Mvav 108,236,88
 ds_read_b64 v[150:151], v203
 T 196,212,16384
 EX 76
 EX 77
 Mvav 36,240,48
 Mvav 100,240,112
 Mvav 164,240,176
 Mvav 44,244,48
 T 198,212,24576
 T 200,209,16384
 EX 78
 EX 79
 Mvav 108,244,112
 Mvav 36,248,56
 T 202,209,24576
 Mvav 100,248,120
 Mvav 164,248,184
 T 204,213,16384
 T 206,213,24576
 CV 22,12,13
 CV 23,14,15
 CV 84,68,69
 CV 85,70,71
 Mvav 44,252,56
 CV 86,76,77
 CV 87,78,79
 Mvav 108,252,120
 s_waitcnt lgkmcnt(5)
 Maav 0,192,20
 T 208,210,16384
 T 210,210,24576
 Maav 64,192,84
 Maav 128,192,148
 s_waitcnt lgkmcnt(4)
 Maav 16,196,20
 T 212,214,16384
 T 214,214,24576
 v_add_f32 v195, v195, v4
 v_add_f32 v196, v196, v68
 EX 164
 Maav 80,196,84
 Maav 4,200,20
 T 216,211,16384
 T 218,211,24576
 Maav 68,200,84
 Maav 132,200,148
 s_waitcnt lgkmcnt(4)
 Maav 20,204,20
 T 220,215,16384
 T 222,215,24576
 v_add_f32 v195, v195, v5
 v_add_f32 v196, v196, v69
 EX 165
 Maav 84,204,84
 Maav 8,208,20
 T 224,208,16640
 T 226,208,24832
 Maav 72,208,84
 Maav 136,208,148
 s_waitcnt lgkmcnt(4)
 T 228,212,16640
 T 230,212,24832
 v_add_f32 v195, v195, v6
 v_add_f32 v196, v196, v70
 v_add_f32 v197, v197, v133
 CV 156,164,165
 Maav 24,212,20
 Maav 88,212,84
 Maav 12,216,20
 T 232,209,16640
 T 234,209,24832
 Maav 76,216,84
 Maav 140,216,148
 s_waitcnt lgkmcnt(4)
 T 236,213,16640
 T 238,213,24832
 T 240,210,16640
 T 242,210,24832
 T 244,214,16640
 T 246,214,24832
 T 248,211,16640
 T 250,211,24832
 T 252,215,16640
 T 254,215,24832
 Maav 28,220,20
 Maav 92,220,84
 s_waitcnt lgkmcnt(12)
 Maav 32,224,20
 Maav 96,224,84
 Maav 160,224,148
 s_waitcnt lgkmcnt(10)
 Maav 48,228,20
 v_add_f32 v195, v195, v7
 v_add_f32 v196, v196, v71
 v_add_f32 v197, v197, v134
 EX 166
 Maav 112,228,84
 s_waitcnt vmcnt(8) lgkmcnt(0)
 s_barrier
 Maav 36,232,20
 Maav 100,232,84
 R 192,232,32768
 v_add_f32 v195, v195, v12
 v_add_f32 v196, v196, v76
 v_add_f32 v197, v197, v135
 EX 167
 Maav 164,232,148
 Maav 52,236,20
 Maav 116,236,84
 R 196,232,40960
 v_add_f32 v195, v195, v13
 v_add_f32 v196, v196, v77
 CV 157,166,167
 EX 36
 Maav 40,240,20
 Maav 104,240,84
 Maav 168,240,148
 Maav 56,244,20
 R 200,233,32768
 v_add_f32 v195, v195, v14
 v_add_f32 v196, v196, v78
 EX 37
 v_add_f32 v197, v197, v164
 Maav 120,244,84
 Maav 44,248,20
 Maav 108,248,84
 s_add_u32 m0, s33, 131072
 R 204,233,40960
 v_add_f32 v195, v195, v15
 v_add_f32 v196, v196, v79
 EX 38
 CV 28,36,37
 Maav 172,248,148
 Maav 60,252,20
 s_mov_b32 s32, 196608
 Maav 124,252,84
 s_waitcnt lgkmcnt(2)
 Mc 4,192,0,52
 R 208,232,33024
 buffer_load_dwordx4 v244, s[12:15], s32 offen nt lds
 buffer_load_dwordx4 v245, s[12:15], s32 offen offset:1024 nt lds
 v_add_f32 v195, v195, v36
 Mc 68,192,64,116
 Mc 132,192,128,180
 Mc 12,196,0,52
 R 212,232,41216
 buffer_load_dwordx4 v246, s[12:15], s32 offen offset:2048 nt lds
 buffer_load_dwordx4 v247, s[12:15], s32 offen offset:3072 nt lds
 v_add_f32 v195, v195, v37
 Mc 76,196,64,116
 s_waitcnt lgkmcnt(2)
 Mvav 4,200,8
 s_add_u32 m0, s33, 139264
 R 216,233,33024
 Mvav 68,200,72
 s_mov_b32 s32, 204800
 Mvav 132,200,136
 Mvav 12,204,8
 R 220,233,41216
 buffer_load_dwordx4 v244, s[12:15], s32 offen nt lds
 buffer_load_dwordx4 v245, s[12:15], s32 offen offset:1024 nt lds
 v_add_f32 v195, v195, v38
 Mvav 76,204,72
 s_waitcnt lgkmcnt(3)
 Mvav 4,208,32
 R 224,234,32768
 Mvav 68,208,96
 Mvav 132,208,160
 s_waitcnt lgkmcnt(2)
 R 228,234,40960
 buffer_load_dwordx4 v246, s[12:15], s32 offen offset:2048 nt lds
 buffer_load_dwordx4 v247, s[12:15], s32 offen offset:3072 nt lds
 v_add_f32 v197, v197, v165
 Mvav 12,212,32
 Mvav 76,212,96
 Mvav 4,216,40
 R 232,235,32768
 EX 39
 EX 44
 v_add_f32 v197, v197, v166
 Mvav 68,216,104
 Mvav 132,216,168
 s_waitcnt lgkmcnt(2)
 R 236,235,40960
 R 240,234,33024
 R 244,234,41216
 R 248,235,33024
 R 252,235,41216
 Mvav 12,220,40
 Mvav 76,220,104
 Mvav 4,224,16
 ds_write_b64 v202, v[156:157] offset:8
 Mvav 68,224,80
 Mvav 132,224,144
 s_waitcnt lgkmcnt(6)
 EX 45
 EX 46
 EX 47
 Mvav 12,228,16
 Mvav 76,228,80
 s_waitcnt lgkmcnt(0)
 s_barrier
 Mvav 4,232,24
 Mvav 68,232,88
 T 192,216,32768
 T 194,216,40960
 EX 100
 EX 101
 Mvav 132,232,152
 Mvav 12,236,24
 Mvav 76,236,88
 ds_read_b64 v[158:159], v203 offset:8
 T 196,220,32768
 EX 102
 EX 103
 Mvav 4,240,48
 Mvav 68,240,112
 Mvav 132,240,176
 Mvav 12,244,48
 T 198,220,40960
 T 200,217,32768
 EX 108
 EX 109
 Mvav 76,244,112
 Mvav 4,248,56
 T 202,217,40960
 Mvav 68,248,120
 Mvav 132,248,184
 EX 110
 EX 111
 CV 29,38,39
 T 204,221,32768
 Mvav 12,252,56
 T 206,221,40960
 CV 30,44,45
 CV 31,46,47
 CV 92,100,101
 CV 93,102,103
 CV 94,108,109
 CV 95,110,111
 Mvav 76,252,120
 s_waitcnt lgkmcnt(5)
 Maav 0,192,28
 s_add_u32 m0, s33, 147456
 T 208,218,32768
 T 210,218,40960
 Maav 64,192,92
 s_mov_b32 s32, 128
 Maav 128,192,156
 s_waitcnt lgkmcnt(4)
 Maav 16,196,28
 T 212,222,32768
 T 214,222,40960
 Maav 80,196,92
 Maav 4,200,28
 T 216,219,32768
 T 218,219,40960
 Maav 68,200,92
 Maav 132,200,156
 s_waitcnt lgkmcnt(4)
 Maav 20,204,28
 T 220,223,32768
 T 222,223,40960
 buffer_load_dwordx4 v252, s[20:23], s32 offen lds
 buffer_load_dwordx4 v253, s[20:23], s32 offen offset:1024 lds
 Maav 84,204,92
 Maav 8,208,28
 T 224,216,33024
 T 226,216,41216
 Maav 72,208,92
 Maav 136,208,156
 s_waitcnt lgkmcnt(4)
 Maav 24,212,28
 buffer_load_dwordx4 v254, s[20:23], s32 offen offset:2048 lds
 T 228,220,33024
 T 230,220,41216
 buffer_load_dwordx4 v255, s[20:23], s32 offen offset:3072 lds
 Maav 88,212,92
 Maav 12,216,28
 s_add_u32 m0, s33, 155648
 T 232,217,33024
 T 234,217,41216
 Maav 76,216,92
 s_mov_b32 s32, 14464
 Maav 140,216,156
 s_waitcnt lgkmcnt(4)
 buffer_load_dwordx4 v252, s[20:23], s32 offen lds
 T 236,221,33024
 T 238,221,41216
 T 240,218,33024
 T 242,218,41216
 T 244,222,33024
 T 246,222,41216
 T 248,219,33024
 T 250,219,41216
 T 252,223,33024
 T 254,223,41216
 Maav 28,220,28
 Maav 92,220,92
 buffer_load_dwordx4 v253, s[20:23], s32 offen offset:1024 lds
 Maav 32,224,28
 Maav 96,224,92
 buffer_load_dwordx4 v254, s[20:23], s32 offen offset:2048 lds
 Maav 160,224,156
 s_waitcnt lgkmcnt(10)
 Maav 48,228,28
 buffer_load_dwordx4 v255, s[20:23], s32 offen offset:3072 lds
 Maav 112,228,92
 s_waitcnt vmcnt(16) lgkmcnt(0)
 s_barrier
 Maav 36,232,28
 Maav 100,232,92
 Maav 164,232,156
 Maav 52,236,28
 R 192,236,0
 v_add_f32 v196, v196, v100
 v_add_f32 v195, v195, v39
 v_add_f32 v197, v197, v167
 EX 132
 Maav 116,236,92
 Maav 40,240,28
 Maav 104,240,92
 Maav 168,240,156
 R 196,236,8192
 v_add_f32 v196, v196, v101
 v_add_f32 v195, v195, v44
 EX 133
 v_add_f32 v197, v197, v132
 Maav 56,244,28
 Maav 120,244,92
 v_add_f32 v196, v196, v102
 Maav 44,248,28
 R 200,237,0
 v_add_f32 v196, v196, v103
 Maav 108,248,92
 v_add_f32 v196, v196, v108
 Maav 172,248,156
 v_add_f32 v195, v195, v45
 v_add_f32 v196, v196, v109
 Maav 60,252,28
 R 204,237,8192
 v_add_f32 v195, v195, v46
 v_add_f32 v196, v196, v110
 Maav 124,252,92
 s_waitcnt lgkmcnt(2)
 v_add_f32 v195, v195, v47
 v_add_f32 v196, v196, v111
 Mc 36,192,0,52
 R 208,236,256
 Mc 100,192,64,116
 Mc 164,192,128,180
 R 212,236,8448
 EX 134
 EX 135
 CV 148,132,133
 Mc 44,196,0,52
 Mc 108,196,64,116
 s_waitcnt lgkmcnt(3)
 Mvav 36,200,8
 R 216,237,256
 Mvav 100,200,72
 R 220,237,8448
 CV 149,134,135
 EX 4
 EX 5
 Mvav 164,200,136
 s_waitcnt lgkmcnt(3)
 Mvav 44,204,8
 Mvav 108,204,72
 Mvav 36,208,32
 R 224,238,0
 EX 6
 EX 7
 CV 20,4,5
 Mvav 100,208,96
 Mvav 164,208,160
 s_waitcnt lgkmcnt(2)
 Mvav 44,212,32
 R 228,238,8192
 EX 12
 EX 13
 CV 21,6,7
 Mvav 108,212,96
 Mvav 36,216,40
 R 232,239,0
 Mvav 100,216,104
 Mvav 164,216,168
 s_waitcnt lgkmcnt(2)
 R 236,239,8192
 R 240,238,256
 R 244,238,8448
 R 248,239,256
 R 252,239,8448
 Mvav 44,220,40
 Mvav 108,220,104
 Mvav 36,224,16
 s_add_u32 m0, s33, 32768
 ds_write_b64 v202, v[148:149]
 EX 14
 EX 15
 CV 22,12,13
 Mvav 100,224,80
 s_mov_b32 s32, 212992
 Mvav 164,224,144
 s_waitcnt lgkmcnt(6)
 Mvav 44,228,16
 Mvav 108,228,80
 s_waitcnt lgkmcnt(0)
 s_barrier
 buffer_load_dwordx4 v244, s[12:15], s32 offen nt lds
 T 192,216,49152
 T 194,216,57344
 buffer_load_dwordx4 v245, s[12:15], s32 offen offset:1024 nt lds
 Mvav 36,232,24
 Mvav 100,232,88
 Mvav 164,232,152
 Mvav 44,236,24
 ds_read_b64 v[150:151], v203
 buffer_load_dwordx4 v246, s[12:15], s32 offen offset:2048 nt lds
 T 196,220,49152
 buffer_load_dwordx4 v247, s[12:15], s32 offen offset:3072 nt lds
 Mvav 108,236,88
 Mvav 36,240,48
 s_add_u32 m0, s33, 40960
 Mvav 100,240,112
 s_mov_b32 s32, 221184
 T 198,220,57344
 T 200,217,49152
 buffer_load_dwordx4 v244, s[12:15], s32 offen nt lds
 EX 68
 Mvav 164,240,176
 Mvav 44,244,48
 Mvav 108,244,112
 Mvav 36,248,56
 T 202,217,57344
 EX 69
 EX 70
 CV 23,14,15
 Mvav 100,248,120
 Mvav 164,248,184
 EX 71
 EX 76
 EX 77
 EX 78
 EX 79
 Mvav 44,252,56
 T 204,221,49152
 T 206,221,57344
 CV 84,68,69
 CV 85,70,71
 CV 86,76,77
 CV 87,78,79
 Mvav 108,252,120
 s_waitcnt lgkmcnt(3)
 buffer_load_dwordx4 v245, s[12:15], s32 offen offset:1024 nt lds
 Maav 0,192,20
 T 208,218,49152
 T 210,218,57344
 Maav 64,192,84
 buffer_load_dwordx4 v246, s[12:15], s32 offen offset:2048 nt lds
 Maav 128,192,148
 Maav 16,196,20
 buffer_load_dwordx4 v247, s[12:15], s32 offen offset:3072 nt lds
 T 212,222,49152
 T 214,222,57344
 Maav 80,196,84
 s_waitcnt lgkmcnt(6)
 Maav 4,200,20
 T 216,219,49152
 T 218,219,57344
 Maav 68,200,84
 Maav 132,200,148
 s_waitcnt lgkmcnt(4)
 Maav 20,204,20
 T 220,223,49152
 T 222,223,57344
 Maav 84,204,84
 Maav 8,208,20
 T 224,216,49408
 T 226,216,57600
 Maav 72,208,84
 Maav 136,208,148
 s_waitcnt lgkmcnt(4)
 Maav 24,212,20
 T 228,220,49408
 T 230,220,57600
 Maav 88,212,84
 Maav 12,216,20
 T 232,217,49408
 T 234,217,57600
 Maav 76,216,84
 Maav 140,216,148
 s_waitcnt lgkmcnt(4)
 T 236,221,49408
 T 238,221,57600
 T 240,218,49408
 T 242,218,57600
 T 244,222,49408
 T 246,222,57600
 T 248,219,49408
 T 250,219,57600
 T 252,223,49408
 T 254,223,57600
 Maav 28,220,20
 Maav 92,220,84
 Maav 32,224,20
 Maav 96,224,84
 Maav 160,224,148
 s_waitcnt lgkmcnt(10)
 Maav 48,228,20
 Maav 112,228,84
 s_waitcnt vmcnt(16) lgkmcnt(0)
 s_barrier
 Maav 36,232,20
 R 192,240,0
 v_add_f32 v195, v195, v4
 v_add_f32 v196, v196, v68
 v_add_f32 v197, v197, v133
 EX 164
 Maav 100,232,84
 Maav 164,232,148
 Maav 52,236,20
 Maav 116,236,84
 R 196,240,8192
 v_add_f32 v195, v195, v5
 v_add_f32 v196, v196, v69
 v_add_f32 v197, v197, v134
 EX 165
 Maav 40,240,20
 Maav 104,240,84
 Maav 168,240,148
 v_add_f32 v195, v195, v6
 v_add_f32 v196, v196, v70
 R 200,241,0
 v_add_f32 v197, v197, v135
 EX 166
 Maav 56,244,20
 Maav 120,244,84
 Maav 44,248,20
 v_add_f32 v195, v195, v7
 v_add_f32 v196, v196, v71
 Maav 108,248,84
 v_add_f32 v195, v195, v12
 v_add_f32 v196, v196, v76
 Maav 172,248,148
 v_add_f32 v195, v195, v13
 v_add_f32 v196, v196, v77
 Maav 60,252,20
 R 204,241,8192
 v_add_f32 v195, v195, v14
 v_add_f32 v196, v196, v78
 Maav 124,252,84
 s_waitcnt lgkmcnt(1)
 v_add_f32 v195, v195, v15
 v_add_f32 v196, v196, v79
 Mc 4,192,0,52
 R 208,240,256
 Mc 68,192,64,116
 Mc 132,192,128,180
 Mc 12,196,0,52
 R 212,240,8448
 EX 167
 CV 156,164,165
 EX 36
 Mc 76,196,64,116
 Mvav 4,200,8
 R 216,241,256
 Mvav 68,200,72
 Mvav 132,200,136
 s_waitcnt lgkmcnt(2)
 R 220,241,8448
 CV 157,166,167
 EX 37
 EX 38
 Mvav 12,204,8
 Mvav 76,204,72
 Mvav 4,208,32
 R 224,242,0
 EX 39
 EX 44
 CV 28,36,37
 Mvav 68,208,96
 Mvav 132,208,160
 s_waitcnt lgkmcnt(2)
 Mvav 12,212,32
 R 228,242,8192
 Mvav 76,212,96
 Mvav 4,216,40
 R 232,243,0
 EX 45
 EX 46
 CV 29,38,39
 Mvav 68,216,104
 Mvav 132,216,168
 s_waitcnt lgkmcnt(2)
 R 236,243,8192
 R 240,242,256
 R 244,242,8448
 R 248,243,256
 R 252,243,8448
 Mvav 12,220,40
 Mvav 76,220,104
 Mvav 4,224,16
 ds_write_b64 v202, v[156:157] offset:8
 Mvav 68,224,80
 Mvav 132,224,144
 s_waitcnt lgkmcnt(6)
 EX 47
 EX 100
 EX 101
 Mvav 12,228,16
 Mvav 76,228,80
 s_waitcnt lgkmcnt(0)
 s_barrier
 Mvav 4,232,24
 T 192,208,16384
 T 194,208,24576
 EX 102
 EX 103
 Mvav 68,232,88
 Mvav 132,232,152
 Mvav 12,236,24
 Mvav 76,236,88
 ds_read_b64 v[158:159], v203 offset:8
 T 196,212,16384
 EX 108
 EX 109
 Mvav 4,240,48
 Mvav 68,240,112
 Mvav 132,240,176
 T 198,212,24576
 T 200,209,16384
 EX 110
 EX 111
 Mvav 12,244,48
 Mvav 76,244,112
 Mvav 4,248,56
 T 202,209,24576
 Mvav 68,248,120
 T 204,213,16384
 T 206,213,24576
 CV 30,44,45
 CV 31,46,47
 CV 92,100,101
 CV 93,102,103
 Mvav 132,248,184
 Mvav 12,252,56
 CV 94,108,109
 CV 95,110,111
 Mvav 76,252,120
 s_waitcnt lgkmcnt(3)
 Maav 0,192,28
 T 208,210,16384
 T 210,210,24576
 Maav 64,192,92
 Maav 128,192,156
 T 212,214,16384
 T 214,214,24576
 v_add_f32 v195, v195, v36
 v_add_f32 v196, v196, v100
 v_add_f32 v197, v197, v164
 Maav 16,196,28
 Maav 80,196,92
 s_waitcnt lgkmcnt(4)
 Maav 4,200,28
 s_add_u32 m0, s33, 114688
 T 216,211,16384
 T 218,211,24576
 v_add_f32 v195, v195, v37
 v_add_f32 v196, v196, v101
 EX 132
 Maav 68,200,92
 s_mov_b32 s32, 229376
 Maav 132,200,156
 Maav 20,204,28
 T 220,215,16384
 T 222,215,24576
 Maav 84,204,92
 s_waitcnt lgkmcnt(4)
 Maav 8,208,28
 T 224,208,16640
 T 226,208,24832
 buffer_load_dwordx4 v244, s[12:15], s32 offen nt lds
 buffer_load_dwordx4 v245, s[12:15], s32 offen offset:1024 nt lds
 Maav 72,208,92
 Maav 136,208,156
 Maav 24,212,28
 T 228,212,16640
 T 230,212,24832
 buffer_load_dwordx4 v246, s[12:15], s32 offen offset:2048 nt lds
 buffer_load_dwordx4 v247, s[12:15], s32 offen offset:3072 nt lds
 Maav 88,212,92
 s_waitcnt lgkmcnt(6)
 Maav 12,216,28
 s_add_u32 m0, s33, 122880
 T 232,209,16640
 T 234,209,24832
 Maav 76,216,92
 s_mov_b32 s32, 237568
 Maav 140,216,156
 s_waitcnt lgkmcnt(4)
 T 236,213,16640
 T 238,213,24832
 T 240,210,16640
 T 242,210,24832
 T 244,214,16640
 T 246,214,24832
 T 248,211,16640
 T 250,211,24832
 T 252,215,16640
 T 254,215,24832
 Maav 28,220,28
 Maav 92,220,92
 Maav 32,224,28
 Maav 96,224,92
 buffer_load_dwordx4 v244, s[12:15], s32 offen nt lds
 Maav 160,224,156
 s_waitcnt lgkmcnt(10)
 Maav 48,228,28
 buffer_load_dwordx4 v245, s[12:15], s32 offen offset:1024 nt lds
 Maav 112,228,92
 s_waitcnt vmcnt(6) lgkmcnt(0)
 s_barrier
 Maav 36,232,28
 buffer_load_dwordx4 v246, s[12:15], s32 offen offset:2048 nt lds
 Maav 100,232,92
 Maav 164,232,156
 buffer_load_dwordx4 v247, s[12:15], s32 offen offset:3072 nt lds
 Maav 52,236,28
 Maav 116,236,92
 R 192,232,32768
 v_add_f32 v195, v195, v38
 v_add_f32 v196, v196, v102
 v_add_f32 v197, v197, v165
 EX 133
 Maav 40,240,28
 Maav 104,240,92
 Maav 168,240,156
 R 196,232,40960
 v_add_f32 v195, v195, v39
 v_add_f32 v196, v196, v103
 v_add_f32 v197, v197, v166
 EX 134
 Maav 56,244,28
 Maav 120,244,92
 Maav 44,248,28
 R 200,233,32768
 Maav 108,248,92
 v_add_f32 v195, v195, v44
 v_add_f32 v196, v196, v108
 R 204,233,40960
 v_add_f32 v197, v197, v167
 EX 135
 Maav 172,248,156
 v_add_f32 v195, v195, v45
 v_add_f32 v196, v196, v109
 Maav 60,252,28
 v_add_f32 v195, v195, v46
 v_add_f32 v196, v196, v110
 Maav 124,252,92
 s_waitcnt lgkmcnt(2)
 v_add_f32 v195, v195, v47
 v_add_f32 v196, v196, v111
 Mc 36,192,0,52
 R 208,232,33024
 Mc 100,192,64,116
 Mc 164,192,128,180
 Mc 44,196,0,52
 R 212,232,41216
 Mc 108,196,64,116
 s_waitcnt lgkmcnt(2)
 Mvav 36,200,8
 R 216,233,33024
 CV 148,132,133
 CV 149,134,135
 EX 4
 v_add_f32 v197, v197, v132
 Mvav 100,200,72
 Mvav 164,200,136
 Mvav 44,204,8
 R 220,233,41216
 EX 5
 EX 6
 v_add_f32 v195, v195, v4
 Mvav 108,204,72
 s_waitcnt lgkmcnt(3)
 Mvav 36,208,32
 R 224,234,32768
 Mvav 100,208,96
 Mvav 164,208,160
 s_waitcnt lgkmcnt(2)
 R 228,234,40960
 EX 7
 EX 12
 CV 20,4,5
 Mvav 44,212,32
 Mvav 108,212,96
 Mvav 36,216,40
 R 232,235,32768
 Mvav 100,216,104
 R 236,235,40960
 EX 13
 EX 14
 CV 21,6,7
 Mvav 164,216,168
 s_waitcnt lgkmcnt(3)
 R 240,234,33024
 R 244,234,41216
 R 248,235,33024
 R 252,235,41216
 Mvav 44,220,40
 Mvav 108,220,104
 Mvav 36,224,16
 ds_write_b64 v202, v[148:149]
 Mvav 100,224,80
 Mvav 164,224,144
 s_waitcnt lgkmcnt(6)
 Mvav 44,228,16
 EX 15
 EX 68
 EX 69
 Mvav 108,228,80
 s_waitcnt lgkmcnt(0)
 s_barrier
 Mvav 36,232,24
 Mvav 100,232,88
 T 192,216,32768
 T 194,216,40960
 EX 70
 EX 71
 Mvav 164,232,152
 Mvav 44,236,24
 Mvav 108,236,88
 Mvav 36,240,48
 ds_read_b64 v[150:151], v203
 T 196,220,32768
 EX 76
 EX 77
 Mvav 100,240,112
 Mvav 164,240,176
 Mvav 44,244,48
 T 198,220,40960
 T 200,217,32768
 EX 78
 EX 79
 Mvav 108,244,112
 Mvav 36,248,56
 T 202,217,40960
 Mvav 100,248,120
 Mvav 164,248,184
 Mvav 44,252,56
 T 204,221,32768
 T 206,221,40960
 CV 22,12,13
 CV 23,14,15
 CV 84,68,69
 CV 85,70,71
 CV 86,76,77
 CV 87,78,79
 Mvav 108,252,120
 s_waitcnt lgkmcnt(5)
 Maav 0,192,20
 T 208,218,32768
 T 210,218,40960
 Maav 64,192,84
 Maav 128,192,148
 s_waitcnt lgkmcnt(4)
 Maav 16,196,20
 T 212,222,32768
 T 214,222,40960
 v_add_f32 v196, v196, v68
 v_add_f32 v195, v195, v5
 buffer_load_ubyte v200, v207, s[88:91], 0 offen sc1
 Maav 80,196,84
 Maav 4,200,20
 T 216,219,32768
 T 218,219,40960
 Maav 68,200,84
 Maav 132,200,148
 s_waitcnt lgkmcnt(4)
 Maav 20,204,20
 T 220,223,32768
 T 222,223,40960
 v_add_f32 v196, v196, v69
 v_add_f32 v195, v195, v6
 EX 164
 Maav 84,204,84
 Maav 8,208,20
 T 224,216,33024
 T 226,216,41216
 Maav 72,208,84
 Maav 136,208,148
 s_waitcnt lgkmcnt(4)
 Maav 24,212,20
 T 228,220,33024
 T 230,220,41216
 v_add_f32 v196, v196, v70
 v_add_f32 v195, v195, v7
 EX 165
 Maav 88,212,84
 Maav 12,216,20
 T 232,217,33024
 T 234,217,41216
 Maav 76,216,84
 Maav 140,216,148
 s_waitcnt lgkmcnt(4)
 T 236,221,33024
 T 238,221,41216
 T 240,218,33024
 T 242,218,41216
 T 244,222,33024
 T 246,222,41216
 T 248,219,33024
 T 250,219,41216
 T 252,223,33024
 T 254,223,41216
 Maav 28,220,20
 Maav 92,220,84
 Maav 32,224,20
 Maav 96,224,84
 Maav 160,224,148
 s_waitcnt lgkmcnt(10)
 Maav 48,228,20
 v_add_f32 v196, v196, v71
 v_add_f32 v195, v195, v12
 v_add_f32 v197, v197, v133
 EX 166
 CV 156,164,165
 Maav 112,228,84
 s_waitcnt vmcnt(1) lgkmcnt(0)
 s_barrier
 Maav 36,232,20
 s_add_u32 m0, s33, 16384
 Maav 100,232,84
 s_mov_b32 s32, 245760
 Maav 164,232,148
 R 192,236,49152
 buffer_load_dwordx4 v244, s[12:15], s32 offen nt lds
 buffer_load_dwordx4 v245, s[12:15], s32 offen offset:1024 nt lds
 v_add_f32 v196, v196, v76
 Maav 52,236,20
 Maav 116,236,84
 Maav 40,240,20
 R 196,236,57344
 buffer_load_dwordx4 v246, s[12:15], s32 offen offset:2048 nt lds
 v_add_f32 v195, v195, v13
 v_add_f32 v196, v196, v77
 v_add_f32 v197, v197, v134
 Maav 104,240,84
 Maav 168,240,148
 Maav 56,244,20
 Maav 120,244,84
 R 200,237,49152
 v_add_f32 v195, v195, v14
 v_add_f32 v196, v196, v78
 buffer_load_dwordx4 v247, s[12:15], s32 offen offset:3072 nt lds
 v_add_f32 v197, v197, v135
 Maav 44,248,20
 s_add_u32 m0, s33, 24576
 Maav 108,248,84
 s_mov_b32 s32, 253952
 Maav 172,248,148
 Maav 60,252,20
 R 204,237,57344
 v_add_f32 v195, v195, v15
 v_add_f32 v196, v196, v79
 buffer_load_dwordx4 v244, s[12:15], s32 offen nt lds
 v_add_f32 v197, v197, v164
 Maav 124,252,84
 s_waitcnt lgkmcnt(2)
 Mc 4,192,0,52
 R 208,236,49408
 Mc 68,192,64,116
 Mc 132,192,128,180
 buffer_load_dwordx4 v245, s[12:15], s32 offen offset:1024 nt lds
 R 212,236,57600
 buffer_load_dwordx4 v246, s[12:15], s32 offen offset:2048 nt lds
 v_lshrrev_b32 v249, 6, v204
 Mc 12,196,0,52
 Mc 76,196,64,116
 s_waitcnt lgkmcnt(3)
 Mvav 4,200,8
 R 216,237,49408
 buffer_load_dwordx4 v247, s[12:15], s32 offen offset:3072 nt lds
 EX 167
 v_mul_u32_u24 v249, 896, v249
 Mvav 68,200,72
 Mvav 132,200,136
 s_waitcnt lgkmcnt(2)
 Mvav 12,204,8
 R 220,237,57600
 Mvav 76,204,72
 R 224,238,49152
 CV 157,166,167
 EX 36
 EX 37
 Mvav 4,208,32
 Mvav 68,208,96
 Mvav 132,208,160
 s_waitcnt lgkmcnt(2)
 Mvav 12,212,32
 R 228,238,57344
 EX 38
 EX 39
 CV 28,36,37
 Mvav 76,212,96
 Mvav 4,216,40
 R 232,239,49152
 Mvav 68,216,104
 Mvav 132,216,168
 s_waitcnt lgkmcnt(2)
 R 236,239,57344
 R 240,238,49408
 R 244,238,57600
 R 248,239,49408
 R 252,239,57600
 Mvav 12,220,40
 Mvav 76,220,104
 Mvav 4,224,16
 ds_write_b64 v202, v[156:157] offset:8
 EX 44
 EX 45
 CV 29,38,39
 Mvav 68,224,80
 Mvav 132,224,144
 s_waitcnt lgkmcnt(6)
 Mvav 12,228,16
 EX 46
 EX 47
 EX 100
 Mvav 76,228,80
 s_waitcnt lgkmcnt(0)
 s_barrier
 Mvav 4,232,24
 Mvav 68,232,88
 Mvav 132,232,152
 T 192,224,0
 T 194,224,8192
 EX 101
 EX 102
 Mvav 12,236,24
 Mvav 76,236,88
 Mvav 4,240,48
 ds_read_b64 v[158:159], v203 offset:8
 T 196,228,0
 EX 103
 EX 108
 Mvav 68,240,112
 Mvav 132,240,176
 Mvav 12,244,48
 T 198,228,8192
 Mvav 76,244,112
 Mvav 4,248,56
 T 200,225,0
 T 202,225,8192
 EX 109
 EX 110
 Mvav 68,248,120
 Mvav 132,248,184
 EX 111
 Mvav 12,252,56
 T 204,229,0
 T 206,229,8192
 CV 30,44,45
 CV 31,46,47
 CV 92,100,101
 CV 93,102,103
 CV 94,108,109
 CV 95,110,111
 Mvav 76,252,120
 s_waitcnt lgkmcnt(5)
 v_and_b32 v250, 48, v204
 v_lshl_add_u32 v249, v250, 3, v249
 s_lshl_b32 s66, s44, 14
 s_add_u32 s66, s66, s33
 s_lshr_b32 s66, s66, 9
 s_mul_i32 s66, s66, 896
 s_mov_b32 s69, s66
 Maav 0,192,28
 T 208,226,0
 T 210,226,8192
 Maav 64,192,92
 Maav 128,192,156
 s_waitcnt lgkmcnt(4)
 Maav 16,196,28
 T 212,230,0
 T 214,230,8192
 Maav 80,196,92
 Maav 4,200,28
 T 216,227,0
 T 218,227,8192
 Maav 68,200,92
 Maav 132,200,156
 s_waitcnt lgkmcnt(4)
 Maav 20,204,28
 T 220,231,0
 T 222,231,8192
 Maav 84,204,92
 Maav 8,208,28
 T 224,224,256
 T 226,224,8448
 v_add_f32 v195, v195, v36
 v_add_f32 v196, v196, v100
 buffer_load_dword v251, v249, s[20:23], s69 offen offset:384
 Maav 72,208,92
 Maav 136,208,156
 s_waitcnt lgkmcnt(4)
 Maav 24,212,28
 T 228,228,256
 T 230,228,8448
 v_add_f32 v195, v195, v37
 v_add_f32 v196, v196, v101
 EX 132
 Maav 88,212,92
 Maav 12,216,28
 T 232,225,256
 T 234,225,8448
 Maav 76,216,92
 Maav 140,216,156
 s_waitcnt lgkmcnt(4)
 T 236,229,256
 T 238,229,8448
 T 240,226,256
 T 242,226,8448
 T 244,230,256
 T 246,230,8448
 T 248,227,256
 T 250,227,8448
 T 252,231,256
 T 254,231,8448
 Maav 28,220,28
 Maav 92,220,92
 Maav 32,224,28
 Maav 96,224,92
 Maav 160,224,156
 s_waitcnt lgkmcnt(10)
 Maav 48,228,28
 Maav 112,228,92
 s_waitcnt vmcnt(1) lgkmcnt(0)
 s_barrier
 R 192,232,16384
 v_add_f32 v195, v195, v38
 v_add_f32 v196, v196, v102
 v_add_f32 v197, v197, v165
 EX 133
 Maav 36,232,28
 Maav 100,232,92
 Maav 164,232,156
 Maav 52,236,28
 R 196,232,24576
 v_add_f32 v195, v195, v39
 v_add_f32 v196, v196, v103
 v_add_f32 v197, v197, v166
 EX 134
 Maav 116,236,92
 Maav 40,240,28
 Maav 104,240,92
 R 200,233,16384
 v_add_f32 v195, v195, v44
 v_add_f32 v196, v196, v108
 v_add_f32 v197, v197, v167
 EX 135
 Maav 168,240,156
 Maav 56,244,28
 Maav 120,244,92
 Maav 44,248,28
 v_add_f32 v195, v195, v45
 v_add_f32 v196, v196, v109
 R 204,233,24576
 CV 148,132,133
 CV 149,134,135
 v_add_f32 v197, v197, v132
 Maav 108,248,92
 Maav 172,248,156
 Maav 60,252,28
 v_add_f32 v195, v195, v46
 v_add_f32 v196, v196, v110
 R 208,232,16640
 EX 4
 v_add_f32 v197, v197, v133
 Maav 124,252,92
 s_waitcnt lgkmcnt(2)
 v_add_f32 v195, v195, v47
 v_add_f32 v196, v196, v111
 Mc 36,192,0,52
 Mc 100,192,64,116
 Mc 164,192,128,180
 Mc 44,196,0,52
 R 212,232,24832
 EX 5
 EX 6
 v_cmp_eq_u32 vcc, 1, v200
 Mc 108,196,64,116
 Mvav 36,200,8
 s_mov_b32 s43, vcc_lo
 R 216,233,16640
 Mvav 100,200,72
 Mvav 164,200,136
 s_waitcnt lgkmcnt(2)
 R 220,233,24832
 EX 7
 EX 12
 CV 20,4,5
 Mvav 44,204,8
 Mvav 108,204,72
 Mvav 36,208,32
 R 224,234,16384
 EX 13
 EX 14
 CV 21,6,7
 Mvav 100,208,96
 Mvav 164,208,160
 s_waitcnt lgkmcnt(2)
 Mvav 44,212,32
 R 228,234,24576
 Mvav 108,212,96
 Mvav 36,216,40
 s_add_u32 m0, s33, 114688
 R 232,235,16384
 EX 15
 EX 68
 CV 22,12,13
 Mvav 100,216,104
 s_mov_b32 s32, 256
 Mvav 164,216,168
 s_waitcnt lgkmcnt(2)
 R 236,235,24576
 R 240,234,16640
 R 244,234,24832
 R 248,235,16640
 R 252,235,24832
 Mvav 44,220,40
 Mvav 108,220,104
 Mvav 36,224,16
 ds_write_b64 v202, v[148:149]
 Mvav 100,224,80
 Mvav 164,224,144
 s_waitcnt lgkmcnt(6)
 buffer_load_dwordx4 v252, s[20:23], s32 offen lds
 buffer_load_dwordx4 v253, s[20:23], s32 offen offset:1024 lds
 buffer_load_dwordx4 v254, s[20:23], s32 offen offset:2048 lds
 Mvav 44,228,16
 Mvav 108,228,80
 s_waitcnt lgkmcnt(0)
 s_barrier
 Mvav 36,232,24
 buffer_load_dwordx4 v255, s[20:23], s32 offen offset:3072 lds
 T 192,208,32768
 T 194,208,40960
 EX 69
 Mvav 100,232,88
 s_add_u32 m0, s33, 122880
 Mvav 164,232,152
 Mvav 44,236,24
 s_mov_b32 s32, 14592
 Mvav 108,236,88
 ds_read_b64 v[150:151], v203
 buffer_load_dwordx4 v252, s[20:23], s32 offen lds
 buffer_load_dwordx4 v253, s[20:23], s32 offen offset:1024 lds
 T 196,212,32768
 Mvav 36,240,48
 Mvav 100,240,112
 Mvav 164,240,176
 T 198,212,40960
 buffer_load_dwordx4 v254, s[20:23], s32 offen offset:2048 lds
 T 200,209,32768
 buffer_load_dwordx4 v255, s[20:23], s32 offen offset:3072 lds
 Mvav 44,244,48
 Mvav 108,244,112
 Mvav 36,248,56
 T 202,209,40960
 Mvav 100,248,120
 EX 70
 EX 71
 EX 76
 Mvav 164,248,184
 EX 77
 EX 78
 EX 79
 Mvav 44,252,56
 T 204,213,32768
 T 206,213,40960
 CV 23,14,15
 CV 84,68,69
 CV 85,70,71
 CV 86,76,77
 CV 87,78,79
 Mvav 108,252,120
 s_waitcnt lgkmcnt(3)
 Maav 0,192,20
 T 208,210,32768
 T 210,210,40960
 Maav 64,192,84
 T 212,214,32768
 T 214,214,40960
 Maav 128,192,148
 T 216,211,32768
 T 218,211,40960
 Maav 16,196,20
 T 220,215,32768
 T 222,215,40960
 Maav 80,196,84
 s_waitcnt lgkmcnt(10)
 T 224,208,33024
 T 226,208,41216
 Maav 4,200,20
 T 228,212,33024
 T 230,212,41216
 Maav 68,200,84
 T 232,209,33024
 s_waitcnt lgkmcnt(14)
 T 234,209,41216
 Maav 132,200,148
 s_waitcnt lgkmcnt(12)
 T 236,213,33024
 T 238,213,41216
 Maav 20,204,20
 T 240,210,33024
 s_waitcnt lgkmcnt(14)
 T 242,210,41216
 Maav 84,204,84
 s_waitcnt lgkmcnt(12)
 EX 164
 Maav 8,208,20
 T 244,214,33024
 T 246,214,41216
 Maav 72,208,84
 EX 165
 Maav 136,208,148
 s_waitcnt lgkmcnt(8)
 T 248,211,33024
 T 250,211,41216
 Maav 24,212,20
 EX 166
 Maav 88,212,84
 T 252,215,33024
 T 254,215,41216
 Maav 12,216,20
 EX 167
 Maav 76,216,84
 CV 156,164,165
 CV 157,166,167
 Maav 140,216,148
 s_waitcnt lgkmcnt(4)
 ds_write_b64 v202, v[156:157] offset:8
 v_add_f32 v195, v195, v4
 Maav 28,220,20
 v_add_f32 v196, v196, v68
 v_add_f32 v195, v195, v5
 Maav 92,220,84
 v_add_f32 v196, v196, v69
 v_add_f32 v195, v195, v6
 Maav 32,224,20
 v_add_f32 v196, v196, v70
 v_add_f32 v195, v195, v7
 Maav 96,224,84
 v_add_f32 v196, v196, v71
 v_add_f32 v195, v195, v12
 Maav 160,224,148
 v_add_f32 v196, v196, v76
 v_add_f32 v195, v195, v13
 Maav 48,228,20
 v_add_f32 v196, v196, v77
 v_add_f32 v197, v197, v134
 Maav 112,228,84
 s_waitcnt lgkmcnt(0)
 s_barrier
 T 192,216,32768
 Maav 36,232,20
 T 194,216,40960
 ds_read_b64 v[158:159], v203 offset:8
 Maav 100,232,84
 T 196,217,32768
 T 198,217,40960
 Maav 164,232,148
 EX 36
 Maav 52,236,20
 T 200,218,32768
 T 202,218,40960
 Maav 116,236,84
 EX 37
 Maav 40,240,20
 EX 38
 Maav 104,240,84
 EX 39
 Maav 168,240,148
 EX 44
 Maav 56,244,20
 EX 45
 Maav 120,244,84
 EX 46
 Maav 44,248,20
 s_add_u32 m0, s33, 16384
 EX 47
 Maav 108,248,84
 s_mov_b32 s32, 384
 EX 100
 Maav 172,248,148
 EX 101
 EX 102
 EX 103
 EX 108
 EX 109
 EX 110
 EX 111
 Maav 60,252,20
 v_add_f32 v195, v195, v14
 v_add_f32 v196, v196, v78
 CV 28,36,37
 CV 29,38,39
 CV 30,44,45
 CV 31,46,47
 CV 92,100,101
 CV 93,102,103
 CV 94,108,109
 CV 95,110,111
 Maav 124,252,84
 s_waitcnt lgkmcnt(0)
 T 204,219,32768
 T 206,219,40960
 v_add_f32 v197, v197, v135
 v_add_f32 v195, v195, v15
 v_add_f32 v196, v196, v79
 Maav 0,192,28
 T 208,216,33024
 T 210,216,41216
 Maav 64,192,92
 buffer_load_dwordx4 v252, s[20:23], s32 offen lds
 Maav 128,192,156
 buffer_load_dwordx4 v253, s[20:23], s32 offen offset:1024 lds
 Maav 4,196,28
 T 212,217,33024
 T 214,217,41216
 Maav 68,196,92
 buffer_load_dwordx4 v254, s[20:23], s32 offen offset:2048 lds
 Maav 132,196,156
 T 216,218,33024
 T 218,218,41216
 Maav 8,200,28
 buffer_load_dwordx4 v255, s[20:23], s32 offen offset:3072 lds
 Maav 72,200,92
 s_add_u32 m0, s33, 24576
 T 220,219,33024
 T 222,219,41216
 Maav 136,200,156
 s_waitcnt lgkmcnt(6)
 s_mov_b32 s32, 14720
 T 224,220,32768
 Maav 12,204,28
 buffer_load_dwordx4 v252, s[20:23], s32 offen lds
 Maav 76,204,92
 buffer_load_dwordx4 v253, s[20:23], s32 offen offset:1024 lds
 Maav 140,204,156
 T 226,220,40960
 T 228,221,32768
 Maav 32,208,28
 buffer_load_dwordx4 v254, s[20:23], s32 offen offset:2048 lds
 Maav 96,208,92
 T 230,221,40960
 T 232,222,32768
 Maav 160,208,156
 s_waitcnt lgkmcnt(5)
 buffer_load_dwordx4 v255, s[20:23], s32 offen offset:3072 lds
 Maav 36,212,28
 T 234,222,40960
 T 236,223,32768
 Maav 100,212,92
 T 238,223,40960
 T 240,220,33024
 Maav 164,212,156
 T 242,220,41216
 T 244,221,33024
 Maav 40,216,28
 T 246,221,41216
 T 248,222,33024
 Maav 104,216,92
 T 250,222,41216
 T 252,223,33024
 Maav 168,216,156
 s_waitcnt lgkmcnt(10)
 T 254,223,41216
 v_add_f32 v195, v195, v36
 Maav 44,220,28
 v_add_f32 v196, v196, v100
 v_add_f32 v195, v195, v37
 Maav 108,220,92
 v_add_f32 v196, v196, v101
 v_add_f32 v195, v195, v38
 Maav 172,220,156
 s_waitcnt lgkmcnt(7)
 v_add_f32 v196, v196, v102
 v_add_f32 v195, v195, v39
 Maav 16,224,28
 v_add_f32 v196, v196, v103
 v_add_f32 v197, v197, v164
 Maav 80,224,92
 v_add_f32 v195, v195, v44
 v_add_f32 v196, v196, v108
 Maav 20,228,28
 v_add_f32 v197, v197, v165
 v_add_f32 v195, v195, v45
 Maav 84,228,92
 s_waitcnt lgkmcnt(0)
 s_barrier
 T 192,208,0
 Maav 24,232,28
 T 194,208,8192
 v_add_f32 v196, v196, v109
 Maav 88,232,92
 T 196,210,0
 T 198,210,8192
 Maav 28,236,28
 v_add_f32 v197, v197, v166
 v_add_f32 v195, v195, v46
 Maav 92,236,92
 T 200,209,0
 T 202,209,8192
 Maav 48,240,28
 v_add_f32 v196, v196, v110
 AR 232,0
 Maav 112,240,92
 T 204,211,0
 T 206,211,8192
 Maav 52,244,28
 AR 233,1
 CV 0,232,233
 Maav 116,244,92
 AR 234,2
 AR 235,3
 Maav 56,248,28
 CV 1,234,235
 AR 236,4
 Maav 120,248,92
 AR 237,5
 CV 2,236,237
 Maav 60,252,28
 AR 238,6
 AR 239,7
 CV 3,238,239
 AR 240,64
 AR 241,65
 CV 64,240,241
 AR 242,66
 AR 243,67
 CV 65,242,243
 AR 232,68
 AR 233,69
 CV 66,232,233
 AR 234,70
 AR 235,71
 CV 67,234,235
 AR 236,128
 AR 237,129
 CV 128,236,237
 AR 238,130
 AR 239,131
 CV 129,238,239
 AR 240,132
 AR 241,133
 CV 130,240,241
 AR 242,134
 AR 243,135
 CV 131,242,243
 Maav 124,252,92
 s_waitcnt lgkmcnt(2)
 v_add_f32 v197, v197, v167
 v_add_f32 v195, v195, v47
 v_add_f32 v196, v196, v111
 Mvavz 4,192,0
 T 208,212,0
 T 210,212,8192
 Mvavz 68,192,64
 T 212,214,0
 T 214,214,8192
 Mvavz 132,192,128
 AR 232,136
 AR 233,137
 Mvavz 36,196,0
 CV 136,232,233
 AR 234,138
 Mvavz 100,196,64
 AR 235,139
 CV 137,234,235
 AR 236,140
 AR 237,141
 CV 138,236,237
 AR 238,142
 AR 239,143
 CV 139,238,239
 AR 240,160
 AR 241,161
 CV 160,240,241
 AR 242,162
 AR 243,163
 CV 161,242,243
 AR 232,164
 AR 233,165
 CV 162,232,233
 AR 234,166
 AR 235,167
 CV 163,234,235
 AR 236,168
 AR 237,169
 CV 168,236,237
 AR 238,170
 AR 239,171
 CV 169,238,239
 AR 240,172
 AR 241,173
 CV 170,240,241
 AR 242,174
 AR 243,175
 CV 171,242,243
 Mvavz 12,200,0
 T 216,213,0
 T 218,213,8192
 Mvavz 76,200,64
 ds_write_b128 v202, v[128:131]
 ds_write_b128 v202, v[136:139] offset:1024
 ds_write_b128 v202, v[160:163] offset:2048
 ds_write_b128 v202, v[168:171] offset:3072
 Mvavz 140,200,128
 s_waitcnt lgkmcnt(8)
 T 220,215,0
 T 222,215,8192
 Mvavz 44,204,0
 AR 232,8
 AR 233,9
 CV 8,232,233
 AR 234,10
 AR 235,11
 CV 9,234,235
 AR 236,12
 AR 237,13
 CV 10,236,237
 AR 238,14
 AR 239,15
 CV 11,238,239
 AR 240,72
 AR 241,73
 CV 72,240,241
 AR 242,74
 AR 243,75
 CV 73,242,243
 AR 232,76
 AR 233,77
 CV 74,232,233
 AR 234,78
 AR 235,79
 CV 75,234,235
 Mvavz 108,204,64
 s_waitcnt lgkmcnt(0)
 s_barrier
 T 224,208,256
 Mvav 4,208,8
 T 226,208,8448
 ds_read_b128 v[144:147], v203
 Mvav 68,208,72
 T 228,210,256
 T 230,210,8448
 Mvav 132,208,136
 T 232,209,256
 T 234,209,8448
 Mvav 36,212,8
 T 236,211,256
 T 238,211,8448
 Mvav 100,212,72
 T 240,212,256
 T 242,212,8448
 Mvav 12,216,8
 s_add_u32 m0, s33, 98304
 T 244,214,256
 T 246,214,8448
 Mvav 76,216,72
 s_mov_b32 s32, 512
 T 248,213,256
 T 250,213,8448
 Mvav 140,216,136
 s_waitcnt lgkmcnt(12)
 T 252,215,256
 T 254,215,8448
 Mvav 44,220,8
 AR 236,16
 AR 237,17
 CV 16,236,237
 AR 238,18
 AR 239,19
 CV 17,238,239
 AR 240,20
 AR 241,21
 CV 18,240,241
 AR 242,22
 AR 243,23
 CV 19,242,243
 AR 232,80
 AR 233,81
 CV 80,232,233
 AR 234,82
 AR 235,83
 CV 81,234,235
 AR 236,84
 AR 237,85
 CV 82,236,237
 AR 238,86
 AR 239,87
 CV 83,238,239
 Mvav 108,220,72
 s_waitcnt lgkmcnt(10)
 ds_read_b128 v[152:155], v203 offset:1024
 AR 240,24
 Mvav 4,224,16
 ds_read_b128 v[176:179], v203 offset:2048
 AR 241,25
 Mvav 68,224,80
 ds_read_b128 v[184:187], v203 offset:3072
 CV 24,240,241
 Mvav 132,224,144
 s_waitcnt lgkmcnt(7)
 buffer_load_dwordx4 v252, s[20:23], s32 offen lds
 Mvav 36,228,16
 buffer_load_dwordx4 v253, s[20:23], s32 offen offset:1024 lds
 Mvav 100,228,80
 s_waitcnt lgkmcnt(0)
 s_barrier
 AR 242,26
 Mvav 12,232,16
 buffer_load_dwordx4 v254, s[20:23], s32 offen offset:2048 lds
 Mvav 76,232,80
 AR 243,27
 CV 25,242,243
 Mvav 140,232,144
 AR 232,28
 AR 233,29
 Mvav 44,236,16
 CV 26,232,233
 AR 234,30
 AR 235,31
 CV 27,234,235
 AR 236,88
 AR 237,89
 CV 88,236,237
 AR 238,90
 AR 239,91
 CV 89,238,239
 AR 240,92
 AR 241,93
 CV 90,240,241
 AR 242,94
 AR 243,95
 CV 91,242,243
 Mvav 108,236,80
 buffer_load_dwordx4 v255, s[20:23], s32 offen offset:3072 lds
 Mvav 4,240,24
 s_add_u32 m0, s33, 106496
 T 192,208,49152
 T 194,208,57344
 Mvav 68,240,88
 s_mov_b32 s32, 14848
 buffer_load_dwordx4 v252, s[20:23], s32 offen lds
 Mvav 132,240,152
 buffer_load_dwordx4 v253, s[20:23], s32 offen offset:1024 lds
 Mvav 36,244,24
 T 196,210,49152
 T 198,210,57344
 Mvav 100,244,88
 buffer_load_dwordx4 v254, s[20:23], s32 offen offset:2048 lds
 Mvav 12,248,24
 T 200,209,49152
 T 202,209,57344
 Mvav 76,248,88
 buffer_load_dwordx4 v255, s[20:23], s32 offen offset:3072 lds
 Mvav 140,248,152
 T 204,211,49152
 T 206,211,57344
 Mvav 44,252,24
 AR 232,32
 AR 233,33
 CV 32,232,233
 AR 234,34
 AR 235,35
 CV 33,234,235
 AR 236,36
 AR 237,37
 CV 34,236,237
 AR 238,38
 AR 239,39
 CV 35,238,239
 AR 240,96
 AR 241,97
 CV 96,240,241
 AR 242,98
 AR 243,99
 CV 97,242,243
 AR 232,100
 AR 233,101
 CV 98,232,233
 AR 234,102
 AR 235,103
 CV 99,234,235
 Mvav 108,252,88
 s_waitcnt lgkmcnt(6)
 T 208,212,49152
 T 210,212,57344
 Mvav 4,192,32
 T 212,214,49152
 T 214,214,57344
 Mvav 68,192,96
 T 216,213,49152
 T 218,213,57344
 Mvav 132,192,160
 s_waitcnt lgkmcnt(8)
 T 220,215,49152
 T 222,215,57344
 Mvav 36,196,32
 AR 236,40
 AR 237,41
 Mvav 100,196,96
 CV 40,236,237
 AR 238,42
 Mvav 12,200,32
 AR 239,43
 CV 41,238,239
 Mvav 76,200,96
 AR 240,44
 AR 241,45
 Mvav 140,200,160
 s_waitcnt lgkmcnt(4)
 CV 42,240,241
 AR 242,46
 Mvav 44,204,32
 AR 243,47
 CV 43,242,243
 AR 232,104
 AR 233,105
 CV 104,232,233
 AR 234,106
 AR 235,107
 CV 105,234,235
 AR 236,108
 AR 237,109
 CV 106,236,237
 AR 238,110
 AR 239,111
 CV 107,238,239
 Mvav 108,204,96
 T 224,208,49408
 T 226,208,57600
 Mvav 4,208,40
 T 228,210,49408
 T 230,210,57600
 Mvav 68,208,104
 T 232,209,49408
 T 234,209,57600
 Mvav 132,208,168
 T 236,211,49408
 T 238,211,57600
 Mvav 36,212,40
 T 240,212,49408
 T 242,212,57600
 Mvav 100,212,104
 s_waitcnt lgkmcnt(10)
 T 244,214,49408
 T 246,214,57600
 Mvav 12,216,40
 T 248,213,49408
 T 250,213,57600
 Mvav 76,216,104
 T 252,215,49408
 s_waitcnt lgkmcnt(14)
 T 254,215,57600
 Mvav 140,216,168
 s_waitcnt lgkmcnt(12)
 AR 240,48
 AR 241,49
 Mvav 44,220,40
 CV 48,240,241
 AR 242,50
 AR 243,51
 CV 49,242,243
 AR 232,52
 AR 233,53
 CV 50,232,233
 AR 234,54
 AR 235,55
 CV 51,234,235
 AR 236,112
 AR 237,113
 CV 112,236,237
 AR 238,114
 AR 239,115
 CV 113,238,239
 AR 240,116
 AR 241,117
 CV 114,240,241
 AR 242,118
 AR 243,119
 CV 115,242,243
 Mvav 108,220,104
 s_waitcnt lgkmcnt(8)
 v_max3_f32 v198, v195, v196, v197
 v_cmp_ngt_f32 vcc, s36, v198
 v_mov_b32 v200, v197
 s_cmp_lg_u64 vcc, 0
 s_cselect_b32 s45, s37, 0
 v_mov_b32 v201, s45
 ds_write_b64 v202, v[200:201]
 v_and_b32 v199, 48, v204
 v_lshlrev_b32 v199, 8, v199
 v_add_u32 v199, 81920, v199
 Mvav 4,224,48
 AR 232,56
 AR 233,57
 Mvav 68,224,112
 CV 56,232,233
 AR 234,58
 Mvav 132,224,176
 AR 235,59
 CV 57,234,235
 Mvav 36,228,48
 AR 236,60
 AR 237,61
 Mvav 100,228,112
 s_waitcnt lgkmcnt(0)
 s_barrier
 ds_read_b32 v198, v203
 Mvav 12,232,48
 ds_read_b32 v199, v199 offset:4
 CV 58,236,237
 Mvav 76,232,112
 AR 238,62
 AR 239,63
 Mvav 140,232,176
 CV 59,238,239
 AR 240,120
 Mvav 44,236,48
 AR 241,121
 CV 120,240,241
 AR 242,122
 AR 243,123
 CV 121,242,243
 AR 232,124
 AR 233,125
 CV 122,232,233
 AR 234,126
 AR 235,127
 CV 123,234,235
 Mvav 108,236,112
 T 192,224,16384
 T 194,224,24576
 Mvav 4,240,56
 T 196,226,16384
 T 198,226,24576
 Mvav 68,240,120
 T 200,225,16384
 T 202,225,24576
 Mvav 132,240,184
 T 204,227,16384
 T 206,227,24576
 Mvav 36,244,56
 T 208,228,16384
 T 210,228,24576
 Mvav 100,244,120
 s_waitcnt lgkmcnt(10)
 T 212,230,16384
 T 214,230,24576
 Mvav 12,248,56
 s_add_u32 m0, s33, 49152
 v_add_f32 v197, v197, v198
 v_mov_b32 v192, v195
 Mvav 76,248,120
 s_mov_b32 s32, 640
 buffer_load_dwordx4 v252, s[20:23], s32 offen lds
 Mvav 140,248,184
 s_waitcnt lgkmcnt(8)
 buffer_load_dwordx4 v253, s[20:23], s32 offen offset:1024 lds
 Mvav 44,252,56
 T 216,229,16384
 T 218,229,24576
 Mvav 108,252,120
 buffer_load_dwordx4 v254, s[20:23], s32 offen offset:2048 lds
 Mvavz 20,192,0
 v_mov_b32 v193, v196
 v_mov_b32 v194, v197
 Mvavz 84,192,64
 T 220,231,16384
 T 222,231,24576
 Mvavz 148,192,128
 s_waitcnt lgkmcnt(4)
 v_permlane16_swap_b32 v195, v192
 v_add_f32 v195, v195, v192
 Mvavz 52,196,0
 s_add_u32 s40, s68, 0
 v_mov_b32 v192, v195
 v_permlane16_swap_b32 v196, v193
 Mvavz 116,196,64
 v_add_f32 v196, v196, v193
 v_mov_b32 v193, v196
 Mvavz 28,200,0
 v_permlane16_swap_b32 v197, v194
 v_add_f32 v197, v197, v194
 Mvavz 92,200,64
 v_mov_b32 v194, v197
 v_cmp_ne_u32 vcc, 0, v199
 Mvavz 156,200,128
 buffer_load_dwordx4 v255, s[20:23], s32 offen offset:3072 lds
 Mvavz 60,204,0
 s_cbranch_vccnz L_restart
 v_permlane32_swap_b32 v195, v192
 v_add_f32 v195, v195, v192
 Mvavz 124,204,64
 v_permlane32_swap_b32 v196, v193
 v_add_f32 v196, v196, v193
 v_permlane32_swap_b32 v197, v194
 v_add_f32 v197, v197, v194
 v_rcp_f32 v195, v195
 v_rcp_f32 v196, v196
 v_rcp_f32 v197, v197
 Mvav 20,208,8
 s_add_u32 m0, s33, 57344
 T 224,224,16640
 T 226,224,24832
 Mvav 84,208,72
 s_mov_b32 s32, 14976
 buffer_load_dwordx4 v252, s[20:23], s32 offen lds
 Mvav 148,208,136
 buffer_load_dwordx4 v253, s[20:23], s32 offen offset:1024 lds
 Mvav 52,212,8
 T 228,226,16640
 T 230,226,24832
 Mvav 116,212,72
 s_waitcnt lgkmcnt(4)
 buffer_load_dwordx4 v254, s[20:23], s32 offen offset:2048 lds
 Mvav 28,216,8
 T 232,225,16640
 T 234,225,24832
 Mvav 92,216,72
 buffer_load_dwordx4 v255, s[20:23], s32 offen offset:3072 lds
 Mvav 156,216,136
 T 236,227,16640
 T 238,227,24832
 T 240,228,16640
 T 242,228,24832
 T 244,230,16640
 T 246,230,24832
 T 248,229,16640
 T 250,229,24832
 T 252,231,16640
 s_waitcnt lgkmcnt(14)
 T 254,231,24832
 Mvav 60,220,8
 v_mul_f32 v4, v4, v195
 v_mul_f32 v5, v5, v195
 Mvav 124,220,72
 s_waitcnt lgkmcnt(14)
 v_mul_f32 v6, v6, v195
 v_mul_f32 v7, v7, v195
 Mvav 20,224,16
 v_mul_f32 v12, v12, v195
 v_mul_f32 v13, v13, v195
 Mvav 84,224,80
 v_mul_f32 v14, v14, v195
 v_mul_f32 v15, v15, v195
 Mvav 148,224,144
 s_waitcnt lgkmcnt(10)
 CV 4,4,5
 CV 5,6,7
 Mvav 52,228,16
 CV 6,12,13
 CV 7,14,15
 s_cmp_eq_u32 s78, 0
 s_cselect_b32 s79, 0x10000000, s40
 s_cbranch_scc1 LE0_k00
LE0_k00b:
 buffer_store_dwordx4 v[4:7], v204, s[24:27], s79 offen sc1
 Mvav 116,228,80
 s_waitcnt lgkmcnt(0)
 s_barrier
 T 192,216,0
 Mvav 28,232,16
 T 194,216,8192
 v_mul_f32 v36, v36, v195
 Mvav 92,232,80
 T 196,218,0
 T 198,218,8192
 Mvav 156,232,144
 v_mul_f32 v37, v37, v195
 v_mul_f32 v38, v38, v195
 Mvav 60,236,16
 T 200,217,0
 T 202,217,8192
 Mvav 124,236,80
 v_mul_f32 v39, v39, v195
 v_mul_f32 v44, v44, v195
 Mvav 20,240,24
 v_mul_f32 v45, v45, v195
 v_mul_f32 v46, v46, v195
 Mvav 84,240,88
 v_mul_f32 v47, v47, v195
 CV 36,36,37
 Mvav 148,240,152
 CV 37,38,39
 CV 38,44,45
 Mvav 52,244,24
 CV 39,46,47
 T 204,219,0
 Mvav 116,244,88
 s_cmp_eq_u32 s78, 1
 s_cselect_b32 s79, 0x10000000, s40
 s_cbranch_scc1 LE0_k01
LE0_k01b:
 T 206,219,8192
 Mvav 28,248,24
 buffer_store_dwordx4 v[36:39], v204, s[24:27], s79 offen offset:1024 sc1
 Mvav 92,248,88
 T 208,220,0
 T 210,220,8192
 Mvav 156,248,152
 T 212,222,0
 T 214,222,8192
 Mvav 60,252,24
 T 216,221,0
 T 218,221,8192
 Mvav 124,252,88
 s_waitcnt lgkmcnt(8)
 T 220,223,0
 T 222,223,8192
 Mvav 20,192,32
 s_lshl_b32 s66, s39, 3
 T 224,216,256
 T 226,216,8448
 Mvav 84,192,96
 s_add_u32 s66, s66, s44
 v_mul_f32 v68, v68, v196
 v_mul_f32 v69, v69, v196
 Mvav 148,192,160
 s_waitcnt lgkmcnt(10)
 v_mul_f32 v70, v70, v196
 v_mul_f32 v71, v71, v196
 Mvav 52,196,32
 s_mul_i32 s66, s66, 2293760
 v_mul_f32 v76, v76, v196
 v_mul_f32 v77, v77, v196
 Mvav 116,196,96
 v_mul_f32 v78, v78, v196
 v_mul_f32 v79, v79, v196
 Mvav 28,200,32
 s_add_u32 s12, s58, s66
 s_addc_u32 s13, s59, 0
 CV 68,68,69
 CV 69,70,71
 Mvav 92,200,96
 s_mov_b32 s14, 2293760
 CV 70,76,77
 CV 71,78,79
 Mvav 156,200,160
 T 228,218,256
 T 230,218,8448
 Mvav 60,204,32
 s_cmp_eq_u32 s78, 2
 s_cselect_b32 s79, 0x10000000, s40
 s_cbranch_scc1 LE0_k02
LE0_k02b:
 buffer_store_dwordx4 v[68:71], v204, s[24:27], s79 offen offset:2048 sc1
 Mvav 124,204,96
 s_waitcnt lgkmcnt(2)
 T 232,217,256
 T 234,217,8448
 Mvav 20,208,40
 s_mov_b32 s16, s92
 T 236,219,256
 T 238,219,8448
 Mvav 84,208,104
 s_mov_b32 s17, s93
 T 240,220,256
 T 242,220,8448
 Mvav 148,208,168
 T 244,222,256
 T 246,222,8448
 Mvav 52,212,40
 s_mov_b32 s18, 2293760
 T 248,221,256
 T 250,221,8448
 Mvav 116,212,104
 s_waitcnt lgkmcnt(10)
 T 252,223,256
 T 254,223,8448
 Mvav 28,216,40
 s_mov_b32 s19, 0x00020000
 v_mul_f32 v100, v100, v196
 v_mul_f32 v101, v101, v196
 Mvav 92,216,104
 v_mul_f32 v102, v102, v196
 v_mul_f32 v103, v103, v196
 Mvav 156,216,168
 s_waitcnt lgkmcnt(8)
 v_mul_f32 v108, v108, v196
 v_mul_f32 v109, v109, v196
 Mvav 60,220,40
 v_mul_f32 v110, v110, v196
 v_mul_f32 v111, v111, v196
 Mvav 124,220,104
 CV 100,100,101
 CV 101,102,103
 Mvav 20,224,48
 CV 102,108,109
 CV 103,110,111
 Mvav 84,224,112
 s_cmp_eq_u32 s78, 3
 s_cselect_b32 s79, 0x10000000, s40
 s_cbranch_scc1 LE0_k03
LE0_k03b:
 buffer_store_dwordx4 v[100:103], v204, s[24:27], s79 offen offset:3072 sc1
 Mvav 148,224,176
 v_mul_f32 v132, v132, v197
 v_mul_f32 v133, v133, v197
 Mvav 52,228,48
 s_add_u32 s40, s68, 4096
 v_mul_f32 v134, v134, v197
 v_mul_f32 v135, v135, v197
 Mvav 116,228,112
 s_waitcnt vmcnt(28) lgkmcnt(0)
 s_barrier
 T 192,216,49152
 Mvav 28,232,48
 s_add_u32 m0, s33, 65536
 T 194,216,57344
 v_mul_f32 v140, v140, v197
 Mvav 92,232,112
 s_mov_b32 s32, 768
 buffer_load_dwordx4 v252, s[20:23], s32 offen lds
 Mvav 156,232,176
 T 196,218,49152
 T 198,218,57344
 Mvav 60,236,48
 buffer_load_dwordx4 v253, s[20:23], s32 offen offset:1024 lds
 Mvav 124,236,112
 T 200,217,49152
 T 202,217,57344
 Mvav 20,240,56
 buffer_load_dwordx4 v254, s[20:23], s32 offen offset:2048 lds
 Mvav 84,240,120
 T 204,219,49152
 T 206,219,57344
 Mvav 148,240,184
 buffer_load_dwordx4 v255, s[20:23], s32 offen offset:3072 lds
 Mvav 52,244,56
 s_add_u32 m0, s33, 73728
 v_mul_f32 v141, v141, v197
 v_mul_f32 v142, v142, v197
 Mvav 116,244,120
 v_mul_f32 v143, v143, v197
 CV 132,132,133
 Mvav 28,248,56
 s_mov_b32 s32, 15104
 CV 133,134,135
 CV 134,140,141
 Mvav 92,248,120
 CV 135,142,143
 s_cmp_eq_u32 s78, 4
 s_cselect_b32 s79, 0x10000000, s40
 s_cbranch_scc1 LE0_k04
LE0_k04b:
 Mvav 156,248,184
 buffer_store_dwordx4 v[132:135], v204, s[24:27], s79 offen sc1
 Mvav 60,252,56
 T 208,220,49152
 T 210,220,57344
 Mvav 124,252,120
 s_waitcnt lgkmcnt(2)
 buffer_load_dwordx4 v252, s[20:23], s32 offen lds
 Mvavz 4,192,0
 buffer_load_dwordx4 v253, s[20:23], s32 offen offset:1024 lds
 Mvavz 68,192,64
 T 212,222,49152
 T 214,222,57344
 Mvavz 132,192,128
 buffer_load_dwordx4 v254, s[20:23], s32 offen offset:2048 lds
 Mvavz 36,196,0
 s_add_u32 s40, s68, 20480
 T 216,221,49152
 T 218,221,57344
 Mvavz 100,196,64
 buffer_load_dwordx4 v255, s[20:23], s32 offen offset:3072 lds
 Mvavz 12,200,0
 T 220,223,49152
 T 222,223,57344
 Mvavz 76,200,64
 T 224,216,49408
 T 226,216,57600
 Mvavz 140,200,128
 T 228,218,49408
 T 230,218,57600
 Mvavz 44,204,0
 T 232,217,49408
 T 234,217,57600
 Mvavz 108,204,64
 s_waitcnt lgkmcnt(10)
 T 236,219,49408
 T 238,219,57600
 Mvav 4,208,8
 T 240,220,49408
 T 242,220,57600
 Mvav 68,208,72
 T 244,222,49408
 s_waitcnt lgkmcnt(14)
 T 246,222,57600
 Mvav 132,208,136
 s_waitcnt lgkmcnt(12)
 T 248,221,49408
 T 250,221,57600
 Mvav 36,212,8
 v_mul_f32 v20, v20, v195
 v_mul_f32 v21, v21, v195
 Mvav 100,212,72
 s_waitcnt lgkmcnt(10)
 T 252,223,49408
 T 254,223,57600
 Mvav 12,216,8
 v_mul_f32 v22, v22, v195
 v_mul_f32 v23, v23, v195
 Mvav 76,216,72
 v_mul_f32 v28, v28, v195
 v_mul_f32 v29, v29, v195
 Mvav 140,216,136
 s_waitcnt lgkmcnt(6)
 v_mul_f32 v30, v30, v195
 v_mul_f32 v31, v31, v195
 Mvav 44,220,8
 CV 20,20,21
 CV 21,22,23
 Mvav 108,220,72
 CV 22,28,29
 CV 23,30,31
 Mvav 4,224,16
 s_cmp_eq_u32 s78, 5
 s_cselect_b32 s79, 0x10000000, s40
 s_cbranch_scc1 LE0_k10
LE0_k10b:
 buffer_store_dwordx4 v[20:23], v204, s[24:27], s79 offen sc1
 Mvav 68,224,80
 v_mul_f32 v52, v52, v195
 v_mul_f32 v53, v53, v195
 Mvav 132,224,144
 v_mul_f32 v54, v54, v195
 v_mul_f32 v55, v55, v195
 Mvav 36,228,16
 v_mul_f32 v60, v60, v195
 v_mul_f32 v61, v61, v195
 Mvav 100,228,80
 s_waitcnt lgkmcnt(0)
 s_barrier
 T 192,224,0
 Mvav 12,232,16
 T 194,224,8192
 v_mul_f32 v62, v62, v195
 Mvav 76,232,80
 T 196,226,0
 T 198,226,8192
 Mvav 140,232,144
 v_mul_f32 v63, v63, v195
 CV 52,52,53
 Mvav 44,236,16
 T 200,225,0
 T 202,225,8192
 Mvav 108,236,80
 CV 53,54,55
 CV 54,60,61
 Mvav 4,240,24
 CV 55,62,63
 T 204,227,0
 Mvav 68,240,88
 s_cmp_eq_u32 s78, 6
 s_cselect_b32 s79, 0x10000000, s40
 s_cbranch_scc1 LE0_k11
LE0_k11b:
 buffer_store_dwordx4 v[52:55], v204, s[24:27], s79 offen offset:1024 sc1
 Mvav 132,240,152
 T 206,227,8192
 T 208,228,0
 Mvav 36,244,24
 T 210,228,8192
 v_mul_f32 v84, v84, v196
 Mvav 100,244,88
 T 212,230,0
 T 214,230,8192
 Mvav 12,248,24
 v_mul_f32 v85, v85, v196
 v_mul_f32 v86, v86, v196
 Mvav 76,248,88
 T 216,229,0
 T 218,229,8192
 Mvav 140,248,152
 s_waitcnt lgkmcnt(7)
 v_mul_f32 v87, v87, v196
 v_mul_f32 v92, v92, v196
 Mvav 44,252,24
 T 220,231,0
 T 222,231,8192
 Mvav 108,252,88
 v_mul_f32 v93, v93, v196
 v_mul_f32 v94, v94, v196
 Mvav 4,192,32
 T 224,224,256
 T 226,224,8448
 Mvav 68,192,96
 v_mul_f32 v95, v95, v196
 CV 84,84,85
 Mvav 132,192,160
 s_waitcnt lgkmcnt(6)
 CV 85,86,87
 CV 86,92,93
 Mvav 36,196,32
 CV 87,94,95
 T 228,226,256
 Mvav 100,196,96
 T 230,226,8448
 T 232,225,256
 Mvav 12,200,32
 s_cmp_eq_u32 s78, 7
 s_cselect_b32 s79, 0x10000000, s40
 s_cbranch_scc1 LE0_k12
LE0_k12b:
 buffer_store_dwordx4 v[84:87], v204, s[24:27], s79 offen offset:2048 sc1
 Mvav 76,200,96
 T 234,225,8448
 T 236,227,256
 Mvav 140,200,160
 s_waitcnt lgkmcnt(5)
 T 238,227,8448
 v_mul_f32 v116, v116, v196
 Mvav 44,204,32
 T 240,228,256
 T 242,228,8448
 Mvav 108,204,96
 v_mul_f32 v117, v117, v196
 v_mul_f32 v118, v118, v196
 Mvav 4,208,40
 T 244,230,256
 T 246,230,8448
 Mvav 68,208,104
 v_mul_f32 v119, v119, v196
 v_mul_f32 v124, v124, v196
 Mvav 132,208,168
 T 248,229,256
 T 250,229,8448
 Mvav 36,212,40
 v_mul_f32 v125, v125, v196
 v_mul_f32 v126, v126, v196
 Mvav 100,212,104
 s_waitcnt lgkmcnt(6)
 T 252,231,256
 T 254,231,8448
 Mvav 12,216,40
 v_mul_f32 v127, v127, v196
 CV 116,116,117
 Mvav 76,216,104
 CV 117,118,119
 CV 118,124,125
 Mvav 140,216,168
 CV 119,126,127
 v_mul_f32 v148, v148, v197
 Mvav 44,220,40
 s_cmp_eq_u32 s78, 8
 s_cselect_b32 s79, 0x10000000, s40
 s_cbranch_scc1 LE0_k13
LE0_k13b:
 buffer_store_dwordx4 v[116:119], v204, s[24:27], s79 offen offset:3072 sc1
 Mvav 108,220,104
 v_mul_f32 v149, v149, v197
 v_mul_f32 v150, v150, v197
 Mvav 4,224,48
 s_add_u32 s40, s68, 24576
 v_mul_f32 v151, v151, v197
 v_mul_f32 v156, v156, v197
 Mvav 68,224,112
 v_mul_f32 v157, v157, v197
 v_mul_f32 v158, v158, v197
 Mvav 132,224,176
 v_mul_f32 v159, v159, v197
 CV 148,148,149
 Mvav 36,228,48
 CV 149,150,151
 CV 150,156,157
 Mvav 100,228,112
 s_waitcnt vmcnt(33) lgkmcnt(0)
 s_barrier
 T 192,208,16384
 Mvav 12,232,48
 T 194,208,24576
 CV 151,158,159
 Mvav 76,232,112
 s_cmp_eq_u32 s78, 9
 s_cselect_b32 s79, 0x10000000, s40
 s_cbranch_scc1 LE0_k14
LE0_k14b:
 T 196,210,16384
 T 198,210,24576
 Mvav 140,232,176
 buffer_store_dwordx4 v[148:151], v204, s[24:27], s79 offen sc1
 Mvav 44,236,48
 T 200,209,16384
 T 202,209,24576
 Mvav 108,236,112
 v_lshlrev_b32 v241, 4, v204
 v_bfe_u32 v238, v207, 2, 2
 Mvav 4,240,56
 T 204,211,16384
 T 206,211,24576
 Mvav 68,240,120
 v_lshrrev_b32 v239, 4, v207
 v_cmp_eq_u32 vcc, v238, v239
 Mvav 132,240,184
 T 208,212,16384
 T 210,212,24576
 Mvav 36,244,56
 v_and_b32 v238, 1, v207
 v_lshlrev_b32 v238, 4, v238
 Mvav 100,244,120
 T 212,214,16384
 T 214,214,24576
 Mvav 12,248,56
 v_mov_b32 v239, 0x3f80
 v_lshlrev_b32 v238, v238, v239
 Mvav 76,248,120
 T 216,213,16384
 T 218,213,24576
 Mvav 140,248,184
 s_waitcnt lgkmcnt(6)
 v_cndmask_b32 v238, 0, v238, vcc
 v_and_b32 v239, 2, v207
 Mvav 44,252,56
 T 220,215,16384
 T 222,215,24576
 Mvav 108,252,120
 v_cmp_eq_u32 vcc, 0, v239
 v_mov_b32 v232, 0
 Mvavz 20,192,0
 T 224,208,16640
 T 226,208,24832
 Mvavz 84,192,64
 v_mov_b32 v233, 0
 v_mov_b32 v236, 0
 Mvavz 148,192,128
 T 228,210,16640
 T 230,210,24832
 Mvavz 52,196,0
 s_add_u32 s40, s68, 40960
 v_mul_f32 v4, v4, v195
 v_mul_f32 v5, v5, v195
 Mvavz 116,196,64
 s_waitcnt lgkmcnt(6)
 T 232,209,16640
 T 234,209,24832
 Mvavz 28,200,0
 v_mul_f32 v6, v6, v195
 v_mul_f32 v7, v7, v195
 Mvavz 92,200,64
 T 236,211,16640
 T 238,211,24832
 Mvavz 156,200,128
 v_mul_f32 v12, v12, v195
 v_mul_f32 v13, v13, v195
 Mvavz 60,204,0
 T 240,212,16640
 T 242,212,24832
 Mvavz 124,204,64
 s_waitcnt lgkmcnt(6)
 v_mul_f32 v14, v14, v195
 v_mul_f32 v15, v15, v195
 Mvav 20,208,8
 T 244,214,16640
 T 246,214,24832
 Mvav 84,208,72
 CV 4,4,5
 CV 5,6,7
 Mvav 148,208,136
 T 248,213,16640
 T 250,213,24832
 Mvav 52,212,8
 CV 6,12,13
 CV 7,14,15
 Mvav 116,212,72
 T 252,215,16640
 T 254,215,24832
 Mvav 28,216,8
 s_cmp_eq_u32 s78, 10
 s_cselect_b32 s79, 0x10000000, s40
 s_cbranch_scc1 LE0_k20
LE0_k20b:
 buffer_store_dwordx4 v[4:7], v204, s[24:27], s79 offen sc1
 Mvav 92,216,72
 v_mul_f32 v36, v36, v195
 v_mul_f32 v37, v37, v195
 Mvav 156,216,136
 s_waitcnt lgkmcnt(4)
 v_mul_f32 v38, v38, v195
 v_mul_f32 v39, v39, v195
 Mvav 60,220,8
 v_mul_f32 v44, v44, v195
 v_mul_f32 v45, v45, v195
 Mvav 124,220,72
 v_mul_f32 v46, v46, v195
 v_mul_f32 v47, v47, v195
 Mvav 20,224,16
 CV 36,36,37
 CV 37,38,39
 Mvav 84,224,80
 CV 38,44,45
 CV 39,46,47
 Mvav 148,224,144
 v_mul_f32 v68, v68, v196
 v_mul_f32 v69, v69, v196
 Mvav 52,228,16
 s_cmp_eq_u32 s78, 11
 s_cselect_b32 s79, 0x10000000, s40
 s_cbranch_scc1 LE0_k21
LE0_k21b:
 buffer_store_dwordx4 v[36:39], v204, s[24:27], s79 offen offset:1024 sc1
 Mvav 116,228,80
 s_waitcnt lgkmcnt(0)
 s_barrier
 T 192,208,32768
 Mvav 28,232,16
 T 194,208,40960
 v_mul_f32 v70, v70, v196
 Mvav 92,232,80
 T 196,210,32768
 T 198,210,40960
 Mvav 156,232,144
 v_mul_f32 v71, v71, v196
 v_mul_f32 v76, v76, v196
 Mvav 60,236,16
 T 200,209,32768
 T 202,209,40960
 Mvav 124,236,80
 v_mul_f32 v77, v77, v196
 v_mul_f32 v78, v78, v196
 Mvav 20,240,24
 T 204,211,32768
 T 206,211,40960
 Mvav 84,240,88
 v_mul_f32 v79, v79, v196
 CV 68,68,69
 Mvav 148,240,152
 T 208,212,32768
 T 210,212,40960
 Mvav 52,244,24
 CV 69,70,71
 CV 70,76,77
 Mvav 116,244,88
 T 212,214,32768
 T 214,214,40960
 Mvav 28,248,24
 CV 71,78,79
 v_mul_f32 v100, v100, v196
 Mvav 92,248,88
 s_cmp_eq_u32 s78, 12
 s_cselect_b32 s79, 0x10000000, s40
 s_cbranch_scc1 LE0_k22
LE0_k22b:
 T 216,213,32768
 T 218,213,40960
 Mvav 156,248,152
 s_waitcnt lgkmcnt(6)
 buffer_store_dwordx4 v[68:71], v204, s[24:27], s79 offen offset:2048 sc1
 Mvav 60,252,24
 T 220,215,32768
 T 222,215,40960
 Mvav 124,252,88
 v_mul_f32 v101, v101, v196
 v_mul_f32 v102, v102, v196
 Mvav 20,192,32
 T 224,208,33024
 T 226,208,41216
 Mvav 84,192,96
 v_mul_f32 v103, v103, v196
 v_mul_f32 v108, v108, v196
 Mvav 148,192,160
 T 228,210,33024
 T 230,210,41216
 Mvav 52,196,32
 v_mul_f32 v109, v109, v196
 v_mul_f32 v110, v110, v196
 Mvav 116,196,96
 s_waitcnt lgkmcnt(6)
 T 232,209,33024
 T 234,209,41216
 Mvav 28,200,32
 v_mul_f32 v111, v111, v196
 CV 100,100,101
 Mvav 92,200,96
 T 236,211,33024
 T 238,211,41216
 Mvav 156,200,160
 CV 101,102,103
 CV 102,108,109
 Mvav 60,204,32
 T 240,212,33024
 T 242,212,41216
 Mvav 124,204,96
 s_waitcnt lgkmcnt(6)
 CV 103,110,111
 v_mov_b32 v237, 0
 Mvav 20,208,40
 s_cmp_eq_u32 s78, 13
 s_cselect_b32 s79, 0x10000000, s40
 s_cbranch_scc1 LE0_k23
LE0_k23b:
 T 244,214,33024
 T 246,214,41216
 Mvav 84,208,104
 buffer_store_dwordx4 v[100:103], v204, s[24:27], s79 offen offset:3072 sc1
 Mvav 148,208,168
 T 248,213,33024
 T 250,213,41216
 Mvav 52,212,40
 s_add_u32 s40, s68, 45056
 v_cndmask_b32 v234, 0, v238, vcc
 v_sub_u32 v235, v238, v234
 Mvav 116,212,104
 T 252,215,33024
 T 254,215,41216
 Mvav 28,216,40
 v_and_b32 v238, 15, v207
 v_mul_u32_u24 v240, 1792, v238
 Mvav 92,216,104
 v_bfe_u32 v238, v207, 4, 1
 v_lshl_add_u32 v240, v238, 5, v240
 Mvav 156,216,168
 s_waitcnt lgkmcnt(4)
 v_lshrrev_b32 v238, 5, v207
 v_lshl_add_u32 v240, v238, 4, v240
 Mvav 60,220,40
 v_mov_b32 v242, 1
 v_mul_f32 v132, v132, v197
 Mvav 124,220,104
 v_mul_f32 v133, v133, v197
 v_mul_f32 v134, v134, v197
 Mvav 20,224,48
 v_mul_f32 v135, v135, v197
 v_mul_f32 v140, v140, v197
 Mvav 84,224,112
 v_mul_f32 v141, v141, v197
 v_mul_f32 v142, v142, v197
 Mvav 148,224,176
 v_mul_f32 v143, v143, v197
 CV 132,132,133
 Mvav 52,228,48
 CV 133,134,135
 CV 134,140,141
 Mvav 116,228,112
 s_waitcnt vmcnt(30) lgkmcnt(0)
 s_barrier
 T 192,216,32768
 Mvav 28,232,48
 T 194,216,40960
 CV 135,142,143
 Mvav 92,232,112
 s_cmp_eq_u32 s78, 14
 s_cselect_b32 s79, 0x10000000, s40
 s_cbranch_scc1 LE0_k24
LE0_k24b:
 T 196,218,32768
 T 198,218,40960
 Mvav 156,232,176
 buffer_store_dwordx4 v[132:135], v204, s[24:27], s79 offen sc1
 Mvav 60,236,48
 T 200,217,32768
 T 202,217,40960
 Mvav 124,236,112
 Mvav 20,240,56
 T 204,219,32768
 T 206,219,40960
 Mvav 84,240,120
 Mvav 148,240,184
 T 208,220,32768
 T 210,220,40960
 Mvav 52,244,56
 Mvav 116,244,120
 T 212,222,32768
 T 214,222,40960
 Mvav 28,248,56
 Mvav 92,248,120
 T 216,221,32768
 T 218,221,40960
 Mvav 156,248,184
 s_waitcnt lgkmcnt(6)
 Mvav 60,252,56
 T 220,223,32768
 T 222,223,40960
 Mvav 124,252,120
 Mvavz 4,192,0
 T 224,216,33024
 T 226,216,41216
 Mvavz 68,192,64
 Mvavz 132,192,128
 T 228,218,33024
 T 230,218,41216
 Mvavz 36,196,0
 s_add_u32 s40, s68, 61440
 v_mul_f32 v20, v20, v195
 v_mul_f32 v21, v21, v195
 Mvavz 100,196,64
 s_waitcnt lgkmcnt(6)
 T 232,217,33024
 T 234,217,41216
 Mvavz 12,200,0
 v_mul_f32 v22, v22, v195
 v_mul_f32 v23, v23, v195
 Mvavz 76,200,64
 T 236,219,33024
 T 238,219,41216
 Mvavz 140,200,128
 v_mul_f32 v28, v28, v195
 v_mul_f32 v29, v29, v195
 Mvavz 44,204,0
 T 240,220,33024
 T 242,220,41216
 Mvavz 108,204,64
 s_waitcnt lgkmcnt(6)
 v_mul_f32 v30, v30, v195
 v_mul_f32 v31, v31, v195
 Mvav 4,208,8
 T 244,222,33024
 T 246,222,41216
 Mvav 68,208,72
 CV 20,20,21
 CV 21,22,23
 Mvav 132,208,136
 T 248,221,33024
 T 250,221,41216
 Mvav 36,212,8
 CV 22,28,29
 CV 23,30,31
 Mvav 100,212,72
 T 252,223,33024
 T 254,223,41216
 Mvav 12,216,8
 s_cmp_eq_u32 s78, 15
 s_cselect_b32 s79, 0x10000000, s40
 s_cbranch_scc1 LE0_k30
LE0_k30b:
 buffer_store_dwordx4 v[20:23], v204, s[24:27], s79 offen sc1
 Mvav 76,216,72
 v_mul_f32 v52, v52, v195
 v_mul_f32 v53, v53, v195
 Mvav 140,216,136
 s_waitcnt lgkmcnt(4)
 v_mul_f32 v54, v54, v195
 v_mul_f32 v55, v55, v195
 Mvav 44,220,8
 v_mul_f32 v60, v60, v195
 v_mul_f32 v61, v61, v195
 Mvav 108,220,72
 v_mul_f32 v62, v62, v195
 v_mul_f32 v63, v63, v195
 Mvav 4,224,16
 CV 52,52,53
 CV 53,54,55
 Mvav 68,224,80
 CV 54,60,61
 CV 55,62,63
 Mvav 132,224,144
 v_mul_f32 v84, v84, v196
 v_mul_f32 v85, v85, v196
 Mvav 36,228,16
 s_cmp_eq_u32 s78, 0
 s_cselect_b32 s79, 0x10000000, s40
 s_cbranch_scc1 LE0_k31
LE0_k31b:
 buffer_store_dwordx4 v[52:55], v204, s[24:27], s79 offen offset:1024 sc1
 Mvav 100,228,80
 s_waitcnt lgkmcnt(0)
 s_barrier
 T 192,208,0
 Mvav 12,232,16
 T 194,208,8192
 v_mul_f32 v86, v86, v196
 Mvav 76,232,80
 T 196,210,0
 T 198,210,8192
 Mvav 140,232,144
 v_mul_f32 v87, v87, v196
 v_mul_f32 v92, v92, v196
 Mvav 44,236,16
 T 200,209,0
 T 202,209,8192
 Mvav 108,236,80
 v_mul_f32 v93, v93, v196
 v_mul_f32 v94, v94, v196
 Mvav 4,240,24
 T 204,211,0
 T 206,211,8192
 Mvav 68,240,88
 v_mul_f32 v95, v95, v196
 CV 84,84,85
 Mvav 132,240,152
 T 208,212,0
 T 210,212,8192
 Mvav 36,244,24
 CV 85,86,87
 CV 86,92,93
 Mvav 100,244,88
 T 212,214,0
 T 214,214,8192
 Mvav 12,248,24
 CV 87,94,95
 v_mul_f32 v116, v116, v196
 Mvav 76,248,88
 s_cmp_eq_u32 s78, 1
 s_cselect_b32 s79, 0x10000000, s40
 s_cbranch_scc1 LE0_k32
LE0_k32b:
 T 216,213,0
 T 218,213,8192
 Mvav 140,248,152
 s_waitcnt lgkmcnt(6)
 buffer_store_dwordx4 v[84:87], v204, s[24:27], s79 offen offset:2048 sc1
 Mvav 44,252,24
 T 220,215,0
 T 222,215,8192
 Mvav 108,252,88
 v_mul_f32 v117, v117, v196
 v_mul_f32 v118, v118, v196
 Mvav 4,192,32
 T 224,208,256
 T 226,208,8448
 Mvav 68,192,96
 v_mul_f32 v119, v119, v196
 v_mul_f32 v124, v124, v196
 Mvav 132,192,160
 T 228,210,256
 T 230,210,8448
 Mvav 36,196,32
 v_mul_f32 v125, v125, v196
 v_mul_f32 v126, v126, v196
 Mvav 100,196,96
 s_waitcnt lgkmcnt(6)
 T 232,209,256
 T 234,209,8448
 Mvav 12,200,32
 v_mul_f32 v127, v127, v196
 CV 116,116,117
 Mvav 76,200,96
 T 236,211,256
 T 238,211,8448
 Mvav 140,200,160
 CV 117,118,119
 CV 118,124,125
 Mvav 44,204,32
 T 240,212,256
 T 242,212,8448
 Mvav 108,204,96
 s_waitcnt lgkmcnt(6)
 CV 119,126,127
 v_mul_f32 v148, v148, v197
 Mvav 4,208,40
 s_cmp_eq_u32 s78, 2
 s_cselect_b32 s79, 0x10000000, s40
 s_cbranch_scc1 LE0_k33
LE0_k33b:
 T 244,214,256
 T 246,214,8448
 Mvav 68,208,104
 buffer_store_dwordx4 v[116:119], v204, s[24:27], s79 offen offset:3072 sc1
 Mvav 132,208,168
 T 248,213,256
 T 250,213,8448
 Mvav 36,212,40
 s_add_u32 s40, s68, 65536
 v_mul_f32 v149, v149, v197
 v_mul_f32 v150, v150, v197
 Mvav 100,212,104
 T 252,215,256
 T 254,215,8448
 Mvav 12,216,40
 v_mul_f32 v151, v151, v197
 v_mul_f32 v156, v156, v197
 Mvav 76,216,104
 v_mul_f32 v157, v157, v197
 v_mul_f32 v158, v158, v197
 Mvav 140,216,168
 s_waitcnt lgkmcnt(4)
 v_mul_f32 v159, v159, v197
 CV 148,148,149
 Mvav 44,220,40
 CV 149,150,151
 CV 150,156,157
 Mvav 108,220,104
 CV 151,158,159
 Mvav 4,224,48
 s_cmp_eq_u32 s78, 3
 s_cselect_b32 s79, 0x10000000, s40
 s_cbranch_scc1 LE0_k34
LE0_k34b:
 buffer_store_dwordx4 v[148:151], v204, s[24:27], s79 offen sc1
 Mvav 68,224,112
 Mvav 132,224,176
 Mvav 36,228,48
 Mvav 100,228,112
 s_waitcnt vmcnt(28) lgkmcnt(0)
 s_barrier
 T 192,208,49152
 Mvav 12,232,48
 T 194,208,57344
 Mvav 76,232,112
 T 196,210,49152
 T 198,210,57344
 Mvav 140,232,176
 Mvav 44,236,48
 T 200,209,49152
 T 202,209,57344
 Mvav 108,236,112
 Mvav 4,240,56
 T 204,211,49152
 T 206,211,57344
 Mvav 68,240,120
 Mvav 132,240,184
 T 208,212,49152
 T 210,212,57344
 Mvav 36,244,56
 Mvav 100,244,120
 T 212,214,49152
 T 214,214,57344
 Mvav 12,248,56
 Mvav 76,248,120
 T 216,213,49152
 T 218,213,57344
 Mvav 140,248,184
 s_waitcnt lgkmcnt(6)
 Mvav 44,252,56
 T 220,215,49152
 T 222,215,57344
 Mvav 108,252,120
 Mvavz 20,192,0
 T 224,208,49408
 T 226,208,57600
 Mvavz 84,192,64
 Mvavz 148,192,128
 T 228,210,49408
 T 230,210,57600
 Mvavz 52,196,0
 s_add_u32 s40, s68, 81920
 v_mul_f32 v4, v4, v195
 v_mul_f32 v5, v5, v195
 Mvavz 116,196,64
 s_waitcnt lgkmcnt(6)
 T 232,209,49408
 T 234,209,57600
 Mvavz 28,200,0
 v_mul_f32 v6, v6, v195
 v_mul_f32 v7, v7, v195
 Mvavz 92,200,64
 T 236,211,49408
 T 238,211,57600
 Mvavz 156,200,128
 v_mul_f32 v12, v12, v195
 v_mul_f32 v13, v13, v195
 Mvavz 60,204,0
 T 240,212,49408
 T 242,212,57600
 Mvavz 124,204,64
 s_waitcnt lgkmcnt(6)
 v_mul_f32 v14, v14, v195
 v_mul_f32 v15, v15, v195
 Mvav 20,208,8
 T 244,214,49408
 T 246,214,57600
 Mvav 84,208,72
 CV 4,4,5
 CV 5,6,7
 Mvav 148,208,136
 T 248,213,49408
 T 250,213,57600
 Mvav 52,212,8
 CV 6,12,13
 CV 7,14,15
 Mvav 116,212,72
 T 252,215,49408
 T 254,215,57600
 Mvav 28,216,8
 s_cmp_eq_u32 s78, 0
 s_cselect_b32 s79, 0x10000000, s40
 s_cbranch_scc1 LE0_k40
LE0_k40b:
 v_mul_f32 v36, v36, v195
 v_mul_f32 v37, v37, v195
 Mvav 92,216,72
 v_mul_f32 v38, v38, v195
 v_mul_f32 v39, v39, v195
 Mvav 156,216,136
 s_waitcnt lgkmcnt(4)
 v_mul_f32 v44, v44, v195
 v_mul_f32 v45, v45, v195
 Mvav 60,220,8
 v_mul_f32 v46, v46, v195
 v_mul_f32 v47, v47, v195
 Mvav 124,220,72
 CV 36,36,37
 CV 37,38,39
 Mvav 20,224,16
 CV 38,44,45
 CV 39,46,47
 Mvav 84,224,80
 v_mul_f32 v68, v68, v196
 v_mul_f32 v69, v69, v196
 Mvav 148,224,144
 v_mul_f32 v70, v70, v196
 v_mul_f32 v71, v71, v196
 Mvav 52,228,16
 v_mul_f32 v76, v76, v196
 v_mul_f32 v77, v77, v196
 Mvav 116,228,80
 s_waitcnt vmcnt(0) lgkmcnt(0)
 s_barrier
 buffer_store_dword v242, v241, s[84:87], s47 offen sc1
 Mvav 28,232,16
 buffer_store_dwordx4 v[4:7], v204, s[24:27], s79 offen sc1
 Mvav 92,232,80
 s_cmp_eq_u32 s78, 1
 s_cselect_b32 s79, 0x10000000, s40
 s_cbranch_scc1 LE0_k41
LE0_k41b:
 T 192,224,16384
 T 194,224,24576
 Mvav 156,232,144
 T 196,226,16384
 T 198,226,24576
 Mvav 60,236,16
 T 200,225,16384
 T 202,225,24576
 Mvav 124,236,80
 buffer_store_dwordx4 v[36:39], v204, s[24:27], s79 offen offset:1024 sc1
 Mvav 20,240,24
 T 204,227,16384
 T 206,227,24576
 Mvav 84,240,88
 v_mul_f32 v78, v78, v196
 v_mul_f32 v79, v79, v196
 Mvav 148,240,152
 T 208,228,16384
 T 210,228,24576
 Mvav 52,244,24
 CV 68,68,69
 CV 69,70,71
 Mvav 116,244,88
 T 212,230,16384
 T 214,230,24576
 Mvav 28,248,24
 CV 70,76,77
 CV 71,78,79
 Mvav 92,248,88
 s_cmp_eq_u32 s78, 2
 s_cselect_b32 s79, 0x10000000, s40
 s_cbranch_scc1 LE0_k42
LE0_k42b:
 T 216,229,16384
 T 218,229,24576
 Mvav 156,248,152
 s_waitcnt lgkmcnt(6)
 buffer_store_dwordx4 v[68:71], v204, s[24:27], s79 offen offset:2048 sc1
 Mvav 60,252,24
 T 220,231,16384
 T 222,231,24576
 Mvav 124,252,88
 v_mul_f32 v100, v100, v196
 v_mul_f32 v101, v101, v196
 Mvav 20,192,32
 T 224,224,16640
 T 226,224,24832
 Mvav 84,192,96
 v_mul_f32 v102, v102, v196
 v_mul_f32 v103, v103, v196
 Mvav 148,192,160
 T 228,226,16640
 T 230,226,24832
 Mvav 52,196,32
 v_mul_f32 v108, v108, v196
 v_mul_f32 v109, v109, v196
 Mvav 116,196,96
 s_waitcnt lgkmcnt(6)
 T 232,225,16640
 T 234,225,24832
 Mvav 28,200,32
 v_mul_f32 v110, v110, v196
 v_mul_f32 v111, v111, v196
 Mvav 92,200,96
 T 236,227,16640
 T 238,227,24832
 Mvav 156,200,160
 CV 100,100,101
 CV 101,102,103
 Mvav 60,204,32
 T 240,228,16640
 T 242,228,24832
 Mvav 124,204,96
 s_waitcnt lgkmcnt(6)
 CV 102,108,109
 CV 103,110,111
 Mvav 20,208,40
 s_cmp_eq_u32 s78, 3
 s_cselect_b32 s79, 0x10000000, s40
 s_cbranch_scc1 LE0_k43
LE0_k43b:
 T 244,230,16640
 T 246,230,24832
 Mvav 84,208,104
 buffer_store_dwordx4 v[100:103], v204, s[24:27], s79 offen offset:3072 sc1
 Mvav 148,208,168
 T 248,229,16640
 T 250,229,24832
 Mvav 52,212,40
 s_add_u32 s40, s68, 86016
 v_mul_f32 v132, v132, v197
 v_mul_f32 v133, v133, v197
 Mvav 116,212,104
 T 252,231,16640
 T 254,231,24832
 Mvav 28,216,40
 v_mul_f32 v134, v134, v197
 v_mul_f32 v135, v135, v197
 Mvav 92,216,104
 v_mul_f32 v140, v140, v197
 v_mul_f32 v141, v141, v197
 Mvav 156,216,168
 s_waitcnt lgkmcnt(4)
 v_mul_f32 v142, v142, v197
 v_mul_f32 v143, v143, v197
 Mvav 60,220,40
 CV 132,132,133
 CV 133,134,135
 Mvav 124,220,104
 CV 134,140,141
 CV 135,142,143
 Mvav 20,224,48
 s_cmp_eq_u32 s78, 4
 s_cselect_b32 s79, 0x10000000, s40
 s_cbranch_scc1 LE0_k44
LE0_k44b:
 buffer_store_dwordx4 v[132:135], v204, s[24:27], s79 offen sc1
 Mvav 84,224,112
 Mvav 148,224,176
 Mvav 52,228,48
 Mvav 116,228,112
 s_waitcnt lgkmcnt(0)
 s_barrier
 T 192,216,0
 Mvav 28,232,48
 T 194,216,8192
 Mvav 92,232,112
 T 196,218,0
 T 198,218,8192
 Mvav 156,232,176
 Mvav 60,236,48
 T 200,217,0
 T 202,217,8192
 Mvav 124,236,112
 Mvav 20,240,56
 T 204,219,0
 T 206,219,8192
 Mvav 84,240,120
 Mvav 148,240,184
 T 208,220,0
 T 210,220,8192
 Mvav 52,244,56
 Mvav 116,244,120
 T 212,222,0
 T 214,222,8192
 Mvav 28,248,56
 Mvav 92,248,120
 T 216,221,0
 T 218,221,8192
 Mvav 156,248,184
 s_waitcnt lgkmcnt(6)
 Mvav 60,252,56
 T 220,223,0
 T 222,223,8192
 Mvav 124,252,120
 Mvavz 4,192,0
 T 224,216,256
 T 226,216,8448
 Mvavz 68,192,64
 Mvavz 132,192,128
 T 228,218,256
 T 230,218,8448
 Mvavz 36,196,0
 s_add_u32 s40, s68, 102400
 v_mul_f32 v20, v20, v195
 v_mul_f32 v21, v21, v195
 Mvavz 100,196,64
 s_waitcnt lgkmcnt(6)
 T 232,217,256
 T 234,217,8448
 Mvavz 12,200,0
 v_mul_f32 v22, v22, v195
 v_mul_f32 v23, v23, v195
 Mvavz 76,200,64
 T 236,219,256
 T 238,219,8448
 Mvavz 140,200,128
 v_mul_f32 v28, v28, v195
 v_mul_f32 v29, v29, v195
 Mvavz 44,204,0
 T 240,220,256
 T 242,220,8448
 Mvavz 108,204,64
 s_waitcnt lgkmcnt(6)
 v_mul_f32 v30, v30, v195
 v_mul_f32 v31, v31, v195
 Mvav 4,208,8
 T 244,222,256
 T 246,222,8448
 Mvav 68,208,72
 CV 20,20,21
 CV 21,22,23
 Mvav 132,208,136
 T 248,221,256
 T 250,221,8448
 Mvav 36,212,8
 CV 22,28,29
 CV 23,30,31
 Mvav 100,212,72
 T 252,223,256
 T 254,223,8448
 Mvav 12,216,8
 s_cmp_eq_u32 s78, 5
 s_cselect_b32 s79, 0x10000000, s40
 s_cbranch_scc1 LE0_k50
LE0_k50b:
 buffer_store_dwordx4 v[20:23], v204, s[24:27], s79 offen sc1
 Mvav 76,216,72
 v_mul_f32 v52, v52, v195
 v_mul_f32 v53, v53, v195
 Mvav 140,216,136
 s_waitcnt lgkmcnt(4)
 v_mul_f32 v54, v54, v195
 v_mul_f32 v55, v55, v195
 Mvav 44,220,8
 v_mul_f32 v60, v60, v195
 v_mul_f32 v61, v61, v195
 Mvav 108,220,72
 v_mul_f32 v62, v62, v195
 v_mul_f32 v63, v63, v195
 Mvav 4,224,16
 CV 52,52,53
 CV 53,54,55
 Mvav 68,224,80
 CV 54,60,61
 CV 55,62,63
 Mvav 132,224,144
 v_mul_f32 v84, v84, v196
 v_mul_f32 v85, v85, v196
 Mvav 36,228,16
 s_cmp_eq_u32 s78, 6
 s_cselect_b32 s79, 0x10000000, s40
 s_cbranch_scc1 LE0_k51
LE0_k51b:
 buffer_store_dwordx4 v[52:55], v204, s[24:27], s79 offen offset:1024 sc1
 Mvav 100,228,80
 s_waitcnt lgkmcnt(0)
 s_barrier
 T 192,216,49152
 Mvav 12,232,16
 T 194,216,57344
 v_mul_f32 v86, v86, v196
 Mvav 76,232,80
 T 196,217,49152
 T 198,217,57344
 Mvav 140,232,144
 v_mul_f32 v87, v87, v196
 v_mul_f32 v92, v92, v196
 Mvav 44,236,16
 T 200,220,49152
 T 202,220,57344
 Mvav 108,236,80
 v_mul_f32 v93, v93, v196
 v_mul_f32 v94, v94, v196
 Mvav 4,240,24
 T 204,221,49152
 T 206,221,57344
 Mvav 68,240,88
 v_mul_f32 v95, v95, v196
 CV 84,84,85
 Mvav 132,240,152
 T 208,216,49408
 T 210,216,57600
 Mvav 36,244,24
 CV 85,86,87
 CV 86,92,93
 Mvav 100,244,88
 T 212,217,49408
 T 214,217,57600
 Mvav 12,248,24
 CV 87,94,95
 v_mul_f32 v116, v116, v196
 Mvav 76,248,88
 s_cmp_eq_u32 s78, 7
 s_cselect_b32 s79, 0x10000000, s40
 s_cbranch_scc1 LE0_k52
LE0_k52b:
 T 216,220,49408
 T 218,220,57600
 Mvav 140,248,152
 s_waitcnt lgkmcnt(6)
 buffer_store_dwordx4 v[84:87], v204, s[24:27], s79 offen offset:2048 sc1
 Mvav 44,252,24
 T 220,221,49408
 T 222,221,57600
 Mvav 108,252,88
 v_mul_f32 v117, v117, v196
 v_mul_f32 v118, v118, v196
 Mvav 4,192,32
 T 224,218,49152
 T 226,218,57344
 Mvav 68,192,96
 v_mul_f32 v119, v119, v196
 v_mul_f32 v124, v124, v196
 Mvav 132,192,160
 T 228,219,49152
 T 230,219,57344
 Mvav 12,196,32
 v_mul_f32 v125, v125, v196
 v_mul_f32 v126, v126, v196
 Mvav 76,196,96
 T 232,222,49152
 T 234,222,57344
 Mvav 140,196,160
 s_waitcnt lgkmcnt(6)
 v_mul_f32 v127, v127, v196
 CV 116,116,117
 Mvav 4,200,40
 buffer_load_dword v198, v205, s[84:87], 0 offen sc1
 Mvav 68,200,104
 T 236,223,49152
 T 238,223,57344
 Mvav 132,200,168
 T 240,218,49408
 T 242,218,57600
 Mvav 12,204,40
 CV 117,118,119
 CV 118,124,125
 Mvav 76,204,104
 T 244,219,49408
 T 246,219,57600
 Mvav 140,204,168
 s_waitcnt lgkmcnt(6)
 CV 119,126,127
 v_mul_f32 v148, v148, v197
 Mvav 4,208,48
 s_cmp_eq_u32 s78, 8
 s_cselect_b32 s79, 0x10000000, s40
 s_cbranch_scc1 LE0_k53
LE0_k53b:
 buffer_store_dwordx4 v[116:119], v204, s[24:27], s79 offen offset:3072 sc1
 Mvav 68,208,112
 s_add_u32 s40, s68, 106496
 T 248,222,49408
 T 250,222,57600
 Mvav 132,208,176
 T 252,223,49408
 T 254,223,57600
 Mvav 12,212,48
 v_mul_f32 v149, v149, v197
 v_mul_f32 v150, v150, v197
 Mvav 76,212,112
 v_mul_f32 v151, v151, v197
 v_mul_f32 v156, v156, v197
 Mvav 140,212,176
 v_mul_f32 v157, v157, v197
 v_mul_f32 v158, v158, v197
 Mvav 4,216,56
 v_mul_f32 v159, v159, v197
 CV 148,148,149
 Mvav 68,216,120
 CV 149,150,151
 CV 150,156,157
 Mvav 132,216,184
 CV 151,158,159
 Mvav 12,220,56
 s_cmp_eq_u32 s78, 9
 s_cselect_b32 s79, 0x10000000, s40
 s_cbranch_scc1 LE0_k54
LE0_k54b:
 buffer_store_dwordx4 v[148:151], v204, s[24:27], s79 offen sc1
 Mvav 76,220,120
 Mvav 140,220,184
 Mvav 36,224,32
 Mvav 100,224,96
 Mvav 44,228,32
 Mvav 108,228,96
 v_mul_f32 v132, v132, v197
 v_mul_f32 v133, v133, v197
 Mvav 36,232,40
 s_add_u32 s40, s68, 126976
 v_mul_f32 v134, v134, v197
 v_mul_f32 v135, v135, v197
 Mvav 100,232,104
 s_waitcnt lgkmcnt(0)
 v_mul_f32 v140, v140, v197
 v_mul_f32 v141, v141, v197
 Mvav 44,236,40
 v_mul_f32 v142, v142, v197
 v_mul_f32 v143, v143, v197
 Mvav 108,236,104
 CV 132,132,133
 CV 133,134,135
 Mvav 36,240,48
 CV 134,140,141
 CV 135,142,143
 Mvav 100,240,112
 v_mul_f32 v4, v4, v195
 v_mul_f32 v5, v5, v195
 Mvav 44,244,48
 s_cmp_eq_u32 s78, 14
 s_cselect_b32 s79, 0x10000000, s40
 s_cbranch_scc1 LE0_k64
LE0_k64b:
 buffer_store_dwordx4 v[132:135], v204, s[24:27], s79 offen sc1
 Mvav 108,244,112
 v_mul_f32 v6, v6, v195
 v_mul_f32 v7, v7, v195
 Mvav 36,248,56
 s_add_u32 s40, s68, 122880
 v_mul_f32 v12, v12, v195
 v_mul_f32 v13, v13, v195
 Mvav 100,248,120
 v_mul_f32 v14, v14, v195
 v_mul_f32 v15, v15, v195
 Mvav 44,252,56
 CV 4,4,5
 CV 5,6,7
 Mvav 108,252,120
 CV 6,12,13
 CV 7,14,15
 s_cmp_eq_u32 s78, 10
 s_cselect_b32 s79, 0x10000000, s40
 s_cbranch_scc1 LE0_k60
LE0_k60b:
 buffer_store_dwordx4 v[4:7], v204, s[24:27], s79 offen sc1
 v_mul_f32 v68, v68, v196
 v_mul_f32 v69, v69, v196
 v_mul_f32 v70, v70, v196
 v_mul_f32 v71, v71, v196
 v_mul_f32 v76, v76, v196
 v_mul_f32 v77, v77, v196
 v_mul_f32 v78, v78, v196
 v_mul_f32 v79, v79, v196
 CV 68,68,69
 CV 69,70,71
 CV 70,76,77
 CV 71,78,79
 v_mul_f32 v36, v36, v195
 v_mul_f32 v37, v37, v195
 s_cmp_eq_u32 s78, 12
 s_cselect_b32 s79, 0x10000000, s40
 s_cbranch_scc1 LE0_k62
LE0_k62b:
 buffer_store_dwordx4 v[68:71], v204, s[24:27], s79 offen offset:2048 sc1
 v_mul_f32 v38, v38, v195
 v_mul_f32 v39, v39, v195
 v_mul_f32 v44, v44, v195
 v_mul_f32 v45, v45, v195
 v_mul_f32 v46, v46, v195
 v_mul_f32 v47, v47, v195
 CV 36,36,37
 CV 37,38,39
 CV 38,44,45
 CV 39,46,47
 s_cmp_eq_u32 s78, 11
 s_cselect_b32 s79, 0x10000000, s40
 s_cbranch_scc1 LE0_k61
LE0_k61b:
 buffer_store_dwordx4 v[36:39], v204, s[24:27], s79 offen offset:1024 sc1
 v_mul_f32 v100, v100, v196
 v_mul_f32 v101, v101, v196
 v_mul_f32 v102, v102, v196
 v_mul_f32 v103, v103, v196
 v_mul_f32 v108, v108, v196
 v_mul_f32 v109, v109, v196
 v_mul_f32 v110, v110, v196
 v_mul_f32 v111, v111, v196
 CV 100,100,101
 CV 101,102,103
 CV 102,108,109
 CV 103,110,111
 s_cmp_eq_u32 s78, 13
 s_cselect_b32 s79, 0x10000000, s40
 s_cbranch_scc1 LE0_k63
LE0_k63b:
 buffer_store_dwordx4 v[100:103], v204, s[24:27], s79 offen offset:3072 sc1
 s_waitcnt vmcnt(7)
 s_branch L_tail
LE0_k00:
 AW 60,4
 AW 61,5
 AW 62,6
 AW 63,7
 s_branch LE0_k00b
LE0_k01:
 AW 60,36
 AW 61,37
 AW 62,38
 AW 63,39
 s_branch LE0_k01b
LE0_k02:
 AW 60,68
 AW 61,69
 AW 62,70
 AW 63,71
 s_branch LE0_k02b
LE0_k03:
 AW 60,100
 AW 61,101
 AW 62,102
 AW 63,103
 s_branch LE0_k03b
LE0_k04:
 AW 60,132
 AW 61,133
 AW 62,134
 AW 63,135
 s_branch LE0_k04b
LE0_k10:
 AW 60,20
 AW 61,21
 AW 62,22
 AW 63,23
 s_branch LE0_k10b
LE0_k11:
 AW 60,52
 AW 61,53
 AW 62,54
 AW 63,55
 s_branch LE0_k11b
LE0_k12:
 AW 60,84
 AW 61,85
 AW 62,86
 AW 63,87
 s_branch LE0_k12b
LE0_k13:
 AW 60,116
 AW 61,117
 AW 62,118
 AW 63,119
 s_branch LE0_k13b
LE0_k14:
 AW 60,148
 AW 61,149
 AW 62,150
 AW 63,151
 s_branch LE0_k14b
LE0_k20:
 AW 60,4
 AW 61,5
 AW 62,6
 AW 63,7
 s_branch LE0_k20b
LE0_k21:
 AW 60,36
 AW 61,37
 AW 62,38
 AW 63,39
 s_branch LE0_k21b
LE0_k22:
 AW 60,68
 AW 61,69
 AW 62,70
 AW 63,71
 s_branch LE0_k22b
LE0_k23:
 AW 60,100
 AW 61,101
 AW 62,102
 AW 63,103
 s_branch LE0_k23b
LE0_k24:
 AW 60,132
 AW 61,133
 AW 62,134
 AW 63,135
 s_branch LE0_k24b
LE0_k30:
 AW 60,20
 AW 61,21
 AW 62,22
 AW 63,23
 s_branch LE0_k30b
LE0_k31:
 AW 124,52
 AW 125,53
 AW 126,54
 AW 127,55
 s_branch LE0_k31b
LE0_k32:
 AW 124,84
 AW 125,85
 AW 126,86
 AW 127,87
 s_branch LE0_k32b
LE0_k33:
 AW 124,116
 AW 125,117
 AW 126,118
 AW 127,119
 s_branch LE0_k33b
LE0_k34:
 AW 124,148
 AW 125,149
 AW 126,150
 AW 127,151
 s_branch LE0_k34b
LE0_k40:
 AW 188,4
 AW 189,5
 AW 190,6
 AW 191,7
 s_branch LE0_k40b
LE0_k41:
 AW 188,36
 AW 189,37
 AW 190,38
 AW 191,39
 s_branch LE0_k41b
LE0_k42:
 AW 188,68
 AW 189,69
 AW 190,70
 AW 191,71
 s_branch LE0_k42b
LE0_k43:
 AW 188,100
 AW 189,101
 AW 190,102
 AW 191,103
 s_branch LE0_k43b
LE0_k44:
 AW 188,132
 AW 189,133
 AW 190,134
 AW 191,135
 s_branch LE0_k44b
LE0_k50:
 AW 188,20
 AW 189,21
 AW 190,22
 AW 191,23
 s_branch LE0_k50b
LE0_k51:
 AW 188,52
 AW 189,53
 AW 190,54
 AW 191,55
 s_branch LE0_k51b
LE0_k52:
 AW 188,84
 AW 189,85
 AW 190,86
 AW 191,87
 s_branch LE0_k52b
LE0_k53:
 AW 188,116
 AW 189,117
 AW 190,118
 AW 191,119
 s_branch LE0_k53b
LE0_k54:
 AW 188,148
 AW 189,149
 AW 190,150
 AW 191,151
 s_branch LE0_k54b
LE0_k64:
 AW 188,132
 AW 189,133
 AW 190,134
 AW 191,135
 s_branch LE0_k64b
LE0_k60:
 AW 188,4
 AW 189,5
 AW 190,6
 AW 191,7
 s_branch LE0_k60b
LE0_k62:
 AW 188,68
 AW 189,69
 AW 190,70
 AW 191,71
 s_branch LE0_k62b
LE0_k61:
 AW 188,36
 AW 189,37
 AW 190,38
 AW 191,39
 s_branch LE0_k61b
LE0_k63:
 AW 188,100
 AW 189,101
 AW 190,102
 AW 191,103
 s_branch LE0_k63b
L_pres0:
 buffer_store_byte v201, v204, s[88:91], s46 offen sc1
 s_branch L_pres0b
L_pres1:
 buffer_store_byte v201, v204, s[88:91], s46 offen sc1
 s_branch L_pres1b
L_pres2:
 buffer_store_byte v201, v204, s[88:91], s46 offen sc1
 s_branch L_pres2b
L_pres3:
 buffer_store_byte v201, v204, s[88:91], s46 offen sc1
 s_branch L_pres3b
L_pres4:
 buffer_store_byte v201, v204, s[88:91], s46 offen sc1
 s_branch L_pres4b
L_pres5:
 buffer_store_byte v201, v204, s[88:91], s46 offen sc1
 s_branch L_pres5b
L_pres6:
 buffer_store_byte v201, v204, s[88:91], s46 offen sc1
 s_branch L_pres6b
L_pres7:
 buffer_store_byte v201, v204, s[88:91], s46 offen sc1
 s_branch L_pres7b
L_pres8:
 buffer_store_byte v201, v204, s[88:91], s46 offen sc1
 s_branch L_pres8b
L_pres9:
 buffer_store_byte v201, v204, s[88:91], s46 offen sc1
 s_branch L_pres9b
L_pres10:
 buffer_store_byte v201, v204, s[88:91], s46 offen sc1
 s_branch L_pres10b
L_pres11:
 buffer_store_byte v201, v204, s[88:91], s46 offen sc1
 s_branch L_pres11b
L_pres12:
 buffer_store_byte v201, v204, s[88:91], s46 offen sc1
 s_branch L_pres12b
L_pres13:
 buffer_store_byte v201, v204, s[88:91], s46 offen sc1
 s_branch L_pres13b
L_pres14:
 buffer_store_byte v201, v204, s[88:91], s46 offen sc1
 s_branch L_pres14b
L_pres15:
 buffer_store_byte v201, v204, s[88:91], s46 offen sc1
 s_branch L_pres15b
LE1_k00:
 AW 60,20
 AW 61,21
 AW 62,22
 AW 63,23
 s_branch LE1_k00b
LE1_k01:
 AW 60,52
 AW 61,53
 AW 62,54
 AW 63,55
 s_branch LE1_k01b
LE1_k02:
 AW 60,84
 AW 61,85
 AW 62,86
 AW 63,87
 s_branch LE1_k02b
LE1_k03:
 AW 60,116
 AW 61,117
 AW 62,118
 AW 63,119
 s_branch LE1_k03b
LE1_k04:
 AW 60,180
 AW 61,181
 AW 62,182
 AW 63,183
 s_branch LE1_k04b
LE1_k10:
 AW 60,4
 AW 61,5
 AW 62,6
 AW 63,7
 s_branch LE1_k10b
LE1_k11:
 AW 60,36
 AW 61,37
 AW 62,38
 AW 63,39
 s_branch LE1_k11b
LE1_k12:
 AW 60,68
 AW 61,69
 AW 62,70
 AW 63,71
 s_branch LE1_k12b
LE1_k13:
 AW 60,100
 AW 61,101
 AW 62,102
 AW 63,103
 s_branch LE1_k13b
LE1_k14:
 AW 60,164
 AW 61,165
 AW 62,166
 AW 63,167
 s_branch LE1_k14b
LE1_k20:
 AW 60,20
 AW 61,21
 AW 62,22
 AW 63,23
 s_branch LE1_k20b
LE1_k21:
 AW 60,52
 AW 61,53
 AW 62,54
 AW 63,55
 s_branch LE1_k21b
LE1_k22:
 AW 60,84
 AW 61,85
 AW 62,86
 AW 63,87
 s_branch LE1_k22b
LE1_k23:
 AW 60,116
 AW 61,117
 AW 62,118
 AW 63,119
 s_branch LE1_k23b
LE1_k24:
 AW 60,180
 AW 61,181
 AW 62,182
 AW 63,183
 s_branch LE1_k24b
LE1_k30:
 AW 60,4
 AW 61,5
 AW 62,6
 AW 63,7
 s_branch LE1_k30b
LE1_k31:
 AW 124,36
 AW 125,37
 AW 126,38
 AW 127,39
 s_branch LE1_k31b
LE1_k32:
 AW 124,68
 AW 125,69
 AW 126,70
 AW 127,71
 s_branch LE1_k32b
LE1_k33:
 AW 124,100
 AW 125,101
 AW 126,102
 AW 127,103
 s_branch LE1_k33b
LE1_k34:
 AW 124,164
 AW 125,165
 AW 126,166
 AW 127,167
 s_branch LE1_k34b
LE1_k40:
 AW 188,20
 AW 189,21
 AW 190,22
 AW 191,23
 s_branch LE1_k40b
LE1_k41:
 AW 188,52
 AW 189,53
 AW 190,54
 AW 191,55
 s_branch LE1_k41b
LE1_k42:
 AW 188,84
 AW 189,85
 AW 190,86
 AW 191,87
 s_branch LE1_k42b
LE1_k43:
 AW 188,116
 AW 189,117
 AW 190,118
 AW 191,119
 s_branch LE1_k43b
LE1_k44:
 AW 188,180
 AW 189,181
 AW 190,182
 AW 191,183
 s_branch LE1_k44b
LE1_k50:
 AW 188,4
 AW 189,5
 AW 190,6
 AW 191,7
 s_branch LE1_k50b
LE1_k51:
 AW 188,36
 AW 189,37
 AW 190,38
 AW 191,39
 s_branch LE1_k51b
LE1_k52:
 AW 188,68
 AW 189,69
 AW 190,70
 AW 191,71
 s_branch LE1_k52b
LE1_k53:
 AW 188,100
 AW 189,101
 AW 190,102
 AW 191,103
 s_branch LE1_k53b
LE1_k54:
 AW 188,164
 AW 189,165
 AW 190,166
 AW 191,167
 s_branch LE1_k54b
LE1_k64:
 AW 188,180
 AW 189,181
 AW 190,182
 AW 191,183
 s_branch LE1_k64b
LE1_k61:
 AW 188,52
 AW 189,53
 AW 190,54
 AW 191,55
 s_branch LE1_k61b
LE1_k63:
 AW 188,116
 AW 189,117
 AW 190,118
 AW 191,119
 s_branch LE1_k63b
LE1_k60:
 AW 188,20
 AW 189,21
 AW 190,22
 AW 191,23
 s_branch LE1_k60b
LE1_k62:
 AW 188,84
 AW 189,85
 AW 190,86
 AW 191,87
 s_branch LE1_k62b
.p2align 6
L_mainE1:
 s_barrier
 R 0,195,0
 R 4,195,2048
 R 8,197,0
 T 192,228,0
 T 194,228,8192
 T 196,224,0
 T 198,224,8192
 T 200,229,0
 T 202,229,8192
 T 204,225,0
 T 206,225,8192
 s_waitcnt lgkmcnt(6)
 Mvaaz 16,192,0
 T 208,230,0
 T 210,230,8192
 Mvaaz 80,192,4
 T 212,226,0
 T 214,226,8192
 Mvaaz 144,192,8
 s_waitcnt lgkmcnt(8)
 R 12,196,0
 Mvaaz 0,196,0
 T 216,231,0
 T 218,231,8192
 Mvaaz 64,196,4
 s_waitcnt lgkmcnt(9)
 T 220,227,0
 T 222,227,8192
 Mvaaz 20,200,0
 R 16,196,2048
 Mvaaz 84,200,4
 T 224,228,256
 T 226,228,8448
 Mvaaz 148,200,8
 s_waitcnt lgkmcnt(10)
 T 228,224,256
 T 230,224,8448
 Mvaaz 4,204,0
 R 20,207,0
 Mvaaz 68,204,4
 s_waitcnt lgkmcnt(10)
 T 232,229,256
 T 234,229,8448
 Mvaaz 24,208,0
 T 236,225,256
 T 238,225,8448
 Mvaaz 88,208,4
 Mvaaz 152,208,8
 s_waitcnt lgkmcnt(9)
 T 240,230,256
 T 242,230,8448
 Mvaaz 8,212,0
 T 244,226,256
 T 246,226,8448
 Mvaaz 72,212,4
 s_waitcnt lgkmcnt(9)
 Mvaaz 28,216,0
 T 248,231,256
 T 250,231,8448
 Mvaaz 92,216,4
 T 252,227,256
 T 254,227,8448
 Mvaaz 156,216,8
 s_waitcnt lgkmcnt(8)
 Mvaaz 12,220,0
 Mvaaz 76,220,4
 Mvaaz 48,224,0
 Mvaaz 112,224,4
 Mvaaz 176,224,8
 Mvaaz 32,228,0
 Mvaaz 96,228,4
 s_waitcnt lgkmcnt(0)
 s_barrier
 T 192,228,16384
 Mvaaz 52,232,0
 T 194,228,24576
 Mvaaz 116,232,4
 T 196,224,16384
 T 198,224,24576
 Mvaaz 180,232,8
 R 24,195,20480
 Mvaaz 36,236,0
 T 200,229,16384
 T 202,229,24576
 Mvaaz 100,236,4
 R 28,195,22528
 Mvaaz 56,240,0
 T 204,225,16384
 T 206,225,24576
 Mvaaz 120,240,4
 R 32,197,20480
 Mvaaz 184,240,8
 s_waitcnt lgkmcnt(9)
 T 208,230,16384
 T 210,230,24576
 Mvaaz 40,244,0
 R 36,196,20480
 Mvaaz 104,244,4
 s_waitcnt lgkmcnt(9)
 T 212,226,16384
 T 214,226,24576
 Mvaaz 60,248,0
 R 40,196,22528
 Mvaaz 124,248,4
 T 216,231,16384
 T 218,231,24576
 Mvaaz 188,248,8
 s_waitcnt lgkmcnt(9)
 R 44,207,20480
 Mvaaz 44,252,0
 T 220,227,16384
 T 222,227,24576
 Mvaaz 108,252,4
 s_waitcnt lgkmcnt(9)
 Mvaa 16,192,12
 Mvaa 80,192,16
 Mvaa 144,192,20
 Mvaa 0,196,12
 Mvaa 64,196,16
 T 224,228,16640
 T 226,228,24832
 T 228,224,16640
 T 230,224,24832
 Mvaa 20,200,12
 Mvaa 84,200,16
 Mvaa 148,200,20
 s_waitcnt lgkmcnt(4)
 Mvaa 4,204,12
 T 232,229,16640
 T 234,229,24832
 T 236,225,16640
 T 238,225,24832
 Mvaa 68,204,16
 Mvaa 24,208,12
 Mvaa 88,208,16
 Mvaa 152,208,20
 T 240,230,16640
 T 242,230,24832
 T 244,226,16640
 T 246,226,24832
 Mvaa 8,212,12
 Mvaa 72,212,16
 s_waitcnt lgkmcnt(8)
 Mvaa 28,216,12
 Mvaa 92,216,16
 T 248,231,16640
 T 250,231,24832
 T 252,227,16640
 T 254,227,24832
 Mvaa 156,216,20
 s_waitcnt lgkmcnt(8)
 Mvaa 12,220,12
 Mvaa 76,220,16
 Mvaa 48,224,12
 Mvaa 112,224,16
 Mvaa 176,224,20
 Mvaa 32,228,12
 Mvaa 96,228,16
 s_waitcnt lgkmcnt(0)
 s_barrier
 T 192,220,32768
 T 194,220,40960
 Mvaa 52,232,12
 Mvaa 116,232,16
 T 196,216,32768
 T 198,216,40960
 Mvaa 180,232,20
 Mvaa 36,236,12
 T 200,221,32768
 T 202,221,40960
 Mvaa 100,236,16
 Mvaa 56,240,12
 T 204,217,32768
 T 206,217,40960
 Mvaa 120,240,16
 Mvaa 184,240,20
 T 208,222,32768
 T 210,222,40960
 Mvaa 40,244,12
 Mvaa 104,244,16
 T 212,218,32768
 T 214,218,40960
 Mvaa 60,248,12
 Mvaa 124,248,16
 T 216,223,32768
 T 218,223,40960
 Mvaa 188,248,20
 s_waitcnt lgkmcnt(6)
 Mvaa 44,252,12
 T 220,219,32768
 T 222,219,40960
 Mvaa 108,252,16
 Mvaa 16,192,24
 T 224,220,33024
 T 226,220,41216
 Mvaa 80,192,28
 Mvaa 144,192,32
 T 228,216,33024
 T 230,216,41216
 Mvaa 0,196,24
 Mvaa 64,196,28
 s_waitcnt lgkmcnt(6)
 T 232,221,33024
 T 234,221,41216
 Mvaa 20,200,24
 Mvaa 84,200,28
 T 236,217,33024
 T 238,217,41216
 Mvaa 148,200,32
 Mvaa 4,204,24
 T 240,222,33024
 T 242,222,41216
 Mvaa 68,204,28
 s_waitcnt lgkmcnt(6)
 Mvaa 24,208,24
 T 244,218,33024
 T 246,218,41216
 Mvaa 88,208,28
 Mvaa 152,208,32
 T 248,223,33024
 T 250,223,41216
 Mvaa 8,212,24
 Mvaa 72,212,28
 T 252,219,33024
 T 254,219,41216
 Mvaa 28,216,24
 Mvaa 92,216,28
 Mvaa 156,216,32
 s_waitcnt lgkmcnt(4)
 Mvaa 12,220,24
 Mvaa 76,220,28
 Mvaa 48,224,24
 Mvaa 112,224,28
 Mvaa 176,224,32
 Mvaa 32,228,24
 Mvaa 96,228,28
 s_waitcnt lgkmcnt(0)
 s_barrier
 T 192,220,49152
 T 194,220,57344
 R 48,195,0
 Mvaa 52,232,24
 R 52,195,2048
 R 56,197,0
 Mvaa 116,232,28
 T 196,216,49152
 T 198,216,57344
 R 60,196,0
 Mvaa 180,232,32
 Mvaa 36,236,24
 Mvaa 100,236,28
 T 200,221,49152
 T 202,221,57344
 R 64,196,2048
 Mvaa 56,240,24
 Mvaa 120,240,28
 Mvaa 184,240,32
 s_waitcnt lgkmcnt(6)
 T 204,217,49152
 T 206,217,57344
 T 208,222,49152
 T 210,222,57344
 Mvaa 40,244,24
 Mvaa 104,244,28
 Mvaa 60,248,24
 Mvaa 124,248,28
 T 212,218,49152
 T 214,218,57344
 T 216,223,49152
 T 218,223,57344
 Mvaa 188,248,32
 s_waitcnt lgkmcnt(8)
 Mvaa 44,252,24
 Mvaa 108,252,28
 Mvaa 16,192,36
 T 220,219,49152
 T 222,219,57344
 T 224,220,49408
 T 226,220,57600
 Mvaa 80,192,40
 Mvaa 144,192,44
 s_waitcnt lgkmcnt(8)
 Mvaa 0,196,36
 Mvaa 64,196,40
 Mvaa 20,200,36
 T 228,216,49408
 T 230,216,57600
 T 232,221,49408
 T 234,221,57600
 Mvaa 84,200,40
 Mvaa 148,200,44
 s_waitcnt lgkmcnt(4)
 Mvaa 4,204,36
 Mvaa 68,204,40
 T 236,217,49408
 T 238,217,57600
 T 240,222,49408
 T 242,222,57600
 Mvaa 24,208,36
 Mvaa 88,208,40
 Mvaa 152,208,44
 Mvaa 8,212,36
 T 244,218,49408
 T 246,218,57600
 T 248,223,49408
 T 250,223,57600
 Mvaa 72,212,40
 s_waitcnt lgkmcnt(8)
 Mvaa 28,216,36
 Mvaa 92,216,40
 Mvaa 156,216,44
 T 252,219,49408
 T 254,219,57600
 R 68,207,0
 Mvaa 12,220,36
 Mvaa 76,220,40
 s_waitcnt lgkmcnt(7)
 Mvaa 48,224,36
 Mvaa 112,224,40
 Mvaa 176,224,44
 Mvaa 32,228,36
 Mvaa 96,228,40
 s_waitcnt vmcnt(0) lgkmcnt(0)
 s_barrier
 T 192,228,0
 T 194,228,8192
 Mvaa 52,232,36
 Mvaa 116,232,40
 T 196,224,0
 T 198,224,8192
 Mvaa 180,232,44
 Mvaa 36,236,36
 T 200,229,0
 T 202,229,8192
 Mvaa 100,236,40
 Mvaa 56,240,36
 T 204,225,0
 T 206,225,8192
 Mvaa 120,240,40
 Mvaa 184,240,44
 T 208,230,0
 T 210,230,8192
 Mvaa 40,244,36
 Mvaa 104,244,40
 T 212,226,0
 T 214,226,8192
 Mvaa 60,248,36
 Mvaa 124,248,40
 T 216,231,0
 T 218,231,8192
 Mvaa 188,248,44
 s_waitcnt lgkmcnt(6)
 Mvaa 44,252,36
 T 220,227,0
 T 222,227,8192
 Mvaa 108,252,40
 Mvaa 16,192,48
 T 224,228,256
 T 226,228,8448
 Mvaa 80,192,52
 Mvaa 144,192,56
 T 228,224,256
 T 230,224,8448
 Mvaa 0,196,48
 Mvaa 64,196,52
 s_waitcnt lgkmcnt(6)
 T 232,229,256
 T 234,229,8448
 Mvaa 20,200,48
 Mvaa 84,200,52
 T 236,225,256
 T 238,225,8448
 Mvaa 148,200,56
 Mvaa 4,204,48
 T 240,230,256
 T 242,230,8448
 Mvaa 68,204,52
 s_waitcnt lgkmcnt(6)
 Mvaa 24,208,48
 T 244,226,256
 T 246,226,8448
 Mvaa 88,208,52
 Mvaa 152,208,56
 T 248,231,256
 T 250,231,8448
 Mvaa 8,212,48
 Mvaa 72,212,52
 T 252,227,256
 T 254,227,8448
 Mvaa 28,216,48
 Mvaa 92,216,52
 Mvaa 156,216,56
 s_waitcnt lgkmcnt(4)
 Mvaa 12,220,48
 Mvaa 76,220,52
 Mvaa 48,224,48
 Mvaa 112,224,52
 Mvaa 176,224,56
 Mvaa 32,228,48
 Mvaa 96,228,52
 s_waitcnt lgkmcnt(0)
 s_barrier
 T 192,228,16384
 T 194,228,24576
 R 72,195,20480
 Mvaa 52,232,48
 R 76,195,22528
 R 80,197,20480
 Mvaa 116,232,52
 T 196,224,16384
 T 198,224,24576
 R 84,196,20480
 Mvaa 180,232,56
 Mvaa 36,236,48
 Mvaa 100,236,52
 T 200,229,16384
 T 202,229,24576
 R 88,196,22528
 Mvaa 56,240,48
 Mvaa 120,240,52
 Mvaa 184,240,56
 s_waitcnt lgkmcnt(6)
 T 204,225,16384
 T 206,225,24576
 T 208,230,16384
 T 210,230,24576
 Mvaa 40,244,48
 Mvaa 104,244,52
 Mvaa 60,248,48
 Mvaa 124,248,52
 T 212,226,16384
 T 214,226,24576
 T 216,231,16384
 T 218,231,24576
 Mvaa 188,248,56
 s_waitcnt lgkmcnt(8)
 Mvaa 44,252,48
 Mvaa 108,252,52
 Mvaa 16,192,60
 T 220,227,16384
 T 222,227,24576
 T 224,228,16640
 T 226,228,24832
 Mvaa 80,192,64
 Mvaa 144,192,68
 s_waitcnt lgkmcnt(8)
 Mvaa 0,196,60
 Mvaa 64,196,64
 Mvaa 20,200,60
 T 228,224,16640
 T 230,224,24832
 T 232,229,16640
 T 234,229,24832
 Mvaa 84,200,64
 Mvaa 148,200,68
 s_waitcnt lgkmcnt(4)
 Mvaa 4,204,60
 Mvaa 68,204,64
 T 236,225,16640
 T 238,225,24832
 T 240,230,16640
 T 242,230,24832
 Mvaa 24,208,60
 Mvaa 88,208,64
 Mvaa 152,208,68
 Mvaa 8,212,60
 T 244,226,16640
 T 246,226,24832
 T 248,231,16640
 T 250,231,24832
 Mvaa 72,212,64
 s_waitcnt lgkmcnt(8)
 Mvaa 28,216,60
 Mvaa 92,216,64
 Mvaa 156,216,68
 T 252,227,16640
 T 254,227,24832
 R 92,207,20480
 Mvaa 12,220,60
 Mvaa 76,220,64
 s_waitcnt lgkmcnt(7)
 Mvaa 48,224,60
 Mvaa 112,224,64
 Mvaa 176,224,68
 Mvaa 32,228,60
 Mvaa 96,228,64
 s_waitcnt lgkmcnt(0)
 s_barrier
 T 192,220,32768
 T 194,220,40960
 Mvaa 52,232,60
 Mvaa 116,232,64
 T 196,216,32768
 T 198,216,40960
 Mvaa 180,232,68
 Mvaa 36,236,60
 T 200,221,32768
 T 202,221,40960
 Mvaa 100,236,64
 Mvaa 56,240,60
 T 204,217,32768
 T 206,217,40960
 Mvaa 120,240,64
 Mvaa 184,240,68
 T 208,222,32768
 T 210,222,40960
 Mvaa 40,244,60
 Mvaa 104,244,64
 T 212,218,32768
 T 214,218,40960
 Mvaa 60,248,60
 Mvaa 124,248,64
 T 216,223,32768
 T 218,223,40960
 Mvaa 188,248,68
 s_waitcnt lgkmcnt(6)
 Mvaa 44,252,60
 T 220,219,32768
 T 222,219,40960
 Mvaa 108,252,64
 Mvaa 16,192,72
 T 224,220,33024
 T 226,220,41216
 Mvaa 80,192,76
 Mvaa 144,192,80
 T 228,216,33024
 T 230,216,41216
 Mvaa 0,196,72
 Mvaa 64,196,76
 s_waitcnt lgkmcnt(6)
 T 232,221,33024
 T 234,221,41216
 Mvaa 20,200,72
 Mvaa 84,200,76
 T 236,217,33024
 T 238,217,41216
 Mvaa 148,200,80
 Mvaa 4,204,72
 T 240,222,33024
 T 242,222,41216
 Mvaa 68,204,76
 s_waitcnt lgkmcnt(6)
 Mvaa 24,208,72
 T 244,218,33024
 T 246,218,41216
 Mvaa 88,208,76
 Mvaa 152,208,80
 T 248,223,33024
 T 250,223,41216
 Mvaa 8,212,72
 Mvaa 72,212,76
 T 252,219,33024
 T 254,219,41216
 Mvaa 28,216,72
 Mvaa 92,216,76
 Mvaa 156,216,80
 s_waitcnt lgkmcnt(4)
 Mvaa 12,220,72
 Mvaa 76,220,76
 Mvaa 48,224,72
 Mvaa 112,224,76
 Mvaa 176,224,80
 Mvaa 32,228,72
 Mvaa 96,228,76
 s_waitcnt lgkmcnt(0)
 s_barrier
 T 192,220,49152
 T 194,220,57344
 R 96,195,0
 Mvaa 52,232,72
 R 100,195,2048
 R 104,197,0
 Mvaa 116,232,76
 T 196,216,49152
 T 198,216,57344
 R 108,196,0
 Mvaa 180,232,80
 Mvaa 36,236,72
 T 200,221,49152
 T 202,221,57344
 R 112,196,2048
 Mvaa 100,236,76
 Mvaa 56,240,72
 Mvaa 120,240,76
 T 204,217,49152
 T 206,217,57344
 R 116,207,0
 Mvaa 184,240,80
 s_waitcnt lgkmcnt(9)
 Mvaa 40,244,72
 Mvaa 104,244,76
 T 208,222,49152
 T 210,222,57344
 T 212,218,49152
 T 214,218,57344
 Mvaa 60,248,72
 Mvaa 124,248,76
 Mvaa 188,248,80
 s_waitcnt lgkmcnt(7)
 T 216,223,49152
 T 218,223,57344
 Mvaa 44,252,72
 Mvaa 108,252,76
 T 220,219,49152
 T 222,219,57344
 Mvaa 16,192,84
 Mvaa 80,192,88
 T 224,220,49408
 T 226,220,57600
 Mvaa 144,192,92
 s_waitcnt lgkmcnt(6)
 T 228,216,49408
 T 230,216,57600
 Mvaa 0,196,84
 Mvaa 64,196,88
 T 232,221,49408
 T 234,221,57600
 Mvaa 20,200,84
 Mvaa 84,200,88
 T 236,217,49408
 T 238,217,57600
 Mvaa 148,200,92
 s_waitcnt lgkmcnt(8)
 Mvaa 4,204,84
 T 240,222,49408
 T 242,222,57600
 Mvaa 68,204,88
 Mvaa 24,208,84
 T 244,218,49408
 T 246,218,57600
 Mvaa 88,208,88
 Mvaa 152,208,92
 s_waitcnt lgkmcnt(6)
 T 248,223,49408
 T 250,223,57600
 Mvaa 8,212,84
 Mvaa 72,212,88
 T 252,219,49408
 T 254,219,57600
 Mvaa 28,216,84
 Mvaa 92,216,88
 Mvaa 156,216,92
 Mvaa 12,220,84
 Mvaa 76,220,88
 Mvaa 48,224,84
 s_add_u32 m0, s33, 16384
 Mvaa 112,224,88
 s_mov_b32 s32, 16384
 buffer_load_dwordx4 v244, s[12:15], s32 offen nt lds
 Mvaa 176,224,92
 buffer_load_dwordx4 v245, s[12:15], s32 offen offset:1024 nt lds
 Mvaa 32,228,84
 Mvaa 96,228,88
 s_waitcnt lgkmcnt(0)
 s_barrier
 T 192,228,0
 T 194,228,8192
 buffer_load_dwordx4 v246, s[12:15], s32 offen offset:2048 nt lds
 Mvaa 52,232,84
 Mvaa 116,232,88
 T 196,224,0
 T 198,224,8192
 buffer_load_dwordx4 v247, s[12:15], s32 offen offset:3072 nt lds
 Mvaa 180,232,92
 Mvaa 36,236,84
 s_add_u32 m0, s33, 24576
 T 200,229,0
 T 202,229,8192
 Mvaa 100,236,88
 Mvaa 56,240,84
 s_mov_b32 s32, 24576
 buffer_load_dwordx4 v244, s[12:15], s32 offen nt lds
 T 204,225,0
 T 206,225,8192
 Mvaa 120,240,88
 Mvaa 184,240,92
 buffer_load_dwordx4 v245, s[12:15], s32 offen offset:1024 nt lds
 T 208,230,0
 T 210,230,8192
 Mvaa 40,244,84
 Mvaa 104,244,88
 Mvaa 60,248,84
 buffer_load_dwordx4 v246, s[12:15], s32 offen offset:2048 nt lds
 buffer_load_dwordx4 v247, s[12:15], s32 offen offset:3072 nt lds
 Mvaa 124,248,88
 Mvaa 188,248,92
 Mvaa 44,252,84
 T 212,226,0
 T 214,226,8192
 T 216,231,0
 T 218,231,8192
 Mvaa 108,252,88
 s_waitcnt lgkmcnt(4)
 Mvaa 16,192,96
 Mvaa 80,192,100
 Mvaa 144,192,104
 T 220,227,0
 T 222,227,8192
 T 224,228,256
 T 226,228,8448
 Mvaa 0,196,96
 Mvaa 64,196,100
 Mvaa 20,200,96
 T 228,224,256
 T 230,224,8448
 T 232,229,256
 T 234,229,8448
 Mvaa 84,200,100
 Mvaa 148,200,104
 s_waitcnt lgkmcnt(8)
 Mvaa 4,204,96
 T 236,225,256
 T 238,225,8448
 T 240,230,256
 T 242,230,8448
 Mvaa 68,204,100
 s_waitcnt lgkmcnt(8)
 Mvaa 24,208,96
 Mvaa 88,208,100
 T 244,226,256
 T 246,226,8448
 Mvaa 152,208,104
 Mvaa 8,212,96
 T 248,231,256
 T 250,231,8448
 Mvaa 72,212,100
 s_waitcnt lgkmcnt(8)
 Mvaa 28,216,96
 T 252,227,256
 T 254,227,8448
 Mvaa 92,216,100
 Mvaa 156,216,104
 Mvaa 12,220,96
 Mvaa 76,220,100
 Mvaa 48,224,96
 s_add_u32 m0, s33, 32768
 Mvaa 112,224,100
 s_mov_b32 s32, 0
 buffer_load_dwordx4 v248, s[16:19], s32 offen nt lds
 Mvaa 176,224,104
 buffer_load_dwordx4 v249, s[16:19], s32 offen offset:1024 nt lds
 Mvaa 32,228,96
 Mvaa 96,228,100
 s_waitcnt lgkmcnt(0)
 s_barrier
 T 192,228,16384
 T 194,228,24576
 buffer_load_dwordx4 v250, s[16:19], s32 offen offset:2048 nt lds
 Mvaa 52,232,96
 R 120,195,20480
 R 124,195,22528
 Mvaa 116,232,100
 T 196,224,16384
 T 198,224,24576
 buffer_load_dwordx4 v251, s[16:19], s32 offen offset:3072 nt lds
 Mvaa 180,232,104
 Mvaa 36,236,96
 s_add_u32 m0, s33, 40960
 Mvaa 100,236,100
 Mvaa 56,240,96
 s_mov_b32 s32, 8192
 T 200,229,16384
 T 202,229,24576
 buffer_load_dwordx4 v248, s[16:19], s32 offen nt lds
 Mvaa 120,240,100
 Mvaa 184,240,104
 Mvaa 40,244,96
 T 204,225,16384
 T 206,225,24576
 buffer_load_dwordx4 v249, s[16:19], s32 offen offset:1024 nt lds
 Mvaa 104,244,100
 Mvaa 60,248,96
 Mvaa 124,248,100
 T 208,230,16384
 T 210,230,24576
 buffer_load_dwordx4 v250, s[16:19], s32 offen offset:2048 nt lds
 Mvaa 188,248,104
 s_waitcnt lgkmcnt(4)
 Mvaa 44,252,96
 Mvaa 108,252,100
 buffer_load_dwordx4 v251, s[16:19], s32 offen offset:3072 nt lds
 T 212,226,16384
 T 214,226,24576
 Mvaa 16,192,108
 Mvaa 80,192,112
 Mvaa 144,192,116
 Mvaa 0,196,108
 T 216,231,16384
 T 218,231,24576
 T 220,227,16384
 T 222,227,24576
 Mvaa 64,196,112
 Mvaa 20,200,108
 Mvaa 84,200,112
 Mvaa 148,200,116
 s_waitcnt lgkmcnt(4)
 T 224,228,16640
 T 226,228,24832
 T 228,224,16640
 T 230,224,24832
 Mvaa 4,204,108
 Mvaa 68,204,112
 Mvaa 24,208,108
 Mvaa 88,208,112
 T 232,229,16640
 T 234,229,24832
 T 236,225,16640
 T 238,225,24832
 Mvaa 152,208,116
 s_waitcnt lgkmcnt(8)
 Mvaa 8,212,108
 Mvaa 72,212,112
 Mvaa 28,216,108
 T 240,230,16640
 T 242,230,24832
 T 244,226,16640
 T 246,226,24832
 Mvaa 92,216,112
 Mvaa 156,216,116
 s_waitcnt lgkmcnt(8)
 T 248,231,16640
 T 250,231,24832
 T 252,227,16640
 T 254,227,24832
 R 128,197,20480
 R 132,196,20480
 R 136,196,22528
 s_waitcnt lgkmcnt(14)
 R 140,207,20480
 Mvaa 12,220,108
 Mvaa 76,220,112
 s_waitcnt lgkmcnt(12)
 Mvaa 48,224,108
 Mvaa 112,224,112
 Mvaa 176,224,116
 s_waitcnt lgkmcnt(8)
 Mvaa 32,228,108
 Mvaa 96,228,112
 s_waitcnt lgkmcnt(0)
 s_barrier
 Mvaa 52,232,108
 Mvaa 116,232,112
 T 192,220,32768
 T 194,220,40960
 T 196,216,32768
 T 198,216,40960
 Mvaa 180,232,116
 Mvaa 36,236,108
 Mvaa 100,236,112
 Mvaa 56,240,108
 T 200,221,32768
 T 202,221,40960
 T 204,217,32768
 T 206,217,40960
 Mvaa 120,240,112
 Mvaa 184,240,116
 Mvaa 40,244,108
 Mvaa 104,244,112
 T 208,222,32768
 T 210,222,40960
 T 212,218,32768
 T 214,218,40960
 Mvaa 60,248,108
 Mvaa 124,248,112
 Mvaa 188,248,116
 s_waitcnt lgkmcnt(4)
 Mvaa 44,252,108
 T 216,223,32768
 T 218,223,40960
 T 220,219,32768
 T 222,219,40960
 Mvaa 108,252,112
 Mvaa 16,192,120
 Mvaa 80,192,124
 Mvaa 144,192,128
 T 224,220,33024
 T 226,220,41216
 T 228,216,33024
 T 230,216,41216
 Mvaa 0,196,120
 Mvaa 64,196,124
 s_waitcnt lgkmcnt(8)
 Mvaa 20,200,120
 Mvaa 84,200,124
 T 232,221,33024
 T 234,221,41216
 T 236,217,33024
 T 238,217,41216
 Mvaa 148,200,128
 s_waitcnt lgkmcnt(8)
 Mvaa 4,204,120
 Mvaa 68,204,124
 Mvaa 24,208,120
 T 240,222,33024
 T 242,222,41216
 T 244,218,33024
 T 246,218,41216
 Mvaa 88,208,124
 Mvaa 152,208,128
 s_waitcnt lgkmcnt(8)
 Mvaa 8,212,120
 Mvaa 72,212,124
 T 248,223,33024
 T 250,223,41216
 T 252,219,33024
 T 254,219,41216
 Mvaa 28,216,120
 Mvaa 92,216,124
 Mvaa 156,216,128
 s_waitcnt lgkmcnt(4)
 Mvaa 12,220,120
 Mvaa 76,220,124
 Mvaa 48,224,120
 Mvaa 112,224,124
 Mvaa 176,224,128
 Mvaa 32,228,120
 Mvaa 96,228,124
 s_waitcnt lgkmcnt(0)
 s_barrier
 T 192,220,49152
 T 194,220,57344
 R 144,195,0
 Mvaa 52,232,120
 R 148,195,2048
 R 152,197,0
 Mvaa 116,232,124
 T 196,216,49152
 T 198,216,57344
 R 156,196,0
 Mvaa 180,232,128
 Mvaa 36,236,120
 T 200,221,49152
 T 202,221,57344
 R 160,196,2048
 Mvaa 100,236,124
 Mvaa 56,240,120
 Mvaa 120,240,124
 T 204,217,49152
 T 206,217,57344
 R 164,207,0
 Mvaa 184,240,128
 s_waitcnt lgkmcnt(9)
 Mvaa 40,244,120
 Mvaa 104,244,124
 T 208,222,49152
 T 210,222,57344
 T 212,218,49152
 T 214,218,57344
 Mvaa 60,248,120
 Mvaa 124,248,124
 Mvaa 188,248,128
 s_waitcnt lgkmcnt(7)
 Mvaa 44,252,120
 T 216,223,49152
 T 218,223,57344
 T 220,219,49152
 T 222,219,57344
 Mvaa 108,252,124
 s_waitcnt lgkmcnt(8)
 Mvaa 16,192,132
 Mvaa 80,192,136
 Mvaa 144,192,140
 T 224,220,49408
 T 226,220,57600
 T 228,216,49408
 T 230,216,57600
 Mvaa 0,196,132
 Mvaa 64,196,136
 s_waitcnt lgkmcnt(8)
 Mvaa 20,200,132
 T 232,221,49408
 T 234,221,57600
 Mvaa 84,200,136
 Mvaa 148,200,140
 T 236,217,49408
 T 238,217,57600
 Mvaa 4,204,132
 Mvaa 68,204,136
 s_waitcnt lgkmcnt(4)
 T 240,222,49408
 T 242,222,57600
 Mvaa 24,208,132
 Mvaa 88,208,136
 T 244,218,49408
 T 246,218,57600
 Mvaa 152,208,140
 T 248,223,49408
 T 250,223,57600
 Mvaa 8,212,132
 Mvaa 72,212,136
 T 252,219,49408
 T 254,219,57600
 Mvaa 28,216,132
 Mvaa 92,216,136
 Mvaa 156,216,140
 s_waitcnt lgkmcnt(6)
 Mvaa 12,220,132
 Mvaa 76,220,136
 Mvaa 48,224,132
 Mvaa 112,224,136
 Mvaa 176,224,140
 Mvaa 32,228,132
 Mvaa 96,228,136
 s_waitcnt lgkmcnt(0)
 s_barrier
 T 192,228,0
 T 194,228,8192
 Mvaa 52,232,132
 s_add_u32 m0, s33, 49152
 Mvaa 116,232,136
 s_mov_b32 s32, 16384
 buffer_load_dwordx4 v248, s[16:19], s32 offen nt lds
 T 196,224,0
 T 198,224,8192
 Mvaa 180,232,140
 buffer_load_dwordx4 v249, s[16:19], s32 offen offset:1024 nt lds
 Mvaa 36,236,132
 T 200,229,0
 T 202,229,8192
 buffer_load_dwordx4 v250, s[16:19], s32 offen offset:2048 nt lds
 Mvaa 100,236,136
 Mvaa 56,240,132
 Mvaa 120,240,136
 Mvaa 184,240,140
 T 204,225,0
 T 206,225,8192
 buffer_load_dwordx4 v251, s[16:19], s32 offen offset:3072 nt lds
 Mvaa 40,244,132
 s_add_u32 m0, s33, 57344
 Mvaa 104,244,136
 Mvaa 60,248,132
 s_mov_b32 s32, 24576
 T 208,230,0
 T 210,230,8192
 buffer_load_dwordx4 v248, s[16:19], s32 offen nt lds
 Mvaa 124,248,136
 Mvaa 188,248,140
 Mvaa 44,252,132
 Mvaa 108,252,136
 s_waitcnt lgkmcnt(2)
 buffer_load_dwordx4 v249, s[16:19], s32 offen offset:1024 nt lds
 T 212,226,0
 T 214,226,8192
 Mvaa 16,192,144
 Mvaa 80,192,148
 buffer_load_dwordx4 v250, s[16:19], s32 offen offset:2048 nt lds
 T 216,231,0
 T 218,231,8192
 Mvaa 144,192,152
 buffer_load_dwordx4 v251, s[16:19], s32 offen offset:3072 nt lds
 T 220,227,0
 T 222,227,8192
 Mvaa 0,196,144
 Mvaa 64,196,148
 T 224,228,256
 T 226,228,8448
 T 228,224,256
 T 230,224,8448
 Mvaa 20,200,144
 T 232,229,256
 T 234,229,8448
 Mvaa 84,200,148
 T 236,225,256
 s_waitcnt lgkmcnt(14)
 T 238,225,8448
 Mvaa 148,200,152
 s_waitcnt lgkmcnt(12)
 Mvaa 4,204,144
 T 240,230,256
 T 242,230,8448
 Mvaa 68,204,148
 s_waitcnt lgkmcnt(10)
 Mvaa 24,208,144
 T 244,226,256
 T 246,226,8448
 Mvaa 88,208,148
 Mvaa 152,208,152
 s_waitcnt lgkmcnt(6)
 T 248,231,256
 T 250,231,8448
 Mvaa 8,212,144
 Mvaa 72,212,148
 T 252,227,256
 T 254,227,8448
 Mvaa 28,216,144
 Mvaa 92,216,148
 Mvaa 156,216,152
 Mvaa 12,220,144
 Mvaa 76,220,148
 Mvaa 48,224,144
 Mvaa 112,224,148
 Mvaa 176,224,152
 Mvaa 32,228,144
 Mvaa 96,228,148
 s_waitcnt lgkmcnt(0)
 s_barrier
 T 192,228,16384
 T 194,228,24576
 Mvaa 52,232,144
 Mvaa 116,232,148
 T 196,229,16384
 T 198,229,24576
 Mvaa 180,232,152
 Mvaa 36,236,144
 T 200,230,16384
 T 202,230,24576
 Mvaa 100,236,148
 Mvaa 56,240,144
 T 204,231,16384
 T 206,231,24576
 Mvaa 120,240,148
 Mvaa 184,240,152
 T 208,228,16640
 T 210,228,24832
 Mvaa 40,244,144
 Mvaa 104,244,148
 T 212,229,16640
 T 214,229,24832
 Mvaa 60,248,144
 Mvaa 124,248,148
 T 216,230,16640
 T 218,230,24832
 Mvaa 188,248,152
 s_waitcnt lgkmcnt(6)
 Mvaa 44,252,144
 T 220,231,16640
 T 222,231,24832
 Mvaa 108,252,148
 Mvaa 16,192,156
 T 224,224,16384
 T 226,224,24576
 Mvaa 80,192,160
 Mvaa 144,192,164
 T 228,225,16384
 T 230,225,24576
 Mvaa 20,196,156
 Mvaa 84,196,160
 T 232,226,16384
 T 234,226,24576
 Mvaa 148,196,164
 s_waitcnt lgkmcnt(6)
 Mvaa 24,200,156
 T 236,227,16384
 T 238,227,24576
 Mvaa 88,200,160
 Mvaa 152,200,164
 T 240,224,16640
 T 242,224,24832
 Mvaa 28,204,156
 v_mul_f32 v144, s34, v144
 v_mul_f32 v145, s34, v145
 Mvaa 92,204,160
 T 244,225,16640
 T 246,225,24832
 Mvaa 156,204,164
 s_waitcnt lgkmcnt(6)
 v_mul_f32 v146, s34, v146
 v_mul_f32 v147, s34, v147
 Mvaa 48,208,156
 T 248,226,16640
 T 250,226,24832
 Mvaa 112,208,160
 v_mul_f32 v148, s34, v148
 v_mul_f32 v149, s34, v149
 Mvaa 176,208,164
 T 252,227,16640
 T 254,227,24832
 Mvaa 52,212,156
 v_mul_f32 v150, s34, v150
 v_mul_f32 v151, s34, v151
 Mvaa 116,212,160
 CV 144,144,145
 CV 145,146,147
 Mvaa 180,212,164
 CV 146,148,149
 CV 147,150,151
 Mvaa 56,216,156
 v_mul_f32 v152, s34, v152
 v_mul_f32 v153, s34, v153
 Mvaa 120,216,160
 v_mul_f32 v154, s34, v154
 v_mul_f32 v155, s34, v155
 Mvaa 184,216,164
 v_mul_f32 v156, s34, v156
 v_mul_f32 v157, s34, v157
 Mvaa 60,220,156
 v_mul_f32 v158, s34, v158
 v_mul_f32 v159, s34, v159
 Mvaa 124,220,160
 CV 152,152,153
 CV 153,154,155
 Mvaa 188,220,164
 CV 154,156,157
 CV 155,158,159
 Mvaa 0,224,156
 s_add_u32 m0, s33, 114688
 v_mul_f32 v176, s34, v176
 v_mul_f32 v177, s34, v177
 Mvaa 64,224,160
 v_mul_f32 v178, s34, v178
 v_mul_f32 v179, s34, v179
 Mvaa 4,228,156
 s_mov_b32 s32, 32768
 v_mul_f32 v180, s34, v180
 v_mul_f32 v181, s34, v181
 Mvaa 68,228,160
 s_waitcnt lgkmcnt(0)
 s_barrier
 v_mul_f32 v182, s34, v182
 Mvaa 8,232,156
 v_mul_f32 v183, s34, v183
 CV 176,176,177
 CV 177,178,179
 CV 178,180,181
 CV 179,182,183
 v_mul_f32 v184, s34, v184
 v_mul_f32 v185, s34, v185
 v_mul_f32 v186, s34, v186
 v_mul_f32 v187, s34, v187
 v_mul_f32 v188, s34, v188
 v_mul_f32 v189, s34, v189
 v_mul_f32 v190, s34, v190
 v_mul_f32 v191, s34, v191
 CV 184,184,185
 CV 185,186,187
 CV 186,188,189
 CV 187,190,191
 Mvaa 72,232,160
 v_permlane16_swap_b32 v144, v146
 v_permlane16_swap_b32 v145, v147
 v_permlane16_swap_b32 v152, v154
 v_permlane16_swap_b32 v153, v155
 v_permlane16_swap_b32 v176, v178
 v_permlane16_swap_b32 v177, v179
 v_permlane16_swap_b32 v184, v186
 v_permlane16_swap_b32 v185, v187
 Mvaa 12,236,156
 R 192,234,8192
 v_mul_f32 v16, s34, v16
 Mvaa 76,236,160
 ds_write_b128 v202, v[144:147]
 ds_write_b128 v202, v[152:155] offset:1024
 ds_write_b128 v202, v[176:179] offset:2048
 ds_write_b128 v202, v[184:187] offset:3072
 Mvaa 32,240,156
 buffer_load_dwordx4 v248, s[16:19], s32 offen nt lds
 Mvaa 96,240,160
 s_waitcnt lgkmcnt(0)
 s_barrier
 R 196,234,0
 Mvaa 36,244,156
 buffer_load_dwordx4 v249, s[16:19], s32 offen offset:1024 nt lds
 Mvaa 100,244,160
 R 200,235,8192
 v_mul_f32 v17, s34, v17
 Mvaa 40,248,156
 buffer_load_dwordx4 v250, s[16:19], s32 offen offset:2048 nt lds
 Mvaa 104,248,160
 v_mul_f32 v18, s34, v18
 v_mul_f32 v19, s34, v19
 v_mul_f32 v20, s34, v20
 v_mul_f32 v21, s34, v21
 v_mul_f32 v22, s34, v22
 v_mul_f32 v23, s34, v23
 CV 16,16,17
 CV 17,18,19
 CV 18,20,21
 CV 19,22,23
 v_mul_f32 v80, s34, v80
 v_mul_f32 v81, s34, v81
 v_mul_f32 v82, s34, v82
 v_mul_f32 v83, s34, v83
 v_mul_f32 v84, s34, v84
 v_mul_f32 v85, s34, v85
 v_mul_f32 v86, s34, v86
 v_mul_f32 v87, s34, v87
 CV 80,80,81
 CV 81,82,83
 CV 82,84,85
 CV 83,86,87
 v_mul_f32 v24, s34, v24
 v_mul_f32 v25, s34, v25
 v_mul_f32 v26, s34, v26
 v_mul_f32 v27, s34, v27
 v_mul_f32 v28, s34, v28
 v_mul_f32 v29, s34, v29
 v_mul_f32 v30, s34, v30
 v_mul_f32 v31, s34, v31
 CV 24,24,25
 CV 25,26,27
 CV 26,28,29
 CV 27,30,31
 v_mul_f32 v88, s34, v88
 v_mul_f32 v89, s34, v89
 v_mul_f32 v90, s34, v90
 v_mul_f32 v91, s34, v91
 v_mul_f32 v92, s34, v92
 v_mul_f32 v93, s34, v93
 v_mul_f32 v94, s34, v94
 v_mul_f32 v95, s34, v95
 CV 88,88,89
 CV 89,90,91
 CV 90,92,93
 CV 91,94,95
 Mvaa 44,252,156
 v_permlane16_swap_b32 v16, v18
 v_permlane16_swap_b32 v17, v19
 v_permlane16_swap_b32 v80, v82
 v_permlane16_swap_b32 v81, v83
 v_permlane16_swap_b32 v24, v26
 v_permlane16_swap_b32 v25, v27
 v_permlane16_swap_b32 v88, v90
 v_permlane16_swap_b32 v89, v91
 Mvaa 108,252,160
 buffer_load_dwordx4 v251, s[16:19], s32 offen offset:3072 nt lds
 R 204,235,0
 Mvavz 28,192,16
 s_add_u32 m0, s33, 122880
 s_mov_b32 s32, 40960
 R 208,234,8448
 Mvavz 92,192,80
 buffer_load_dwordx4 v248, s[16:19], s32 offen nt lds
 Mvavz 156,192,144
 s_waitcnt lgkmcnt(2)
 buffer_load_dwordx4 v249, s[16:19], s32 offen offset:1024 nt lds
 Mvavz 20,196,16
 buffer_load_dwordx4 v250, s[16:19], s32 offen offset:2048 nt lds
 Mvavz 84,196,80
 R 212,234,256
 v_mul_f32 v48, s34, v48
 Mvavz 148,196,144
 buffer_load_dwordx4 v251, s[16:19], s32 offen offset:3072 nt lds
 Mvav 28,200,24
 R 216,235,8448
 v_mul_f32 v49, s34, v49
 Mvav 92,200,88
 v_mul_f32 v50, s34, v50
 v_mul_f32 v51, s34, v51
 Mvav 156,200,152
 s_waitcnt lgkmcnt(2)
 v_mul_f32 v52, s34, v52
 v_mul_f32 v53, s34, v53
 Mvav 20,204,24
 v_mul_f32 v54, s34, v54
 v_mul_f32 v55, s34, v55
 CV 48,48,49
 CV 49,50,51
 CV 50,52,53
 CV 51,54,55
 v_mul_f32 v112, s34, v112
 v_mul_f32 v113, s34, v113
 v_mul_f32 v114, s34, v114
 v_mul_f32 v115, s34, v115
 v_mul_f32 v116, s34, v116
 v_mul_f32 v117, s34, v117
 v_mul_f32 v118, s34, v118
 v_mul_f32 v119, s34, v119
 CV 112,112,113
 CV 113,114,115
 CV 114,116,117
 CV 115,118,119
 Mvav 84,204,88
 v_permlane16_swap_b32 v48, v50
 v_permlane16_swap_b32 v49, v51
 v_permlane16_swap_b32 v112, v114
 v_permlane16_swap_b32 v113, v115
 Mvav 148,204,152
 R 220,235,256
 v_mul_f32 v56, s34, v56
 Mvav 28,208,48
 R 224,232,8192
 v_mul_f32 v57, s34, v57
 Mvav 92,208,112
 ds_read_b128 v[128:131], v203
 v_mul_f32 v58, s34, v58
 Mvav 156,208,176
 s_waitcnt lgkmcnt(3)
 v_mul_f32 v59, s34, v59
 v_mul_f32 v60, s34, v60
 Mvav 20,212,48
 v_mul_f32 v61, s34, v61
 v_mul_f32 v62, s34, v62
 v_mul_f32 v63, s34, v63
 CV 56,56,57
 CV 57,58,59
 CV 58,60,61
 CV 59,62,63
 v_mul_f32 v120, s34, v120
 v_mul_f32 v121, s34, v121
 v_mul_f32 v122, s34, v122
 v_mul_f32 v123, s34, v123
 v_mul_f32 v124, s34, v124
 v_mul_f32 v125, s34, v125
 v_mul_f32 v126, s34, v126
 v_mul_f32 v127, s34, v127
 CV 120,120,121
 CV 121,122,123
 CV 122,124,125
 CV 123,126,127
 Mvav 84,212,112
 v_permlane16_swap_b32 v56, v58
 v_permlane16_swap_b32 v57, v59
 v_permlane16_swap_b32 v120, v122
 v_permlane16_swap_b32 v121, v123
 Mvav 148,212,176
 R 228,232,0
 v_mul_f32 v0, s34, v0
 Mvav 28,216,56
 R 232,233,8192
 v_mul_f32 v1, s34, v1
 Mvav 92,216,120
 ds_read_b128 v[136:139], v203 offset:1024
 v_mul_f32 v2, s34, v2
 Mvav 156,216,184
 s_waitcnt lgkmcnt(3)
 v_mul_f32 v3, s34, v3
 v_mul_f32 v4, s34, v4
 Mvav 20,220,56
 v_mul_f32 v5, s34, v5
 v_mul_f32 v6, s34, v6
 v_mul_f32 v7, s34, v7
 CV 0,0,1
 CV 1,2,3
 CV 2,4,5
 CV 3,6,7
 v_mul_f32 v64, s34, v64
 v_mul_f32 v65, s34, v65
 v_mul_f32 v66, s34, v66
 v_mul_f32 v67, s34, v67
 v_mul_f32 v68, s34, v68
 v_mul_f32 v69, s34, v69
 v_mul_f32 v70, s34, v70
 v_mul_f32 v71, s34, v71
 CV 64,64,65
 CV 65,66,67
 CV 66,68,69
 CV 67,70,71
 Mvav 84,220,120
 R 236,233,0
 R 240,232,8448
 R 244,232,256
 R 248,233,8448
 R 252,233,256
 ds_read_b128 v[160:163], v203 offset:2048
 ds_read_b128 v[168:171], v203 offset:3072
 v_permlane16_swap_b32 v0, v2
 v_permlane16_swap_b32 v1, v3
 v_permlane16_swap_b32 v64, v66
 v_permlane16_swap_b32 v65, v67
 Mvav 148,220,184
 v_mul_f32 v8, s34, v8
 v_mul_f32 v9, s34, v9
 Mvav 28,224,0
 v_mul_f32 v10, s34, v10
 v_mul_f32 v11, s34, v11
 Mvav 92,224,64
 v_mul_f32 v12, s34, v12
 v_mul_f32 v13, s34, v13
 Mvav 156,224,128
 s_waitcnt lgkmcnt(7)
 v_mul_f32 v14, s34, v14
 v_mul_f32 v15, s34, v15
 Mvav 20,228,0
 CV 8,8,9
 CV 9,10,11
 CV 10,12,13
 CV 11,14,15
 v_mul_f32 v72, s34, v72
 v_mul_f32 v73, s34, v73
 v_mul_f32 v74, s34, v74
 v_mul_f32 v75, s34, v75
 v_mul_f32 v76, s34, v76
 v_mul_f32 v77, s34, v77
 v_mul_f32 v78, s34, v78
 v_mul_f32 v79, s34, v79
 CV 72,72,73
 CV 73,74,75
 CV 74,76,77
 CV 75,78,79
 Mvav 84,228,64
 v_permlane16_swap_b32 v8, v10
 v_permlane16_swap_b32 v9, v11
 v_permlane16_swap_b32 v72, v74
 v_permlane16_swap_b32 v73, v75
 Mvav 148,228,128
 s_waitcnt vmcnt(24) lgkmcnt(0)
 s_barrier
 v_mul_f32 v32, s34, v32
 Mvav 28,232,8
 v_mul_f32 v33, s34, v33
 v_mul_f32 v34, s34, v34
 Mvav 92,232,72
 v_mul_f32 v35, s34, v35
 v_mul_f32 v36, s34, v36
 Mvav 156,232,136
 v_mul_f32 v37, s34, v37
 v_mul_f32 v38, s34, v38
 Mvav 20,236,8
 v_mul_f32 v39, s34, v39
 CV 32,32,33
 CV 33,34,35
 CV 34,36,37
 CV 35,38,39
 v_mul_f32 v96, s34, v96
 v_mul_f32 v97, s34, v97
 v_mul_f32 v98, s34, v98
 v_mul_f32 v99, s34, v99
 v_mul_f32 v100, s34, v100
 v_mul_f32 v101, s34, v101
 v_mul_f32 v102, s34, v102
 v_mul_f32 v103, s34, v103
 CV 96,96,97
 CV 97,98,99
 CV 98,100,101
 CV 99,102,103
 Mvav 84,236,72
 v_permlane16_swap_b32 v32, v34
 v_permlane16_swap_b32 v33, v35
 v_permlane16_swap_b32 v96, v98
 v_permlane16_swap_b32 v97, v99
 Mvav 148,236,136
 R 192,234,24576
 v_mul_f32 v40, s34, v40
 Mvav 28,240,32
 s_add_u32 m0, s33, 147456
 v_mul_f32 v41, s34, v41
 v_mul_f32 v42, s34, v42
 Mvav 92,240,96
 s_mov_b32 s32, 49152
 v_mul_f32 v43, s34, v43
 v_mul_f32 v44, s34, v44
 Mvav 156,240,160
 v_mul_f32 v45, s34, v45
 v_mul_f32 v46, s34, v46
 Mvav 20,244,32
 v_mul_f32 v47, s34, v47
 CV 40,40,41
 CV 41,42,43
 CV 42,44,45
 CV 43,46,47
 v_mul_f32 v104, s34, v104
 v_mul_f32 v105, s34, v105
 v_mul_f32 v106, s34, v106
 v_mul_f32 v107, s34, v107
 v_mul_f32 v108, s34, v108
 v_mul_f32 v109, s34, v109
 v_mul_f32 v110, s34, v110
 v_mul_f32 v111, s34, v111
 CV 104,104,105
 CV 105,106,107
 CV 106,108,109
 CV 107,110,111
 Mvav 84,244,96
 v_permlane16_swap_b32 v40, v42
 v_permlane16_swap_b32 v41, v43
 v_permlane16_swap_b32 v104, v106
 v_permlane16_swap_b32 v105, v107
 Mvav 148,244,160
 R 196,234,16384
 Mvav 28,248,40
 R 200,235,24576
 Mvav 92,248,104
 buffer_load_dwordx4 v248, s[16:19], s32 offen nt lds
 Mvav 156,248,168
 R 204,235,16384
 Mvav 20,252,40
 buffer_load_dwordx4 v249, s[16:19], s32 offen offset:1024 nt lds
 Mvav 84,252,104
 R 208,234,24832
 Mvav 148,252,168
 s_cmp_eq_u32 s37, 0
 s_cbranch_scc1 LE1_maxpass
LE1_maxback:
 s_waitcnt lgkmcnt(4)
 R 212,234,16640
 Mvavz 60,192,16
 buffer_load_dwordx4 v250, s[16:19], s32 offen offset:2048 nt lds
 Mvavz 124,192,80
 buffer_load_dwordx4 v251, s[16:19], s32 offen offset:3072 nt lds
 Mvavz 188,192,144
 s_waitcnt lgkmcnt(3)
 s_add_u32 m0, s33, 155648
 s_mov_b32 s32, 57344
 Mvavz 52,196,16
 buffer_load_dwordx4 v248, s[16:19], s32 offen nt lds
 Mvavz 116,196,80
 R 216,235,24832
 v_max3_f32 v192, v192, v20, v21
 Mvav 60,200,24
 buffer_load_dwordx4 v249, s[16:19], s32 offen offset:1024 nt lds
 Mvav 124,200,88
 R 220,235,16640
 v_max3_f32 v192, v192, v22, v23
 Mvav 188,200,152
 s_waitcnt lgkmcnt(2)
 buffer_load_dwordx4 v250, s[16:19], s32 offen offset:2048 nt lds
 Mvav 52,204,24
 R 224,232,24576
 v_max3_f32 v192, v192, v28, v29
 Mvav 116,204,88
 buffer_load_dwordx4 v251, s[16:19], s32 offen offset:3072 nt lds
 Mvav 60,208,48
 R 228,232,16384
 v_max3_f32 v192, v192, v30, v31
 Mvav 124,208,112
 R 232,233,24576
 v_mov_b32 v198, v192
 Mvav 188,208,176
 R 236,233,16384
 v_max3_f32 v193, v193, v84, v85
 Mvav 52,212,48
 R 240,232,24832
 v_max3_f32 v193, v193, v86, v87
 Mvav 116,212,112
 s_waitcnt lgkmcnt(5)
 R 244,232,16640
 v_max3_f32 v193, v193, v92, v93
 Mvav 60,216,56
 R 248,233,24832
 v_max3_f32 v193, v193, v94, v95
 Mvav 124,216,120
 R 252,233,16640
 v_mov_b32 v199, v193
 Mvav 188,216,184
 v_max3_f32 v194, v194, v148, v149
 v_max3_f32 v194, v194, v150, v151
 Mvav 52,220,56
 v_max3_f32 v194, v194, v156, v157
 v_max3_f32 v194, v194, v158, v159
 Mvav 116,220,120
 s_waitcnt lgkmcnt(4)
 v_mov_b32 v200, v194
 v_permlane16_swap_b32 v192, v198
 Mvav 60,224,0
 v_max_f32 v192, v192, v198
 v_mov_b32 v198, v192
 Mvav 124,224,64
 v_permlane16_swap_b32 v193, v199
 v_max_f32 v193, v193, v199
 Mvav 188,224,128
 v_mov_b32 v199, v193
 v_permlane16_swap_b32 v194, v200
 Mvav 52,228,0
 v_max_f32 v194, v194, v200
 v_mov_b32 v200, v194
 Mvav 116,228,64
 s_waitcnt vmcnt(24) lgkmcnt(0)
 s_barrier
 T 192,212,32768
 Mvav 60,232,8
 T 194,212,40960
 v_permlane32_swap_b32 v192, v198
 Mvav 124,232,72
 T 196,208,32768
 T 198,208,40960
 Mvav 188,232,136
 v_max_f32 v192, v192, v198
 v_sub_f32 v36, 0, v192
 Mvav 52,236,8
 T 200,213,32768
 T 202,213,40960
 Mvav 116,236,72
 v_permlane32_swap_b32 v193, v199
 v_max_f32 v193, v193, v199
 Mvav 60,240,32
 v_sub_f32 v100, 0, v193
 v_permlane32_swap_b32 v194, v200
 Mvav 124,240,96
 v_max_f32 v194, v194, v200
 v_sub_f32 v164, 0, v194
 Mvav 188,240,160
 v_add_f32 v148, v148, v164
 v_add_f32 v149, v149, v164
 Mvav 52,244,32
 EX 148
 Mvav 116,244,96
 EX 149
 Mvav 60,248,40
 v_add_f32 v150, v150, v164
 v_add_f32 v151, v151, v164
 Mvav 124,248,104
 EX 150
 Mvav 188,248,168
 v_add_f32 v156, v156, v164
 v_add_f32 v157, v157, v164
 v_add_f32 v158, v158, v164
 v_add_f32 v159, v159, v164
 v_add_f32 v20, v20, v36
 v_add_f32 v21, v21, v36
 v_add_f32 v22, v22, v36
 v_add_f32 v23, v23, v36
 v_add_f32 v28, v28, v36
 v_add_f32 v29, v29, v36
 v_add_f32 v30, v30, v36
 v_add_f32 v31, v31, v36
 v_add_f32 v84, v84, v100
 v_add_f32 v85, v85, v100
 v_add_f32 v86, v86, v100
 v_add_f32 v87, v87, v100
 v_add_f32 v92, v92, v100
 v_add_f32 v93, v93, v100
 v_add_f32 v94, v94, v100
 v_add_f32 v95, v95, v100
 EX 151
 EX 156
 EX 157
 EX 158
 EX 159
 EX 20
 EX 21
 EX 22
 EX 23
 EX 28
 EX 29
 EX 30
 EX 31
 EX 84
 EX 85
 EX 86
 EX 87
 EX 92
 EX 93
 EX 94
 EX 95
 Mvav 52,252,40
 T 204,209,32768
 T 206,209,40960
 CV 132,148,149
 CV 133,150,151
 CV 134,156,157
 CV 135,158,159
 CV 4,20,21
 CV 5,22,23
 CV 6,28,29
 CV 7,30,31
 CV 68,84,85
 CV 69,86,87
 CV 70,92,93
 CV 71,94,95
 Mvav 116,252,104
 s_waitcnt lgkmcnt(2)
 T 208,214,32768
 T 210,214,40960
 Maavz 16,192,4
 s_add_u32 m0, s33, 16384
 T 212,210,32768
 T 214,210,40960
 Maavz 80,192,68
 s_mov_b32 s32, 65536
 T 216,215,32768
 T 218,215,40960
 Maavz 144,192,132
 T 220,211,32768
 T 222,211,40960
 Maavz 0,196,4
 buffer_load_dwordx4 v248, s[16:19], s32 offen nt lds
 Maavz 64,196,68
 T 224,212,33024
 T 226,212,41216
 Maavz 20,200,4
 buffer_load_dwordx4 v249, s[16:19], s32 offen offset:1024 nt lds
 Maavz 84,200,68
 buffer_load_dwordx4 v250, s[16:19], s32 offen offset:2048 nt lds
 Maavz 148,200,132
 s_waitcnt lgkmcnt(6)
 T 228,208,33024
 T 230,208,41216
 Maavz 4,204,4
 buffer_load_dwordx4 v251, s[16:19], s32 offen offset:3072 nt lds
 Maavz 68,204,68
 T 232,213,33024
 T 234,213,41216
 Maavz 24,208,4
 s_add_u32 m0, s33, 24576
 T 236,209,33024
 T 238,209,41216
 Maavz 88,208,68
 s_mov_b32 s32, 73728
 buffer_load_dwordx4 v248, s[16:19], s32 offen nt lds
 Maavz 152,208,132
 s_waitcnt lgkmcnt(6)
 T 240,214,33024
 T 242,214,41216
 Maavz 8,212,4
 T 244,210,33024
 T 246,210,41216
 Maavz 72,212,68
 T 248,215,33024
 T 250,215,41216
 Maavz 28,216,4
 T 252,211,33024
 T 254,211,41216
 Maavz 92,216,68
 buffer_load_dwordx4 v249, s[16:19], s32 offen offset:1024 nt lds
 Maavz 156,216,132
 s_waitcnt lgkmcnt(8)
 buffer_load_dwordx4 v250, s[16:19], s32 offen offset:2048 nt lds
 Maavz 12,220,4
 buffer_load_dwordx4 v251, s[16:19], s32 offen offset:3072 nt lds
 Maavz 76,220,68
 v_mov_b32 v195, v20
 v_mov_b32 v196, v84
 Maavz 48,224,4
 v_add_f32 v195, v195, v21
 v_add_f32 v196, v196, v85
 Maavz 112,224,68
 v_add_f32 v195, v195, v22
 v_add_f32 v196, v196, v86
 Maavz 176,224,132
 v_add_f32 v195, v195, v23
 v_add_f32 v196, v196, v87
 Maavz 32,228,4
 v_mov_b32 v197, v156
 v_add_f32 v195, v195, v28
 Maavz 96,228,68
 s_waitcnt lgkmcnt(0)
 s_barrier
 R 192,238,40960
 Maavz 52,232,4
 v_add_f32 v196, v196, v92
 v_sub_f32 v37, 0, v192
 Maavz 116,232,68
 R 196,238,32768
 v_sub_f32 v38, 0, v192
 Maavz 180,232,132
 v_sub_f32 v39, 0, v192
 v_sub_f32 v101, 0, v193
 Maavz 36,236,4
 R 200,239,40960
 v_sub_f32 v102, 0, v193
 Maavz 100,236,68
 v_sub_f32 v103, 0, v193
 v_sub_f32 v165, 0, v194
 Maavz 56,240,4
 v_sub_f32 v166, 0, v194
 v_sub_f32 v167, 0, v194
 Maavz 120,240,68
 v_add_f32 v197, v197, v157
 v_add_f32 v195, v195, v29
 Maavz 184,240,132
 v_add_f32 v196, v196, v93
 R 204,239,32768
 Maavz 40,244,4
 v_add_f32 v197, v197, v158
 v_add_f32 v195, v195, v30
 Maavz 104,244,68
 v_add_f32 v196, v196, v94
 v_add_f32 v197, v197, v159
 Maavz 60,248,4
 v_add_f32 v195, v195, v31
 v_add_f32 v196, v196, v95
 Maavz 124,248,68
 R 208,238,41216
 v_add_f32 v188, v188, v164
 Maavz 188,248,132
 R 212,238,33024
 v_add_f32 v189, v189, v164
 Maavz 44,252,4
 R 216,239,41216
 v_add_f32 v190, v190, v164
 Maavz 108,252,68
 s_waitcnt lgkmcnt(3)
 R 220,239,33024
 v_add_f32 v191, v191, v164
 Mc 28,192,16,36
 R 224,236,40960
 EX 188
 EX 189
 v_lshrrev_b32 v207, 4, v204
 Mc 92,192,80,100
 Mc 156,192,144,164
 R 228,236,32768
 EX 190
 EX 191
 CV 142,188,189
 Mc 20,196,16,36
 Mc 84,196,80,100
 Mvav 28,200,24
 R 232,237,40960
 CV 143,190,191
 v_lshrrev_b32 v205, 2, v204
 v_mov_b32 v201, 1
 v_add_f32 v52, v52, v36
 v_add_f32 v53, v53, v36
 Mvav 92,200,88
 Mvav 156,200,152
 Mvav 20,204,24
 Mvav 84,204,88
 s_waitcnt lgkmcnt(1)
 R 236,237,32768
 EX 52
 EX 53
 v_add_f32 v54, v54, v36
 Mvav 28,208,48
 Mvav 92,208,112
 Mvav 156,208,176
 R 240,236,41216
 EX 54
 v_add_f32 v55, v55, v36
 EX 55
 Mvav 20,212,48
 Mvav 84,212,112
 Mvav 28,216,56
 Mvav 92,216,120
 R 244,236,33024
 v_add_f32 v60, v60, v36
 EX 60
 v_add_f32 v61, v61, v36
 v_add_f32 v62, v62, v36
 Mvav 156,216,184
 R 248,237,41216
 R 252,237,33024
 Mvav 20,220,56
 Mvav 84,220,120
 Mvav 28,224,0
 ds_write_b64 v202, v[142:143] offset:8
 Mvav 92,224,64
 EX 61
 EX 62
 v_add_f32 v63, v63, v36
 v_add_f32 v116, v116, v100
 Mvav 156,224,128
 Mvav 20,228,0
 Mvav 84,228,64
 s_waitcnt vmcnt(24) lgkmcnt(0)
 s_barrier
 Mvav 28,232,8
 T 192,212,49152
 T 194,212,57344
 EX 63
 EX 116
 Mvav 92,232,72
 Mvav 156,232,136
 Mvav 20,236,8
 ds_read_b64 v[140:141], v203 offset:8
 T 196,208,49152
 v_add_f32 v117, v117, v100
 EX 117
 v_add_f32 v118, v118, v100
 Mvav 84,236,72
 Mvav 28,240,32
 Mvav 92,240,96
 Mvav 156,240,160
 T 198,208,57344
 T 200,213,49152
 EX 118
 v_add_f32 v119, v119, v100
 v_add_f32 v124, v124, v100
 Mvav 20,244,32
 Mvav 84,244,96
 Mvav 28,248,40
 T 202,213,57344
 EX 119
 EX 124
 v_add_f32 v125, v125, v100
 Mvav 92,248,104
 Mvav 156,248,168
 v_add_f32 v126, v126, v100
 v_add_f32 v127, v127, v100
 EX 125
 EX 126
 EX 127
 Mvav 20,252,40
 T 204,209,49152
 T 206,209,57344
 CV 12,52,53
 CV 13,54,55
 CV 14,60,61
 CV 15,62,63
 CV 76,116,117
 CV 77,118,119
 CV 78,124,125
 CV 79,126,127
 Mvav 84,252,104
 s_waitcnt lgkmcnt(3)
 Maav 16,192,12
 T 208,214,49152
 T 210,214,57344
 Maav 80,192,76
 Maav 144,192,140
 Maav 0,196,12
 T 212,210,49152
 T 214,210,57344
 Maav 64,196,76
 s_waitcnt lgkmcnt(6)
 Maav 20,200,12
 s_cmp_eq_u32 s46, 0
 s_cbranch_scc1 L_pres0
L_pres0b:
 T 216,215,49152
 T 218,215,57344
 Maav 84,200,76
 Maav 148,200,140
 s_waitcnt lgkmcnt(4)
 Maav 4,204,12
 T 220,211,49152
 T 222,211,57344
 Maav 68,204,76
 Maav 24,208,12
 T 224,212,49408
 T 226,212,57600
 Maav 88,208,76
 Maav 152,208,140
 s_waitcnt lgkmcnt(4)
 Maav 8,212,12
 T 228,208,49408
 T 230,208,57600
 Maav 72,212,76
 Maav 28,216,12
 T 232,213,49408
 T 234,213,57600
 Maav 92,216,76
 Maav 156,216,140
 s_waitcnt lgkmcnt(4)
 T 236,209,49408
 T 238,209,57600
 T 240,214,49408
 T 242,214,57600
 T 244,210,49408
 T 246,210,57600
 T 248,215,49408
 T 250,215,57600
 T 252,211,49408
 T 254,211,57600
 Maav 12,220,12
 Maav 76,220,76
 Maav 48,224,12
 Maav 112,224,76
 Maav 176,224,140
 s_waitcnt lgkmcnt(10)
 Maav 32,228,12
 Maav 96,228,76
 s_waitcnt lgkmcnt(0)
 s_barrier
 R 192,238,8192
 v_add_f32 v195, v195, v52
 v_add_f32 v196, v196, v116
 v_add_f32 v197, v197, v188
 EX 156
 Maav 52,232,12
 s_add_u32 m0, s33, 98304
 Maav 116,232,76
 s_mov_b32 s32, 81920
 Maav 180,232,140
 buffer_load_dwordx4 v248, s[16:19], s32 offen nt lds
 R 196,238,0
 v_add_f32 v195, v195, v53
 v_add_f32 v196, v196, v117
 v_add_f32 v197, v197, v189
 Maav 36,236,12
 Maav 100,236,76
 Maav 56,240,12
 Maav 120,240,76
 v_add_f32 v195, v195, v54
 v_add_f32 v196, v196, v118
 buffer_load_dwordx4 v249, s[16:19], s32 offen offset:1024 nt lds
 R 200,239,8192
 v_add_f32 v197, v197, v190
 Maav 184,240,140
 Maav 40,244,12
 Maav 104,244,76
 v_add_f32 v195, v195, v55
 v_add_f32 v196, v196, v119
 buffer_load_dwordx4 v250, s[16:19], s32 offen offset:2048 nt lds
 R 204,239,0
 v_add_f32 v197, v197, v191
 Maav 60,248,12
 Maav 124,248,76
 v_add_f32 v195, v195, v60
 v_add_f32 v196, v196, v124
 Maav 188,248,140
 v_add_f32 v195, v195, v61
 v_add_f32 v196, v196, v125
 Maav 44,252,12
 v_add_f32 v195, v195, v62
 v_add_f32 v196, v196, v126
 Maav 108,252,76
 s_waitcnt lgkmcnt(1)
 buffer_load_dwordx4 v251, s[16:19], s32 offen offset:3072 nt lds
 v_add_f32 v195, v195, v63
 v_add_f32 v196, v196, v127
 Mc 60,192,16,36
 s_add_u32 m0, s33, 106496
 R 208,238,8448
 Mc 124,192,80,100
 s_mov_b32 s32, 90112
 buffer_load_dwordx4 v248, s[16:19], s32 offen nt lds
 Mc 188,192,144,164
 Mc 52,196,16,36
 buffer_load_dwordx4 v249, s[16:19], s32 offen offset:1024 nt lds
 R 212,238,256
 Mc 116,196,80,100
 Mvav 60,200,24
 s_cmp_eq_u32 s46, 1
 s_cbranch_scc1 L_pres1
L_pres1b:
 buffer_load_dwordx4 v250, s[16:19], s32 offen offset:2048 nt lds
 R 216,239,8448
 Mvav 124,200,88
 Mvav 188,200,152
 s_waitcnt lgkmcnt(2)
 buffer_load_dwordx4 v251, s[16:19], s32 offen offset:3072 nt lds
 Mvav 52,204,24
 R 220,239,256
 Mvav 116,204,88
 Mvav 60,208,48
 R 224,236,8192
 Mvav 124,208,112
 R 228,236,0
 EX 157
 EX 158
 v_add_f32 v197, v197, v156
 Mvav 188,208,176
 s_waitcnt lgkmcnt(3)
 Mvav 52,212,48
 Mvav 116,212,112
 Mvav 60,216,56
 R 232,237,8192
 EX 159
 CV 134,156,157
 EX 20
 Mvav 124,216,120
 Mvav 188,216,184
 s_waitcnt lgkmcnt(2)
 R 236,237,0
 R 240,236,8448
 R 244,236,256
 R 248,237,8448
 R 252,237,256
 Mvav 52,220,56
 Mvav 116,220,120
 CV 135,158,159
 Mvav 60,224,0
 ds_write_b64 v202, v[134:135]
 Mvav 124,224,64
 Mvav 188,224,128
 s_waitcnt lgkmcnt(6)
 EX 21
 EX 22
 EX 23
 Mvav 52,228,0
 Mvav 116,228,64
 s_waitcnt vmcnt(24) lgkmcnt(0)
 s_barrier
 Mvav 60,232,8
 Mvav 124,232,72
 T 192,220,49152
 T 194,220,57344
 EX 28
 EX 29
 Mvav 188,232,136
 Mvav 52,236,8
 Mvav 116,236,72
 ds_read_b64 v[132:133], v203
 T 196,216,49152
 EX 30
 EX 31
 Mvav 60,240,32
 Mvav 124,240,96
 Mvav 188,240,160
 Mvav 52,244,32
 T 198,216,57344
 T 200,221,49152
 EX 84
 EX 85
 Mvav 116,244,96
 Mvav 60,248,40
 T 202,221,57344
 Mvav 124,248,104
 Mvav 188,248,168
 EX 86
 EX 87
 EX 92
 EX 93
 EX 94
 EX 95
 Mvav 52,252,40
 T 204,217,49152
 T 206,217,57344
 CV 4,20,21
 CV 5,22,23
 CV 6,28,29
 CV 7,30,31
 CV 68,84,85
 CV 69,86,87
 CV 70,92,93
 CV 71,94,95
 Mvav 116,252,104
 s_waitcnt lgkmcnt(5)
 Maav 16,192,4
 T 208,222,49152
 T 210,222,57344
 Maav 80,192,68
 Maav 144,192,132
 s_waitcnt lgkmcnt(4)
 Maav 0,196,4
 T 212,218,49152
 T 214,218,57344
 Maav 64,196,68
 Maav 20,200,4
 s_cmp_eq_u32 s46, 2
 s_cbranch_scc1 L_pres2
L_pres2b:
 T 216,223,49152
 T 218,223,57344
 Maav 84,200,68
 Maav 148,200,132
 s_waitcnt lgkmcnt(4)
 Maav 4,204,4
 T 220,219,49152
 T 222,219,57344
 Maav 68,204,68
 Maav 24,208,4
 T 224,220,49408
 T 226,220,57600
 Maav 88,208,68
 Maav 152,208,132
 s_waitcnt lgkmcnt(4)
 Maav 8,212,4
 T 228,216,49408
 T 230,216,57600
 Maav 72,212,68
 Maav 28,216,4
 T 232,221,49408
 T 234,221,57600
 Maav 92,216,68
 Maav 156,216,132
 s_waitcnt lgkmcnt(4)
 T 236,217,49408
 T 238,217,57600
 T 240,222,49408
 T 242,222,57600
 T 244,218,49408
 T 246,218,57600
 T 248,223,49408
 T 250,223,57600
 T 252,219,49408
 T 254,219,57600
 Maav 12,220,4
 Maav 76,220,68
 Maav 48,224,4
 Maav 112,224,68
 Maav 176,224,132
 s_waitcnt lgkmcnt(10)
 Maav 32,228,4
 Maav 96,228,68
 s_waitcnt lgkmcnt(0)
 s_barrier
 R 192,242,8192
 v_add_f32 v195, v195, v20
 v_add_f32 v196, v196, v84
 v_add_f32 v197, v197, v157
 EX 188
 Maav 52,232,4
 Maav 116,232,68
 Maav 180,232,132
 Maav 36,236,4
 R 196,242,0
 v_add_f32 v195, v195, v21
 v_add_f32 v196, v196, v85
 v_add_f32 v197, v197, v158
 EX 189
 Maav 100,236,68
 Maav 56,240,4
 Maav 120,240,68
 v_add_f32 v195, v195, v22
 v_add_f32 v196, v196, v86
 R 200,243,8192
 v_add_f32 v197, v197, v159
 EX 190
 Maav 184,240,132
 Maav 40,244,4
 Maav 104,244,68
 Maav 60,248,4
 v_add_f32 v195, v195, v23
 v_add_f32 v196, v196, v87
 R 204,243,0
 EX 191
 CV 142,188,189
 Maav 124,248,68
 v_add_f32 v195, v195, v28
 v_add_f32 v196, v196, v92
 Maav 188,248,132
 v_add_f32 v195, v195, v29
 v_add_f32 v196, v196, v93
 Maav 44,252,4
 v_add_f32 v195, v195, v30
 v_add_f32 v196, v196, v94
 Maav 108,252,68
 s_waitcnt lgkmcnt(1)
 v_add_f32 v195, v195, v31
 v_add_f32 v196, v196, v95
 Mc 28,192,16,36
 R 208,242,8448
 Mc 92,192,80,100
 Mc 156,192,144,164
 Mc 20,196,16,36
 R 212,242,256
 Mc 84,196,80,100
 R 216,243,8448
 CV 143,190,191
 EX 52
 EX 53
 Mvav 28,200,24
 s_cmp_eq_u32 s46, 3
 s_cbranch_scc1 L_pres3
L_pres3b:
 Mvav 92,200,88
 Mvav 156,200,152
 s_waitcnt lgkmcnt(2)
 Mvav 20,204,24
 s_add_u32 m0, s33, 65536
 R 220,243,256
 EX 54
 EX 55
 CV 12,52,53
 Mvav 84,204,88
 Mvav 28,208,48
 s_mov_b32 s32, 98304
 R 224,240,8192
 Mvav 92,208,112
 Mvav 156,208,176
 s_waitcnt lgkmcnt(2)
 R 228,240,0
 buffer_load_dwordx4 v248, s[16:19], s32 offen nt lds
 buffer_load_dwordx4 v249, s[16:19], s32 offen offset:1024 nt lds
 CV 13,54,55
 Mvav 20,212,48
 Mvav 84,212,112
 Mvav 28,216,56
 R 232,241,8192
 buffer_load_dwordx4 v250, s[16:19], s32 offen offset:2048 nt lds
 buffer_load_dwordx4 v251, s[16:19], s32 offen offset:3072 nt lds
 v_add_f32 v195, v195, v52
 Mvav 92,216,120
 s_add_u32 m0, s33, 73728
 Mvav 156,216,184
 s_waitcnt lgkmcnt(2)
 R 236,241,0
 R 240,240,8448
 R 244,240,256
 R 248,241,8448
 R 252,241,256
 Mvav 20,220,56
 s_mov_b32 s32, 106496
 Mvav 84,220,120
 Mvav 28,224,0
 ds_write_b64 v202, v[142:143] offset:8
 Mvav 92,224,64
 Mvav 156,224,128
 s_waitcnt lgkmcnt(6)
 buffer_load_dwordx4 v248, s[16:19], s32 offen nt lds
 buffer_load_dwordx4 v249, s[16:19], s32 offen offset:1024 nt lds
 buffer_load_dwordx4 v250, s[16:19], s32 offen offset:2048 nt lds
 Mvav 20,228,0
 Mvav 84,228,64
 s_waitcnt vmcnt(23) lgkmcnt(0)
 s_barrier
 Mvav 28,232,8
 Mvav 92,232,72
 T 192,228,16384
 T 194,228,24576
 buffer_load_dwordx4 v251, s[16:19], s32 offen offset:3072 nt lds
 EX 60
 Mvav 156,232,136
 Mvav 20,236,8
 Mvav 84,236,72
 ds_read_b64 v[140:141], v203 offset:8
 T 196,224,16384
 EX 61
 EX 62
 Mvav 28,240,32
 Mvav 92,240,96
 Mvav 156,240,160
 Mvav 20,244,32
 T 198,224,24576
 T 200,229,16384
 EX 63
 EX 116
 Mvav 84,244,96
 Mvav 28,248,40
 T 202,229,24576
 Mvav 92,248,104
 Mvav 156,248,168
 EX 117
 EX 118
 EX 119
 EX 124
 EX 125
 EX 126
 EX 127
 Mvav 20,252,40
 T 204,225,16384
 T 206,225,24576
 CV 14,60,61
 CV 15,62,63
 CV 76,116,117
 CV 77,118,119
 CV 78,124,125
 CV 79,126,127
 Mvav 84,252,104
 s_waitcnt lgkmcnt(5)
 Maav 16,192,12
 T 208,230,16384
 T 210,230,24576
 Maav 80,192,76
 Maav 144,192,140
 s_waitcnt lgkmcnt(4)
 Maav 0,196,12
 T 212,226,16384
 T 214,226,24576
 Maav 64,196,76
 Maav 20,200,12
 s_cmp_eq_u32 s46, 4
 s_cbranch_scc1 L_pres4
L_pres4b:
 T 216,231,16384
 T 218,231,24576
 Maav 84,200,76
 Maav 148,200,140
 s_waitcnt lgkmcnt(4)
 Maav 4,204,12
 T 220,227,16384
 T 222,227,24576
 Maav 68,204,76
 Maav 24,208,12
 T 224,228,16640
 T 226,228,24832
 Maav 88,208,76
 Maav 152,208,140
 s_waitcnt lgkmcnt(4)
 Maav 8,212,12
 T 228,224,16640
 T 230,224,24832
 Maav 72,212,76
 Maav 28,216,12
 T 232,229,16640
 T 234,229,24832
 Maav 92,216,76
 Maav 156,216,140
 s_waitcnt lgkmcnt(4)
 T 236,225,16640
 T 238,225,24832
 T 240,230,16640
 T 242,230,24832
 T 244,226,16640
 T 246,226,24832
 T 248,231,16640
 T 250,231,24832
 T 252,227,16640
 T 254,227,24832
 Maav 12,220,12
 Maav 76,220,76
 Maav 48,224,12
 Maav 112,224,76
 Maav 176,224,140
 s_waitcnt lgkmcnt(10)
 Maav 32,228,12
 Maav 96,228,76
 s_waitcnt lgkmcnt(0)
 s_barrier
 R 192,234,8192
 v_add_f32 v196, v196, v116
 v_add_f32 v195, v195, v53
 v_add_f32 v197, v197, v188
 EX 156
 Maav 52,232,12
 Maav 116,232,76
 Maav 180,232,140
 Maav 36,236,12
 R 196,234,0
 v_add_f32 v196, v196, v117
 v_add_f32 v195, v195, v54
 v_add_f32 v197, v197, v189
 EX 157
 Maav 100,236,76
 Maav 56,240,12
 Maav 120,240,76
 v_add_f32 v196, v196, v118
 R 200,235,8192
 v_add_f32 v195, v195, v55
 v_add_f32 v197, v197, v190
 EX 158
 Maav 184,240,140
 Maav 40,244,12
 Maav 104,244,76
 Maav 60,248,12
 v_add_f32 v196, v196, v119
 v_add_f32 v195, v195, v60
 R 204,235,0
 v_add_f32 v197, v197, v191
 EX 159
 Maav 124,248,76
 v_add_f32 v196, v196, v124
 Maav 188,248,140
 v_add_f32 v195, v195, v61
 v_add_f32 v196, v196, v125
 Maav 44,252,12
 v_add_f32 v195, v195, v62
 v_add_f32 v196, v196, v126
 Maav 108,252,76
 s_waitcnt lgkmcnt(1)
 v_add_f32 v195, v195, v63
 v_add_f32 v196, v196, v127
 Mc 60,192,16,36
 R 208,234,8448
 Mc 124,192,80,100
 Mc 188,192,144,164
 Mc 52,196,16,36
 R 212,234,256
 CV 134,156,157
 CV 135,158,159
 EX 20
 v_add_f32 v197, v197, v156
 Mc 116,196,80,100
 Mvav 60,200,24
 s_cmp_eq_u32 s46, 5
 s_cbranch_scc1 L_pres5
L_pres5b:
 R 216,235,8448
 Mvav 124,200,88
 Mvav 188,200,152
 s_waitcnt lgkmcnt(2)
 R 220,235,256
 EX 21
 EX 22
 v_add_f32 v195, v195, v20
 Mvav 52,204,24
 Mvav 116,204,88
 Mvav 60,208,48
 R 224,232,8192
 Mvav 124,208,112
 R 228,232,0
 EX 23
 EX 28
 CV 4,20,21
 Mvav 188,208,176
 s_waitcnt lgkmcnt(3)
 Mvav 52,212,48
 Mvav 116,212,112
 Mvav 60,216,56
 R 232,233,8192
 EX 29
 EX 30
 CV 5,22,23
 Mvav 124,216,120
 Mvav 188,216,184
 s_waitcnt lgkmcnt(2)
 R 236,233,0
 R 240,232,8448
 R 244,232,256
 R 248,233,8448
 R 252,233,256
 Mvav 52,220,56
 Mvav 116,220,120
 Mvav 60,224,0
 ds_write_b64 v202, v[134:135]
 Mvav 124,224,64
 Mvav 188,224,128
 s_waitcnt lgkmcnt(6)
 EX 31
 EX 84
 EX 85
 Mvav 52,228,0
 Mvav 116,228,64
 s_waitcnt vmcnt(16) lgkmcnt(0)
 s_barrier
 Mvav 60,232,8
 T 192,212,16384
 T 194,212,24576
 EX 86
 EX 87
 Mvav 124,232,72
 Mvav 188,232,136
 Mvav 52,236,8
 Mvav 116,236,72
 ds_read_b64 v[132:133], v203
 T 196,208,16384
 EX 92
 EX 93
 Mvav 60,240,32
 Mvav 124,240,96
 Mvav 188,240,160
 T 198,208,24576
 T 200,213,16384
 EX 94
 EX 95
 Mvav 52,244,32
 s_add_u32 m0, s33, 131072
 Mvav 116,244,96
 Mvav 60,248,40
 s_mov_b32 s32, 114688
 T 202,213,24576
 Mvav 124,248,104
 Mvav 188,248,168
 T 204,209,16384
 T 206,209,24576
 CV 6,28,29
 CV 7,30,31
 CV 68,84,85
 CV 69,86,87
 Mvav 52,252,40
 CV 70,92,93
 CV 71,94,95
 Mvav 116,252,104
 s_waitcnt lgkmcnt(3)
 Maav 16,192,4
 T 208,214,16384
 T 210,214,24576
 Maav 80,192,68
 buffer_load_dwordx4 v248, s[16:19], s32 offen nt lds
 Maav 144,192,132
 Maav 0,196,4
 buffer_load_dwordx4 v249, s[16:19], s32 offen offset:1024 nt lds
 T 212,210,16384
 T 214,210,24576
 Maav 64,196,68
 s_waitcnt lgkmcnt(4)
 Maav 20,200,4
 s_cmp_eq_u32 s46, 6
 s_cbranch_scc1 L_pres6
L_pres6b:
 buffer_load_dwordx4 v250, s[16:19], s32 offen offset:2048 nt lds
 T 216,215,16384
 T 218,215,24576
 Maav 84,200,68
 Maav 148,200,132
 buffer_load_dwordx4 v251, s[16:19], s32 offen offset:3072 nt lds
 Maav 4,204,4
 s_add_u32 m0, s33, 139264
 T 220,211,16384
 T 222,211,24576
 Maav 68,204,68
 s_waitcnt lgkmcnt(6)
 s_mov_b32 s32, 122880
 buffer_load_dwordx4 v248, s[16:19], s32 offen nt lds
 Maav 24,208,4
 T 224,212,16640
 T 226,212,24832
 Maav 88,208,68
 buffer_load_dwordx4 v249, s[16:19], s32 offen offset:1024 nt lds
 Maav 152,208,132
 s_waitcnt lgkmcnt(4)
 Maav 8,212,4
 buffer_load_dwordx4 v250, s[16:19], s32 offen offset:2048 nt lds
 T 228,208,16640
 T 230,208,24832
 Maav 72,212,68
 Maav 28,216,4
 buffer_load_dwordx4 v251, s[16:19], s32 offen offset:3072 nt lds
 T 232,213,16640
 T 234,213,24832
 Maav 92,216,68
 Maav 156,216,132
 s_waitcnt lgkmcnt(4)
 T 236,209,16640
 T 238,209,24832
 T 240,214,16640
 T 242,214,24832
 T 244,210,16640
 T 246,210,24832
 T 248,215,16640
 T 250,215,24832
 T 252,211,16640
 T 254,211,24832
 Maav 12,220,4
 Maav 76,220,68
 Maav 48,224,4
 Maav 112,224,68
 Maav 176,224,132
 s_waitcnt lgkmcnt(10)
 Maav 32,228,4
 Maav 96,228,68
 s_waitcnt lgkmcnt(0)
 s_barrier
 Maav 52,232,4
 R 192,234,40960
 v_add_f32 v196, v196, v84
 v_add_f32 v195, v195, v21
 v_add_f32 v197, v197, v157
 EX 188
 Maav 116,232,68
 Maav 180,232,132
 Maav 36,236,4
 R 196,234,32768
 v_add_f32 v196, v196, v85
 v_add_f32 v195, v195, v22
 v_add_f32 v197, v197, v158
 EX 189
 Maav 100,236,68
 Maav 56,240,4
 Maav 120,240,68
 Maav 184,240,132
 v_add_f32 v196, v196, v86
 R 200,235,40960
 v_add_f32 v195, v195, v23
 v_add_f32 v197, v197, v159
 EX 190
 Maav 40,244,4
 Maav 104,244,68
 Maav 60,248,4
 v_add_f32 v196, v196, v87
 v_add_f32 v195, v195, v28
 R 204,235,32768
 EX 191
 CV 142,188,189
 Maav 124,248,68
 v_add_f32 v196, v196, v92
 Maav 188,248,132
 v_add_f32 v195, v195, v29
 v_add_f32 v196, v196, v93
 Maav 44,252,4
 v_add_f32 v195, v195, v30
 v_add_f32 v196, v196, v94
 Maav 108,252,68
 s_waitcnt lgkmcnt(1)
 v_add_f32 v195, v195, v31
 v_add_f32 v196, v196, v95
 Mc 28,192,16,36
 R 208,234,41216
 Mc 92,192,80,100
 Mc 156,192,144,164
 Mc 20,196,16,36
 R 212,234,33024
 Mc 84,196,80,100
 R 216,235,41216
 CV 143,190,191
 EX 52
 EX 53
 Mvav 28,200,24
 s_cmp_eq_u32 s46, 7
 s_cbranch_scc1 L_pres7
L_pres7b:
 Mvav 92,200,88
 Mvav 156,200,152
 s_waitcnt lgkmcnt(2)
 Mvav 20,204,24
 R 220,235,33024
 EX 54
 EX 55
 CV 12,52,53
 Mvav 84,204,88
 Mvav 28,208,48
 R 224,232,40960
 Mvav 92,208,112
 Mvav 156,208,176
 s_waitcnt lgkmcnt(2)
 R 228,232,32768
 EX 60
 EX 61
 CV 13,54,55
 Mvav 20,212,48
 Mvav 84,212,112
 Mvav 28,216,56
 R 232,233,40960
 EX 62
 EX 63
 CV 14,60,61
 Mvav 92,216,120
 Mvav 156,216,184
 s_waitcnt lgkmcnt(2)
 R 236,233,32768
 R 240,232,41216
 R 244,232,33024
 R 248,233,41216
 R 252,233,33024
 Mvav 20,220,56
 Mvav 84,220,120
 Mvav 28,224,0
 ds_write_b64 v202, v[142:143] offset:8
 Mvav 92,224,64
 Mvav 156,224,128
 s_waitcnt lgkmcnt(6)
 EX 116
 EX 117
 EX 118
 Mvav 20,228,0
 Mvav 84,228,64
 s_waitcnt vmcnt(16) lgkmcnt(0)
 s_barrier
 Mvav 28,232,8
 Mvav 92,232,72
 T 192,220,32768
 T 194,220,40960
 EX 119
 EX 124
 Mvav 156,232,136
 Mvav 20,236,8
 Mvav 84,236,72
 ds_read_b64 v[140:141], v203 offset:8
 T 196,216,32768
 EX 125
 EX 126
 Mvav 28,240,32
 Mvav 92,240,96
 Mvav 156,240,160
 Mvav 20,244,32
 T 198,216,40960
 T 200,221,32768
 EX 127
 CV 15,62,63
 CV 76,116,117
 Mvav 84,244,96
 Mvav 28,248,40
 T 202,221,40960
 Mvav 92,248,104
 Mvav 156,248,168
 T 204,217,32768
 T 206,217,40960
 CV 77,118,119
 CV 78,124,125
 CV 79,126,127
 v_add_f32 v195, v195, v52
 Mvav 20,252,40
 Mvav 84,252,104
 s_waitcnt lgkmcnt(5)
 Maav 16,192,12
 T 208,222,32768
 T 210,222,40960
 Maav 80,192,76
 Maav 144,192,140
 s_waitcnt lgkmcnt(4)
 T 212,218,32768
 T 214,218,40960
 v_add_f32 v196, v196, v116
 v_add_f32 v195, v195, v53
 v_add_f32 v197, v197, v188
 Maav 0,196,12
 Maav 64,196,76
 Maav 20,200,12
 s_cmp_eq_u32 s46, 8
 s_cbranch_scc1 L_pres8
L_pres8b:
 T 216,223,32768
 T 218,223,40960
 v_add_f32 v196, v196, v117
 v_add_f32 v195, v195, v54
 EX 156
 Maav 84,200,76
 Maav 148,200,140
 s_waitcnt lgkmcnt(4)
 Maav 4,204,12
 T 220,219,32768
 T 222,219,40960
 v_add_f32 v196, v196, v118
 v_add_f32 v195, v195, v55
 EX 157
 Maav 68,204,76
 Maav 24,208,12
 T 224,220,33024
 T 226,220,41216
 Maav 88,208,76
 Maav 152,208,140
 s_waitcnt lgkmcnt(4)
 Maav 8,212,12
 T 228,216,33024
 T 230,216,41216
 v_add_f32 v196, v196, v119
 v_add_f32 v195, v195, v60
 v_add_f32 v197, v197, v189
 CV 134,156,157
 Maav 72,212,76
 Maav 28,216,12
 T 232,221,33024
 T 234,221,41216
 Maav 92,216,76
 s_add_u32 m0, s33, 16384
 Maav 156,216,140
 s_waitcnt lgkmcnt(4)
 T 236,217,33024
 T 238,217,41216
 T 240,222,33024
 T 242,222,41216
 T 244,218,33024
 T 246,218,41216
 T 248,223,33024
 T 250,223,41216
 T 252,219,33024
 T 254,219,41216
 Maav 12,220,12
 s_mov_b32 s32, 131072
 Maav 76,220,76
 Maav 48,224,12
 Maav 112,224,76
 Maav 176,224,140
 s_waitcnt lgkmcnt(10)
 Maav 32,228,12
 Maav 96,228,76
 s_waitcnt lgkmcnt(0)
 s_barrier
 buffer_load_dwordx4 v248, s[16:19], s32 offen nt lds
 buffer_load_dwordx4 v249, s[16:19], s32 offen offset:1024 nt lds
 buffer_load_dwordx4 v250, s[16:19], s32 offen offset:2048 nt lds
 Maav 52,232,12
 Maav 116,232,76
 Maav 180,232,140
 R 192,234,57344
 buffer_load_dwordx4 v251, s[16:19], s32 offen offset:3072 nt lds
 v_add_f32 v196, v196, v124
 v_add_f32 v195, v195, v61
 v_add_f32 v197, v197, v190
 Maav 36,236,12
 s_add_u32 m0, s33, 24576
 Maav 100,236,76
 Maav 56,240,12
 s_mov_b32 s32, 139264
 Maav 120,240,76
 buffer_load_dwordx4 v248, s[16:19], s32 offen nt lds
 R 196,234,49152
 buffer_load_dwordx4 v249, s[16:19], s32 offen offset:1024 nt lds
 v_add_f32 v196, v196, v125
 Maav 184,240,140
 Maav 40,244,12
 Maav 104,244,76
 R 200,235,57344
 buffer_load_dwordx4 v250, s[16:19], s32 offen offset:2048 nt lds
 v_add_f32 v195, v195, v62
 v_add_f32 v196, v196, v126
 v_add_f32 v197, v197, v191
 Maav 60,248,12
 Maav 124,248,76
 Maav 188,248,140
 Maav 44,252,12
 R 204,235,49152
 buffer_load_dwordx4 v251, s[16:19], s32 offen offset:3072 nt lds
 v_add_f32 v195, v195, v63
 v_add_f32 v196, v196, v127
 v_add_f32 v197, v197, v156
 Maav 108,252,76
 s_waitcnt lgkmcnt(2)
 Mc 60,192,16,36
 R 208,234,57600
 Mc 124,192,80,100
 Mc 188,192,144,164
 R 212,234,49408
 EX 158
 EX 159
 v_add_f32 v197, v197, v157
 Mc 52,196,16,36
 Mc 116,196,80,100
 s_waitcnt lgkmcnt(3)
 Mvav 60,200,24
 s_cmp_eq_u32 s46, 9
 s_cbranch_scc1 L_pres9
L_pres9b:
 R 216,235,57600
 CV 135,158,159
 EX 20
 EX 21
 Mvav 124,200,88
 Mvav 188,200,152
 s_waitcnt lgkmcnt(2)
 Mvav 52,204,24
 R 220,235,49408
 Mvav 116,204,88
 R 224,232,57344
 EX 22
 EX 23
 CV 4,20,21
 Mvav 60,208,48
 Mvav 124,208,112
 Mvav 188,208,176
 s_waitcnt lgkmcnt(2)
 Mvav 52,212,48
 R 228,232,49152
 EX 28
 EX 29
 CV 5,22,23
 Mvav 116,212,112
 Mvav 60,216,56
 R 232,233,57344
 Mvav 124,216,120
 Mvav 188,216,184
 s_waitcnt lgkmcnt(2)
 R 236,233,49152
 R 240,232,57600
 R 244,232,49408
 R 248,233,57600
 R 252,233,49408
 Mvav 52,220,56
 Mvav 116,220,120
 Mvav 60,224,0
 ds_write_b64 v202, v[134:135]
 EX 30
 EX 31
 CV 6,28,29
 Mvav 124,224,64
 Mvav 188,224,128
 s_waitcnt lgkmcnt(6)
 Mvav 52,228,0
 Mvav 116,228,64
 s_waitcnt vmcnt(16) lgkmcnt(0)
 s_barrier
 T 192,220,0
 T 194,220,8192
 EX 84
 EX 85
 Mvav 60,232,8
 Mvav 124,232,72
 Mvav 188,232,136
 ds_read_b64 v[132:133], v203
 T 196,216,0
 EX 86
 EX 87
 Mvav 52,236,8
 Mvav 116,236,72
 Mvav 60,240,32
 Mvav 124,240,96
 T 198,216,8192
 T 200,221,0
 EX 92
 EX 93
 Mvav 188,240,160
 Mvav 52,244,32
 Mvav 116,244,96
 T 202,221,8192
 EX 94
 EX 95
 CV 7,30,31
 Mvav 60,248,40
 Mvav 124,248,104
 Mvav 188,248,168
 Mvav 52,252,40
 T 204,217,0
 T 206,217,8192
 CV 68,84,85
 CV 69,86,87
 CV 70,92,93
 CV 71,94,95
 Mvav 116,252,104
 s_waitcnt lgkmcnt(3)
 Maav 16,192,4
 T 208,222,0
 T 210,222,8192
 Maav 80,192,68
 Maav 144,192,132
 T 212,218,0
 T 214,218,8192
 v_add_f32 v195, v195, v20
 v_add_f32 v196, v196, v84
 v_add_f32 v197, v197, v158
 Maav 0,196,4
 Maav 64,196,68
 s_waitcnt lgkmcnt(6)
 Maav 20,200,4
 s_cmp_eq_u32 s46, 10
 s_cbranch_scc1 L_pres10
L_pres10b:
 T 216,223,0
 T 218,223,8192
 v_add_f32 v195, v195, v21
 v_add_f32 v196, v196, v85
 EX 188
 Maav 84,200,68
 Maav 148,200,132
 s_waitcnt lgkmcnt(4)
 Maav 4,204,4
 T 220,219,0
 T 222,219,8192
 Maav 68,204,68
 Maav 24,208,4
 T 224,220,256
 T 226,220,8448
 v_add_f32 v195, v195, v22
 v_add_f32 v196, v196, v86
 EX 189
 Maav 88,208,68
 Maav 152,208,132
 s_waitcnt lgkmcnt(4)
 Maav 8,212,4
 T 228,216,256
 T 230,216,8448
 Maav 72,212,68
 Maav 28,216,4
 T 232,221,256
 T 234,221,8448
 v_add_f32 v195, v195, v23
 v_add_f32 v196, v196, v87
 v_add_f32 v197, v197, v159
 CV 142,188,189
 Maav 92,216,68
 Maav 156,216,132
 s_waitcnt lgkmcnt(4)
 T 236,217,256
 T 238,217,8448
 T 240,222,256
 T 242,222,8448
 T 244,218,256
 T 246,218,8448
 T 248,223,256
 T 250,223,8448
 T 252,219,256
 T 254,219,8448
 Maav 12,220,4
 Maav 76,220,68
 Maav 48,224,4
 Maav 112,224,68
 Maav 176,224,132
 s_waitcnt lgkmcnt(10)
 Maav 32,228,4
 Maav 96,228,68
 s_waitcnt lgkmcnt(0)
 s_barrier
 R 192,238,57344
 v_add_f32 v195, v195, v28
 v_add_f32 v196, v196, v92
 EX 190
 v_add_f32 v197, v197, v188
 Maav 52,232,4
 Maav 116,232,68
 Maav 180,232,132
 Maav 36,236,4
 R 196,238,49152
 v_add_f32 v195, v195, v29
 v_add_f32 v196, v196, v93
 EX 191
 v_add_f32 v197, v197, v189
 Maav 100,236,68
 Maav 56,240,4
 Maav 120,240,68
 R 200,239,57344
 v_add_f32 v195, v195, v30
 v_add_f32 v196, v196, v94
 CV 143,190,191
 EX 52
 Maav 184,240,132
 Maav 40,244,4
 Maav 104,244,68
 Maav 60,248,4
 R 204,239,49152
 v_add_f32 v195, v195, v31
 v_add_f32 v196, v196, v95
 EX 53
 v_add_f32 v197, v197, v190
 Maav 124,248,68
 Maav 188,248,132
 Maav 44,252,4
 R 208,238,57600
 EX 54
 EX 55
 CV 12,52,53
 Maav 108,252,68
 s_waitcnt lgkmcnt(2)
 Mc 28,192,16,36
 s_add_u32 m0, s33, 98304
 Mc 92,192,80,100
 s_mov_b32 s32, 147456
 Mc 156,192,144,164
 R 212,238,49408
 buffer_load_dwordx4 v248, s[16:19], s32 offen nt lds
 buffer_load_dwordx4 v249, s[16:19], s32 offen offset:1024 nt lds
 CV 13,54,55
 Mc 20,196,16,36
 Mc 84,196,80,100
 Mvav 28,200,24
 s_cmp_eq_u32 s46, 11
 s_cbranch_scc1 L_pres11
L_pres11b:
 R 216,239,57600
 buffer_load_dwordx4 v250, s[16:19], s32 offen offset:2048 nt lds
 EX 60
 v_add_f32 v195, v195, v52
 Mvav 92,200,88
 Mvav 156,200,152
 s_waitcnt lgkmcnt(2)
 Mvav 20,204,24
 R 220,239,49408
 Mvav 84,204,88
 R 224,236,57344
 buffer_load_dwordx4 v251, s[16:19], s32 offen offset:3072 nt lds
 EX 61
 v_add_f32 v195, v195, v53
 Mvav 28,208,48
 s_add_u32 m0, s33, 106496
 Mvav 92,208,112
 s_mov_b32 s32, 155648
 Mvav 156,208,176
 s_waitcnt lgkmcnt(2)
 Mvav 20,212,48
 R 228,236,49152
 buffer_load_dwordx4 v248, s[16:19], s32 offen nt lds
 buffer_load_dwordx4 v249, s[16:19], s32 offen offset:1024 nt lds
 CV 14,60,61
 Mvav 84,212,112
 Mvav 28,216,56
 R 232,237,57344
 Mvav 92,216,120
 Mvav 156,216,184
 s_waitcnt lgkmcnt(2)
 R 236,237,49152
 R 240,236,57600
 R 244,236,49408
 R 248,237,57600
 R 252,237,49408
 Mvav 20,220,56
 Mvav 84,220,120
 Mvav 28,224,0
 ds_write_b64 v202, v[142:143] offset:8
 buffer_load_dwordx4 v250, s[16:19], s32 offen offset:2048 nt lds
 buffer_load_dwordx4 v251, s[16:19], s32 offen offset:3072 nt lds
 v_add_f32 v195, v195, v54
 Mvav 92,224,64
 Mvav 156,224,128
 s_waitcnt lgkmcnt(6)
 Mvav 20,228,0
 Mvav 84,228,64
 s_waitcnt vmcnt(16) lgkmcnt(0)
 s_barrier
 T 192,228,0
 T 194,228,8192
 EX 62
 EX 63
 Mvav 28,232,8
 Mvav 92,232,72
 Mvav 156,232,136
 ds_read_b64 v[140:141], v203 offset:8
 T 196,224,0
 EX 116
 EX 117
 Mvav 20,236,8
 Mvav 84,236,72
 Mvav 28,240,32
 Mvav 92,240,96
 T 198,224,8192
 T 200,229,0
 EX 118
 EX 119
 Mvav 156,240,160
 Mvav 20,244,32
 Mvav 84,244,96
 T 202,229,8192
 EX 124
 EX 125
 CV 15,62,63
 Mvav 28,248,40
 Mvav 92,248,104
 Mvav 156,248,168
 EX 126
 EX 127
 Mvav 20,252,40
 T 204,225,0
 T 206,225,8192
 CV 76,116,117
 CV 77,118,119
 CV 78,124,125
 CV 79,126,127
 Mvav 84,252,104
 s_waitcnt lgkmcnt(3)
 Maav 16,192,12
 s_add_u32 m0, s33, 49152
 T 208,230,0
 T 210,230,8192
 Maav 80,192,76
 s_mov_b32 s32, 114688
 Maav 144,192,140
 Maav 0,196,12
 T 212,226,0
 T 214,226,8192
 Maav 64,196,76
 s_waitcnt lgkmcnt(6)
 Maav 20,200,12
 s_cmp_eq_u32 s46, 12
 s_cbranch_scc1 L_pres12
L_pres12b:
 T 216,231,0
 T 218,231,8192
 Maav 84,200,76
 Maav 148,200,140
 s_waitcnt lgkmcnt(4)
 T 220,227,0
 T 222,227,8192
 buffer_load_dwordx4 v252, s[20:23], s32 offen lds
 buffer_load_dwordx4 v253, s[20:23], s32 offen offset:1024 lds
 Maav 4,204,12
 Maav 68,204,76
 Maav 24,208,12
 T 224,228,256
 T 226,228,8448
 Maav 88,208,76
 Maav 152,208,140
 s_waitcnt lgkmcnt(4)
 buffer_load_dwordx4 v254, s[20:23], s32 offen offset:2048 lds
 T 228,224,256
 T 230,224,8448
 buffer_load_dwordx4 v255, s[20:23], s32 offen offset:3072 lds
 Maav 8,212,12
 s_add_u32 m0, s33, 57344
 Maav 72,212,76
 Maav 28,216,12
 s_mov_b32 s32, 129024
 T 232,229,256
 T 234,229,8448
 buffer_load_dwordx4 v252, s[20:23], s32 offen lds
 buffer_load_dwordx4 v253, s[20:23], s32 offen offset:1024 lds
 Maav 92,216,76
 Maav 156,216,140
 s_waitcnt lgkmcnt(4)
 T 236,225,256
 T 238,225,8448
 T 240,230,256
 T 242,230,8448
 T 244,226,256
 T 246,226,8448
 T 248,231,256
 T 250,231,8448
 T 252,227,256
 T 254,227,8448
 Maav 12,220,12
 Maav 76,220,76
 s_waitcnt lgkmcnt(12)
 Maav 48,224,12
 Maav 112,224,76
 buffer_load_dwordx4 v254, s[20:23], s32 offen offset:2048 lds
 Maav 176,224,140
 s_waitcnt lgkmcnt(10)
 Maav 32,228,12
 buffer_load_dwordx4 v255, s[20:23], s32 offen offset:3072 lds
 Maav 96,228,76
 s_waitcnt lgkmcnt(0)
 s_barrier
 Maav 52,232,12
 Maav 116,232,76
 Maav 180,232,140
 R 192,242,24576
 v_add_f32 v196, v196, v116
 v_add_f32 v195, v195, v55
 v_add_f32 v197, v197, v191
 EX 156
 Maav 36,236,12
 Maav 100,236,76
 Maav 56,240,12
 Maav 120,240,76
 R 196,242,16384
 v_add_f32 v196, v196, v117
 v_add_f32 v195, v195, v60
 EX 157
 v_add_f32 v197, v197, v156
 Maav 184,240,140
 Maav 40,244,12
 Maav 104,244,76
 v_add_f32 v196, v196, v118
 R 200,243,24576
 v_add_f32 v195, v195, v61
 EX 158
 CV 134,156,157
 Maav 60,248,12
 v_add_f32 v196, v196, v119
 Maav 124,248,76
 v_add_f32 v196, v196, v124
 Maav 188,248,140
 v_add_f32 v196, v196, v125
 Maav 44,252,12
 R 204,243,16384
 v_add_f32 v195, v195, v62
 v_add_f32 v196, v196, v126
 Maav 108,252,76
 s_waitcnt lgkmcnt(2)
 v_add_f32 v195, v195, v63
 v_add_f32 v196, v196, v127
 Mc 60,192,16,36
 R 208,242,24832
 Mc 124,192,80,100
 Mc 188,192,144,164
 Mc 52,196,16,36
 R 212,242,16640
 EX 159
 EX 20
 v_add_f32 v197, v197, v157
 Mc 116,196,80,100
 s_waitcnt lgkmcnt(3)
 Mvav 60,200,24
 s_cmp_eq_u32 s46, 13
 s_cbranch_scc1 L_pres13
L_pres13b:
 R 216,243,24832
 Mvav 124,200,88
 Mvav 188,200,152
 s_waitcnt lgkmcnt(2)
 R 220,243,16640
 CV 135,158,159
 EX 21
 EX 22
 Mvav 52,204,24
 Mvav 116,204,88
 Mvav 60,208,48
 R 224,240,24576
 Mvav 124,208,112
 R 228,240,16384
 EX 23
 EX 28
 CV 4,20,21
 Mvav 188,208,176
 s_waitcnt lgkmcnt(3)
 Mvav 52,212,48
 Mvav 116,212,112
 Mvav 60,216,56
 R 232,241,24576
 EX 29
 EX 30
 CV 5,22,23
 Mvav 124,216,120
 Mvav 188,216,184
 s_waitcnt lgkmcnt(2)
 R 236,241,16384
 R 240,240,24832
 R 244,240,16640
 R 248,241,24832
 R 252,241,16640
 Mvav 52,220,56
 Mvav 116,220,120
 Mvav 60,224,0
 ds_write_b64 v202, v[134:135]
 Mvav 124,224,64
 Mvav 188,224,128
 s_waitcnt lgkmcnt(6)
 EX 31
 EX 84
 EX 85
 Mvav 52,228,0
 Mvav 116,228,64
 s_waitcnt vmcnt(16) lgkmcnt(0)
 s_barrier
 Mvav 60,232,8
 s_add_u32 m0, s33, 114688
 T 192,212,16384
 T 194,212,24576
 EX 86
 EX 87
 Mvav 124,232,72
 s_mov_b32 s32, 163840
 Mvav 188,232,136
 Mvav 52,236,8
 Mvav 116,236,72
 ds_read_b64 v[132:133], v203
 buffer_load_dwordx4 v248, s[16:19], s32 offen nt lds
 T 196,208,16384
 buffer_load_dwordx4 v249, s[16:19], s32 offen offset:1024 nt lds
 Mvav 60,240,32
 Mvav 124,240,96
 Mvav 188,240,160
 T 198,208,24576
 T 200,213,16384
 buffer_load_dwordx4 v250, s[16:19], s32 offen offset:2048 nt lds
 EX 92
 Mvav 52,244,32
 Mvav 116,244,96
 Mvav 60,248,40
 T 202,213,24576
 Mvav 124,248,104
 Mvav 188,248,168
 EX 93
 EX 94
 EX 95
 Mvav 52,252,40
 T 204,209,16384
 T 206,209,24576
 CV 6,28,29
 CV 7,30,31
 CV 68,84,85
 CV 69,86,87
 CV 70,92,93
 CV 71,94,95
 Mvav 116,252,104
 s_waitcnt lgkmcnt(3)
 buffer_load_dwordx4 v251, s[16:19], s32 offen offset:3072 nt lds
 Maav 16,192,4
 s_add_u32 m0, s33, 122880
 T 208,214,16384
 T 210,214,24576
 Maav 80,192,68
 s_mov_b32 s32, 172032
 buffer_load_dwordx4 v248, s[16:19], s32 offen nt lds
 Maav 144,192,132
 Maav 0,196,4
 buffer_load_dwordx4 v249, s[16:19], s32 offen offset:1024 nt lds
 T 212,210,16384
 T 214,210,24576
 Maav 64,196,68
 s_waitcnt lgkmcnt(6)
 Maav 20,200,4
 s_cmp_eq_u32 s46, 14
 s_cbranch_scc1 L_pres14
L_pres14b:
 buffer_load_dwordx4 v250, s[16:19], s32 offen offset:2048 nt lds
 T 216,215,16384
 T 218,215,24576
 Maav 84,200,68
 Maav 148,200,132
 s_waitcnt lgkmcnt(4)
 buffer_load_dwordx4 v251, s[16:19], s32 offen offset:3072 nt lds
 Maav 4,204,4
 T 220,211,16384
 T 222,211,24576
 Maav 68,204,68
 Maav 24,208,4
 T 224,212,16640
 T 226,212,24832
 Maav 88,208,68
 Maav 152,208,132
 s_waitcnt lgkmcnt(4)
 Maav 8,212,4
 T 228,208,16640
 T 230,208,24832
 Maav 72,212,68
 Maav 28,216,4
 T 232,213,16640
 T 234,213,24832
 Maav 92,216,68
 Maav 156,216,132
 s_waitcnt lgkmcnt(4)
 T 236,209,16640
 T 238,209,24832
 T 240,214,16640
 T 242,214,24832
 T 244,210,16640
 T 246,210,24832
 T 248,215,16640
 T 250,215,24832
 T 252,211,16640
 T 254,211,24832
 Maav 12,220,4
 Maav 76,220,68
 Maav 48,224,4
 Maav 112,224,68
 Maav 176,224,132
 s_waitcnt lgkmcnt(10)
 Maav 32,228,4
 Maav 96,228,68
 s_waitcnt lgkmcnt(0)
 s_barrier
 Maav 52,232,4
 R 192,234,40960
 v_add_f32 v195, v195, v20
 v_add_f32 v196, v196, v84
 v_add_f32 v197, v197, v158
 EX 188
 Maav 116,232,68
 Maav 180,232,132
 Maav 36,236,4
 R 196,234,32768
 v_add_f32 v195, v195, v21
 v_add_f32 v196, v196, v85
 v_add_f32 v197, v197, v159
 EX 189
 Maav 100,236,68
 Maav 56,240,4
 Maav 120,240,68
 Maav 184,240,132
 v_add_f32 v195, v195, v22
 v_add_f32 v196, v196, v86
 R 200,235,40960
 EX 190
 CV 142,188,189
 Maav 40,244,4
 Maav 104,244,68
 Maav 60,248,4
 v_add_f32 v195, v195, v23
 v_add_f32 v196, v196, v87
 R 204,235,32768
 EX 191
 v_add_f32 v197, v197, v188
 Maav 124,248,68
 v_add_f32 v195, v195, v28
 v_add_f32 v196, v196, v92
 Maav 188,248,132
 v_add_f32 v195, v195, v29
 v_add_f32 v196, v196, v93
 Maav 44,252,4
 v_add_f32 v195, v195, v30
 v_add_f32 v196, v196, v94
 Maav 108,252,68
 s_waitcnt lgkmcnt(1)
 v_add_f32 v195, v195, v31
 v_add_f32 v196, v196, v95
 Mc 28,192,16,36
 R 208,234,41216
 Mc 92,192,80,100
 Mc 156,192,144,164
 Mc 20,196,16,36
 R 212,234,33024
 Mc 84,196,80,100
 Mvav 28,200,24
 s_cmp_eq_u32 s46, 15
 s_cbranch_scc1 L_pres15
L_pres15b:
 R 216,235,41216
 CV 143,190,191
 EX 52
 EX 53
 Mvav 92,200,88
 Mvav 156,200,152
 s_waitcnt lgkmcnt(2)
 Mvav 20,204,24
 R 220,235,33024
 EX 54
 EX 55
 CV 12,52,53
 Mvav 84,204,88
 Mvav 28,208,48
 R 224,232,40960
 Mvav 92,208,112
 Mvav 156,208,176
 s_waitcnt lgkmcnt(2)
 R 228,232,32768
 EX 60
 EX 61
 CV 13,54,55
 Mvav 20,212,48
 Mvav 84,212,112
 Mvav 28,216,56
 R 232,233,40960
 Mvav 92,216,120
 Mvav 156,216,184
 s_waitcnt lgkmcnt(2)
 R 236,233,32768
 R 240,232,41216
 R 244,232,33024
 R 248,233,41216
 R 252,233,33024
 Mvav 20,220,56
 Mvav 84,220,120
 ds_write_b64 v202, v[142:143] offset:8
 EX 62
 EX 63
 CV 14,60,61
 Mvav 28,224,0
 Mvav 92,224,64
 Mvav 156,224,128
 s_waitcnt lgkmcnt(6)
 Mvav 20,228,0
 EX 116
 EX 117
 EX 118
 Mvav 84,228,64
 s_waitcnt vmcnt(16) lgkmcnt(0)
 s_barrier
 Mvav 28,232,8
 Mvav 92,232,72
 Mvav 156,232,136
 T 192,220,32768
 T 194,220,40960
 EX 119
 EX 124
 Mvav 20,236,8
 Mvav 84,236,72
 Mvav 28,240,32
 ds_read_b64 v[140:141], v203 offset:8
 T 196,216,32768
 EX 125
 EX 126
 Mvav 92,240,96
 Mvav 156,240,160
 Mvav 20,244,32
 T 198,216,40960
 Mvav 84,244,96
 T 200,221,32768
 T 202,221,40960
 EX 127
 CV 15,62,63
 CV 76,116,117
 Mvav 28,248,40
 Mvav 92,248,104
 Mvav 156,248,168
 Mvav 20,252,40
 T 204,217,32768
 T 206,217,40960
 CV 77,118,119
 CV 78,124,125
 CV 79,126,127
 v_add_f32 v195, v195, v52
 Mvav 84,252,104
 s_waitcnt lgkmcnt(5)
 Maav 16,192,12
 T 208,222,32768
 T 210,222,40960
 Maav 80,192,76
 Maav 144,192,140
 s_waitcnt lgkmcnt(4)
 T 212,218,32768
 T 214,218,40960
 v_add_f32 v196, v196, v116
 v_add_f32 v195, v195, v53
 v_add_f32 v197, v197, v189
 Maav 0,196,12
 Maav 64,196,76
 Maav 20,200,12
 T 216,223,32768
 T 218,223,40960
 v_add_f32 v196, v196, v117
 v_add_f32 v195, v195, v54
 EX 156
 Maav 84,200,76
 Maav 148,200,140
 s_waitcnt lgkmcnt(4)
 Maav 4,204,12
 s_add_u32 m0, s33, 16384
 T 220,219,32768
 T 222,219,40960
 Maav 68,204,76
 Maav 24,208,12
 s_mov_b32 s32, 180224
 T 224,220,33024
 T 226,220,41216
 buffer_load_dwordx4 v248, s[16:19], s32 offen nt lds
 buffer_load_dwordx4 v249, s[16:19], s32 offen offset:1024 nt lds
 Maav 88,208,76
 Maav 152,208,140
 s_waitcnt lgkmcnt(4)
 Maav 8,212,12
 T 228,216,33024
 T 230,216,41216
 Maav 72,212,76
 Maav 28,216,12
 T 232,221,33024
 T 234,221,41216
 buffer_load_dwordx4 v250, s[16:19], s32 offen offset:2048 nt lds
 buffer_load_dwordx4 v251, s[16:19], s32 offen offset:3072 nt lds
 Maav 92,216,76
 s_add_u32 m0, s33, 24576
 Maav 156,216,140
 s_waitcnt lgkmcnt(4)
 T 236,217,33024
 T 238,217,41216
 T 240,222,33024
 T 242,222,41216
 T 244,218,33024
 T 246,218,41216
 T 248,223,33024
 T 250,223,41216
 T 252,219,33024
 T 254,219,41216
 Maav 12,220,12
 s_mov_b32 s32, 188416
 Maav 76,220,76
 Maav 48,224,12
 Maav 112,224,76
 Maav 176,224,140
 s_waitcnt lgkmcnt(10)
 Maav 32,228,12
 Maav 96,228,76
 s_waitcnt lgkmcnt(0)
 s_barrier
 buffer_load_dwordx4 v248, s[16:19], s32 offen nt lds
 buffer_load_dwordx4 v249, s[16:19], s32 offen offset:1024 nt lds
 buffer_load_dwordx4 v250, s[16:19], s32 offen offset:2048 nt lds
 Maav 52,232,12
 Maav 116,232,76
 Maav 180,232,140
 Maav 36,236,12
 R 192,238,8192
 buffer_load_dwordx4 v251, s[16:19], s32 offen offset:3072 nt lds
 v_add_f32 v196, v196, v118
 v_add_f32 v195, v195, v55
 v_add_f32 v197, v197, v190
 Maav 100,236,76
 Maav 56,240,12
 Maav 120,240,76
 R 196,238,0
 v_add_f32 v196, v196, v119
 v_add_f32 v195, v195, v60
 v_add_f32 v197, v197, v191
 EX 157
 Maav 184,240,140
 Maav 40,244,12
 Maav 104,244,76
 Maav 60,248,12
 R 200,239,8192
 v_add_f32 v196, v196, v124
 v_add_f32 v195, v195, v61
 EX 158
 CV 134,156,157
 Maav 124,248,76
 Maav 188,248,140
 v_add_f32 v196, v196, v125
 Maav 44,252,12
 R 204,239,0
 v_add_f32 v195, v195, v62
 v_add_f32 v196, v196, v126
 Maav 108,252,76
 s_waitcnt lgkmcnt(2)
 v_add_f32 v195, v195, v63
 v_add_f32 v196, v196, v127
 Mc 60,192,16,36
 R 208,238,8448
 Mc 124,192,80,100
 Mc 188,192,144,164
 R 212,238,256
 EX 159
 EX 20
 v_add_f32 v197, v197, v156
 Mc 52,196,16,36
 Mc 116,196,80,100
 s_waitcnt lgkmcnt(3)
 Mvav 60,200,24
 R 216,239,8448
 Mvav 124,200,88
 Mvav 188,200,152
 s_waitcnt lgkmcnt(2)
 R 220,239,256
 CV 135,158,159
 EX 21
 EX 22
 Mvav 52,204,24
 Mvav 116,204,88
 Mvav 60,208,48
 R 224,236,8192
 EX 23
 EX 28
 CV 4,20,21
 Mvav 124,208,112
 Mvav 188,208,176
 s_waitcnt lgkmcnt(2)
 Mvav 52,212,48
 R 228,236,0
 Mvav 116,212,112
 R 232,237,8192
 EX 29
 EX 30
 CV 5,22,23
 Mvav 60,216,56
 Mvav 124,216,120
 Mvav 188,216,184
 s_waitcnt lgkmcnt(2)
 R 236,237,0
 R 240,236,8448
 R 244,236,256
 R 248,237,8448
 R 252,237,256
 Mvav 52,220,56
 Mvav 116,220,120
 Mvav 60,224,0
 ds_write_b64 v202, v[134:135]
 Mvav 124,224,64
 EX 31
 EX 84
 EX 85
 Mvav 188,224,128
 s_waitcnt lgkmcnt(6)
 Mvav 52,228,0
 Mvav 116,228,64
 s_waitcnt vmcnt(8) lgkmcnt(0)
 s_barrier
 Mvav 60,232,8
 T 192,220,49152
 T 194,220,57344
 EX 86
 EX 87
 Mvav 124,232,72
 Mvav 188,232,136
 Mvav 52,236,8
 ds_read_b64 v[132:133], v203
 T 196,216,49152
 EX 92
 EX 93
 Mvav 116,236,72
 Mvav 60,240,32
 Mvav 124,240,96
 Mvav 188,240,160
 T 198,216,57344
 T 200,221,49152
 EX 94
 EX 95
 Mvav 52,244,32
 Mvav 116,244,96
 Mvav 60,248,40
 T 202,221,57344
 T 204,217,49152
 CV 6,28,29
 CV 7,30,31
 CV 68,84,85
 CV 69,86,87
 Mvav 124,248,104
 Mvav 188,248,168
 Mvav 52,252,40
 T 206,217,57344
 CV 70,92,93
 CV 71,94,95
 Mvav 116,252,104
 s_waitcnt lgkmcnt(3)
 Maav 16,192,4
 T 208,222,49152
 T 210,222,57344
 Maav 80,192,68
 Maav 144,192,132
 T 212,218,49152
 T 214,218,57344
 v_add_f32 v195, v195, v20
 v_add_f32 v196, v196, v84
 v_add_f32 v197, v197, v157
 Maav 0,196,4
 Maav 64,196,68
 s_waitcnt lgkmcnt(5)
 Maav 20,200,4
 T 216,223,49152
 T 218,223,57344
 v_add_f32 v195, v195, v21
 v_add_f32 v196, v196, v85
 EX 188
 Maav 84,200,68
 Maav 148,200,132
 s_waitcnt lgkmcnt(4)
 Maav 4,204,4
 T 220,219,49152
 T 222,219,57344
 v_add_f32 v195, v195, v22
 v_add_f32 v196, v196, v86
 EX 189
 Maav 68,204,68
 Maav 24,208,4
 T 224,220,49408
 T 226,220,57600
 Maav 88,208,68
 Maav 152,208,132
 s_waitcnt lgkmcnt(4)
 Maav 8,212,4
 T 228,216,49408
 T 230,216,57600
 v_add_f32 v195, v195, v23
 v_add_f32 v196, v196, v87
 v_add_f32 v197, v197, v158
 CV 142,188,189
 Maav 72,212,68
 Maav 28,216,4
 T 232,221,49408
 T 234,221,57600
 Maav 92,216,68
 Maav 156,216,132
 s_waitcnt lgkmcnt(4)
 T 236,217,49408
 T 238,217,57600
 T 240,222,49408
 T 242,222,57600
 T 244,218,49408
 T 246,218,57600
 T 248,223,49408
 T 250,223,57600
 T 252,219,49408
 T 254,219,57600
 Maav 12,220,4
 Maav 76,220,68
 Maav 48,224,4
 Maav 112,224,68
 Maav 176,224,132
 s_waitcnt lgkmcnt(10)
 Maav 32,228,4
 Maav 96,228,68
 s_waitcnt lgkmcnt(0)
 s_barrier
 R 192,242,8192
 v_add_f32 v195, v195, v28
 v_add_f32 v196, v196, v92
 v_add_f32 v197, v197, v159
 EX 190
 Maav 52,232,4
 Maav 116,232,68
 Maav 180,232,132
 R 196,242,0
 v_add_f32 v195, v195, v29
 v_add_f32 v196, v196, v93
 EX 191
 v_add_f32 v197, v197, v188
 Maav 36,236,4
 Maav 100,236,68
 Maav 56,240,4
 Maav 120,240,68
 R 200,243,8192
 v_add_f32 v195, v195, v30
 v_add_f32 v196, v196, v94
 CV 143,190,191
 EX 52
 Maav 184,240,132
 Maav 40,244,4
 s_add_u32 m0, s33, 98304
 Maav 104,244,68
 R 204,243,0
 v_add_f32 v195, v195, v31
 v_add_f32 v196, v196, v95
 EX 53
 v_add_f32 v197, v197, v189
 Maav 60,248,4
 s_mov_b32 s32, 196608
 Maav 124,248,68
 Maav 188,248,132
 Maav 44,252,4
 R 208,242,8448
 buffer_load_dwordx4 v248, s[16:19], s32 offen nt lds
 buffer_load_dwordx4 v249, s[16:19], s32 offen offset:1024 nt lds
 CV 12,52,53
 Maav 108,252,68
 s_waitcnt lgkmcnt(2)
 Mc 28,192,16,36
 Mc 92,192,80,100
 R 212,242,256
 buffer_load_dwordx4 v250, s[16:19], s32 offen offset:2048 nt lds
 buffer_load_dwordx4 v251, s[16:19], s32 offen offset:3072 nt lds
 v_add_f32 v195, v195, v52
 Mc 156,192,144,164
 Mc 20,196,16,36
 s_add_u32 m0, s33, 106496
 Mc 84,196,80,100
 Mvav 28,200,24
 s_mov_b32 s32, 204800
 R 216,243,8448
 buffer_load_dwordx4 v248, s[16:19], s32 offen nt lds
 buffer_load_dwordx4 v249, s[16:19], s32 offen offset:1024 nt lds
 v_add_f32 v195, v195, v53
 Mvav 92,200,88
 Mvav 156,200,152
 s_waitcnt lgkmcnt(2)
 Mvav 20,204,24
 R 220,243,256
 buffer_load_dwordx4 v250, s[16:19], s32 offen offset:2048 nt lds
 buffer_load_dwordx4 v251, s[16:19], s32 offen offset:3072 nt lds
 v_add_f32 v197, v197, v190
 Mvav 84,204,88
 Mvav 28,208,48
 R 224,240,8192
 Mvav 92,208,112
 Mvav 156,208,176
 s_waitcnt lgkmcnt(2)
 R 228,240,0
 EX 54
 EX 55
 v_add_f32 v197, v197, v191
 Mvav 20,212,48
 Mvav 84,212,112
 Mvav 28,216,56
 R 232,241,8192
 Mvav 92,216,120
 Mvav 156,216,184
 s_waitcnt lgkmcnt(2)
 R 236,241,0
 R 240,240,8448
 R 244,240,256
 R 248,241,8448
 R 252,241,256
 Mvav 20,220,56
 Mvav 84,220,120
 ds_write_b64 v202, v[142:143] offset:8
 EX 60
 EX 61
 CV 13,54,55
 Mvav 28,224,0
 Mvav 92,224,64
 Mvav 156,224,128
 s_waitcnt lgkmcnt(6)
 Mvav 20,228,0
 EX 62
 EX 63
 EX 116
 Mvav 84,228,64
 s_waitcnt vmcnt(8) lgkmcnt(0)
 s_barrier
 Mvav 28,232,8
 Mvav 92,232,72
 Mvav 156,232,136
 T 192,212,16384
 T 194,212,24576
 EX 117
 EX 118
 Mvav 20,236,8
 Mvav 84,236,72
 Mvav 28,240,32
 ds_read_b64 v[140:141], v203 offset:8
 T 196,208,16384
 EX 119
 EX 124
 Mvav 92,240,96
 Mvav 156,240,160
 Mvav 20,244,32
 T 198,208,24576
 Mvav 84,244,96
 T 200,213,16384
 T 202,213,24576
 EX 125
 EX 126
 Mvav 28,248,40
 Mvav 92,248,104
 Mvav 156,248,168
 EX 127
 Mvav 20,252,40
 T 204,209,16384
 T 206,209,24576
 CV 14,60,61
 CV 15,62,63
 CV 76,116,117
 CV 77,118,119
 CV 78,124,125
 CV 79,126,127
 Mvav 84,252,104
 s_waitcnt lgkmcnt(5)
 Maav 16,192,12
 s_add_u32 m0, s33, 65536
 T 208,214,16384
 T 210,214,24576
 Maav 80,192,76
 s_mov_b32 s32, 114816
 Maav 144,192,140
 s_waitcnt lgkmcnt(4)
 Maav 0,196,12
 T 212,210,16384
 T 214,210,24576
 Maav 64,196,76
 Maav 20,200,12
 T 216,215,16384
 T 218,215,24576
 Maav 84,200,76
 Maav 148,200,140
 s_waitcnt lgkmcnt(4)
 T 220,211,16384
 T 222,211,24576
 buffer_load_dwordx4 v252, s[20:23], s32 offen lds
 buffer_load_dwordx4 v253, s[20:23], s32 offen offset:1024 lds
 Maav 4,204,12
 Maav 68,204,76
 Maav 24,208,12
 T 224,212,16640
 T 226,212,24832
 Maav 88,208,76
 Maav 152,208,140
 s_waitcnt lgkmcnt(4)
 buffer_load_dwordx4 v254, s[20:23], s32 offen offset:2048 lds
 T 228,208,16640
 T 230,208,24832
 buffer_load_dwordx4 v255, s[20:23], s32 offen offset:3072 lds
 Maav 8,212,12
 s_add_u32 m0, s33, 73728
 Maav 72,212,76
 Maav 28,216,12
 s_mov_b32 s32, 129152
 T 232,213,16640
 T 234,213,24832
 buffer_load_dwordx4 v252, s[20:23], s32 offen lds
 buffer_load_dwordx4 v253, s[20:23], s32 offen offset:1024 lds
 Maav 92,216,76
 Maav 156,216,140
 s_waitcnt lgkmcnt(4)
 T 236,209,16640
 T 238,209,24832
 T 240,214,16640
 T 242,214,24832
 T 244,210,16640
 T 246,210,24832
 T 248,215,16640
 T 250,215,24832
 T 252,211,16640
 T 254,211,24832
 Maav 12,220,12
 Maav 76,220,76
 s_waitcnt lgkmcnt(12)
 Maav 48,224,12
 Maav 112,224,76
 buffer_load_dwordx4 v254, s[20:23], s32 offen offset:2048 lds
 Maav 176,224,140
 s_waitcnt lgkmcnt(10)
 Maav 32,228,12
 buffer_load_dwordx4 v255, s[20:23], s32 offen offset:3072 lds
 Maav 96,228,76
 s_waitcnt lgkmcnt(0)
 s_barrier
 Maav 52,232,12
 Maav 116,232,76
 Maav 180,232,140
 R 192,234,40960
 v_add_f32 v196, v196, v116
 v_add_f32 v195, v195, v54
 EX 156
 Maav 36,236,12
 Maav 100,236,76
 Maav 56,240,12
 R 196,234,32768
 v_add_f32 v196, v196, v117
 v_add_f32 v195, v195, v55
 EX 157
 v_add_f32 v197, v197, v156
 Maav 120,240,76
 Maav 184,240,140
 Maav 40,244,12
 Maav 104,244,76
 v_add_f32 v196, v196, v118
 R 200,235,40960
 v_add_f32 v195, v195, v60
 EX 158
 CV 134,156,157
 Maav 60,248,12
 v_add_f32 v196, v196, v119
 Maav 124,248,76
 v_add_f32 v196, v196, v124
 Maav 188,248,140
 v_add_f32 v195, v195, v61
 v_add_f32 v196, v196, v125
 Maav 44,252,12
 R 204,235,32768
 v_add_f32 v195, v195, v62
 v_add_f32 v196, v196, v126
 Maav 108,252,76
 s_waitcnt lgkmcnt(2)
 v_add_f32 v195, v195, v63
 v_add_f32 v196, v196, v127
 Mc 60,192,16,36
 R 208,234,41216
 Mc 124,192,80,100
 Mc 188,192,144,164
 Mc 52,196,16,36
 R 212,234,33024
 EX 159
 EX 20
 v_add_f32 v197, v197, v157
 Mc 116,196,80,100
 s_waitcnt lgkmcnt(3)
 Mvav 60,200,24
 R 216,235,41216
 Mvav 124,200,88
 Mvav 188,200,152
 s_waitcnt lgkmcnt(2)
 R 220,235,33024
 CV 135,158,159
 EX 21
 EX 22
 Mvav 52,204,24
 Mvav 116,204,88
 Mvav 60,208,48
 R 224,232,40960
 Mvav 124,208,112
 R 228,232,32768
 EX 23
 EX 28
 CV 4,20,21
 Mvav 188,208,176
 s_waitcnt lgkmcnt(3)
 Mvav 52,212,48
 Mvav 116,212,112
 Mvav 60,216,56
 R 232,233,40960
 EX 29
 EX 30
 CV 5,22,23
 Mvav 124,216,120
 s_add_u32 m0, s33, 131072
 Mvav 188,216,184
 s_waitcnt lgkmcnt(2)
 R 236,233,32768
 R 240,232,41216
 R 244,232,33024
 R 248,233,41216
 R 252,233,33024
 Mvav 52,220,56
 s_mov_b32 s32, 212992
 Mvav 116,220,120
 Mvav 60,224,0
 ds_write_b64 v202, v[134:135]
 Mvav 124,224,64
 Mvav 188,224,128
 s_waitcnt lgkmcnt(6)
 buffer_load_dwordx4 v248, s[16:19], s32 offen nt lds
 buffer_load_dwordx4 v249, s[16:19], s32 offen offset:1024 nt lds
 buffer_load_dwordx4 v250, s[16:19], s32 offen offset:2048 nt lds
 Mvav 52,228,0
 Mvav 116,228,64
 s_waitcnt vmcnt(11) lgkmcnt(0)
 s_barrier
 Mvav 60,232,8
 T 192,220,32768
 T 194,220,40960
 buffer_load_dwordx4 v251, s[16:19], s32 offen offset:3072 nt lds
 EX 31
 Mvav 124,232,72
 s_add_u32 m0, s33, 139264
 Mvav 188,232,136
 Mvav 52,236,8
 s_mov_b32 s32, 221184
 Mvav 116,236,72
 ds_read_b64 v[132:133], v203
 buffer_load_dwordx4 v248, s[16:19], s32 offen nt lds
 T 196,216,32768
 buffer_load_dwordx4 v249, s[16:19], s32 offen offset:1024 nt lds
 Mvav 60,240,32
 Mvav 124,240,96
 Mvav 188,240,160
 T 198,216,40960
 T 200,221,32768
 buffer_load_dwordx4 v250, s[16:19], s32 offen offset:2048 nt lds
 EX 84
 Mvav 52,244,32
 Mvav 116,244,96
 Mvav 60,248,40
 T 202,221,40960
 Mvav 124,248,104
 Mvav 188,248,168
 EX 85
 EX 86
 EX 87
 EX 92
 EX 93
 EX 94
 EX 95
 Mvav 52,252,40
 T 204,217,32768
 T 206,217,40960
 CV 6,28,29
 CV 7,30,31
 CV 68,84,85
 CV 69,86,87
 CV 70,92,93
 CV 71,94,95
 Mvav 116,252,104
 s_waitcnt lgkmcnt(3)
 buffer_load_dwordx4 v251, s[16:19], s32 offen offset:3072 nt lds
 Maav 16,192,4
 T 208,222,32768
 T 210,222,40960
 Maav 80,192,68
 Maav 144,192,132
 Maav 0,196,4
 T 212,218,32768
 T 214,218,40960
 Maav 64,196,68
 s_waitcnt lgkmcnt(6)
 Maav 20,200,4
 T 216,223,32768
 T 218,223,40960
 Maav 84,200,68
 Maav 148,200,132
 s_waitcnt lgkmcnt(4)
 Maav 4,204,4
 T 220,219,32768
 T 222,219,40960
 Maav 68,204,68
 Maav 24,208,4
 T 224,220,33024
 T 226,220,41216
 Maav 88,208,68
 Maav 152,208,132
 s_waitcnt lgkmcnt(4)
 Maav 8,212,4
 T 228,216,33024
 T 230,216,41216
 Maav 72,212,68
 Maav 28,216,4
 T 232,221,33024
 T 234,221,41216
 Maav 92,216,68
 Maav 156,216,132
 s_waitcnt lgkmcnt(4)
 T 236,217,33024
 T 238,217,41216
 T 240,222,33024
 T 242,222,41216
 T 244,218,33024
 T 246,218,41216
 T 248,223,33024
 T 250,223,41216
 T 252,219,33024
 T 254,219,41216
 Maav 12,220,4
 Maav 76,220,68
 Maav 48,224,4
 Maav 112,224,68
 Maav 176,224,132
 s_waitcnt lgkmcnt(10)
 Maav 32,228,4
 Maav 96,228,68
 s_waitcnt lgkmcnt(0)
 s_barrier
 Maav 52,232,4
 R 192,238,57344
 v_add_f32 v195, v195, v20
 v_add_f32 v196, v196, v84
 v_add_f32 v197, v197, v158
 buffer_load_ubyte v200, v207, s[88:91], 0 offen sc1
 Maav 116,232,68
 Maav 180,232,132
 Maav 36,236,4
 R 196,238,49152
 v_add_f32 v195, v195, v21
 v_add_f32 v196, v196, v85
 v_add_f32 v197, v197, v159
 EX 188
 Maav 100,236,68
 Maav 56,240,4
 Maav 120,240,68
 Maav 184,240,132
 v_add_f32 v195, v195, v22
 v_add_f32 v196, v196, v86
 R 200,239,57344
 EX 189
 v_add_f32 v197, v197, v188
 Maav 40,244,4
 Maav 104,244,68
 Maav 60,248,4
 v_add_f32 v195, v195, v23
 v_add_f32 v196, v196, v87
 R 204,239,49152
 EX 190
 CV 142,188,189
 Maav 124,248,68
 v_add_f32 v195, v195, v28
 v_add_f32 v196, v196, v92
 Maav 188,248,132
 v_add_f32 v195, v195, v29
 v_add_f32 v196, v196, v93
 Maav 44,252,4
 v_add_f32 v195, v195, v30
 v_add_f32 v196, v196, v94
 Maav 108,252,68
 s_waitcnt lgkmcnt(1)
 v_add_f32 v195, v195, v31
 v_add_f32 v196, v196, v95
 Mc 28,192,16,36
 R 208,238,57600
 Mc 92,192,80,100
 Mc 156,192,144,164
 Mc 20,196,16,36
 R 212,238,49408
 Mc 84,196,80,100
 Mvav 28,200,24
 R 216,239,57600
 EX 191
 EX 52
 v_add_f32 v197, v197, v189
 Mvav 92,200,88
 Mvav 156,200,152
 s_waitcnt lgkmcnt(2)
 Mvav 20,204,24
 R 220,239,49408
 CV 143,190,191
 EX 53
 EX 54
 Mvav 84,204,88
 Mvav 28,208,48
 R 224,236,57344
 Mvav 92,208,112
 Mvav 156,208,176
 s_waitcnt lgkmcnt(2)
 R 228,236,49152
 EX 55
 EX 60
 CV 12,52,53
 Mvav 20,212,48
 Mvav 84,212,112
 Mvav 28,216,56
 R 232,237,57344
 Mvav 92,216,120
 Mvav 156,216,184
 s_waitcnt lgkmcnt(2)
 R 236,237,49152
 R 240,236,57600
 R 244,236,49408
 R 248,237,57600
 R 252,237,49408
 Mvav 20,220,56
 Mvav 84,220,120
 ds_write_b64 v202, v[142:143] offset:8
 EX 61
 EX 62
 CV 13,54,55
 Mvav 28,224,0
 Mvav 92,224,64
 Mvav 156,224,128
 s_waitcnt lgkmcnt(6)
 Mvav 20,228,0
 EX 63
 EX 116
 EX 117
 Mvav 84,228,64
 s_waitcnt vmcnt(1) lgkmcnt(0)
 s_barrier
 Mvav 28,232,8
 s_add_u32 m0, s33, 32768
 Mvav 92,232,72
 s_mov_b32 s32, 229376
 Mvav 156,232,136
 T 192,228,0
 T 194,228,8192
 buffer_load_dwordx4 v248, s[16:19], s32 offen nt lds
 buffer_load_dwordx4 v249, s[16:19], s32 offen offset:1024 nt lds
 Mvav 20,236,8
 Mvav 84,236,72
 Mvav 28,240,32
 ds_read_b64 v[140:141], v203 offset:8
 T 196,224,0
 buffer_load_dwordx4 v250, s[16:19], s32 offen offset:2048 nt lds
 EX 118
 Mvav 92,240,96
 Mvav 156,240,160
 Mvav 20,244,32
 T 198,224,8192
 Mvav 84,244,96
 T 200,229,0
 T 202,229,8192
 EX 119
 EX 124
 Mvav 28,248,40
 Mvav 92,248,104
 Mvav 156,248,168
 EX 125
 EX 126
 EX 127
 Mvav 20,252,40
 T 204,225,0
 T 206,225,8192
 CV 14,60,61
 CV 15,62,63
 CV 76,116,117
 CV 77,118,119
 CV 78,124,125
 CV 79,126,127
 Mvav 84,252,104
 s_waitcnt lgkmcnt(5)
 buffer_load_dwordx4 v251, s[16:19], s32 offen offset:3072 nt lds
 Maav 16,192,12
 s_add_u32 m0, s33, 40960
 T 208,230,0
 T 210,230,8192
 Maav 80,192,76
 s_mov_b32 s32, 237568
 buffer_load_dwordx4 v248, s[16:19], s32 offen nt lds
 Maav 144,192,140
 s_waitcnt lgkmcnt(4)
 Maav 0,196,12
 buffer_load_dwordx4 v249, s[16:19], s32 offen offset:1024 nt lds
 T 212,226,0
 T 214,226,8192
 Maav 64,196,76
 Maav 20,200,12
 buffer_load_dwordx4 v250, s[16:19], s32 offen offset:2048 nt lds
 T 216,231,0
 T 218,231,8192
 Maav 84,200,76
 Maav 148,200,140
 s_waitcnt lgkmcnt(4)
 buffer_load_dwordx4 v251, s[16:19], s32 offen offset:3072 nt lds
 Maav 4,204,12
 T 220,227,0
 T 222,227,8192
 Maav 68,204,76
 Maav 24,208,12
 T 224,228,256
 T 226,228,8448
 Maav 88,208,76
 Maav 152,208,140
 s_waitcnt lgkmcnt(4)
 Maav 8,212,12
 T 228,224,256
 T 230,224,8448
 Maav 72,212,76
 Maav 28,216,12
 T 232,229,256
 T 234,229,8448
 Maav 92,216,76
 Maav 156,216,140
 s_waitcnt lgkmcnt(4)
 T 236,225,256
 T 238,225,8448
 T 240,230,256
 T 242,230,8448
 T 244,226,256
 T 246,226,8448
 T 248,231,256
 T 250,231,8448
 T 252,227,256
 T 254,227,8448
 Maav 12,220,12
 Maav 76,220,76
 Maav 48,224,12
 Maav 112,224,76
 Maav 176,224,140
 s_waitcnt lgkmcnt(10)
 Maav 32,228,12
 Maav 96,228,76
 s_waitcnt lgkmcnt(0)
 s_barrier
 Maav 52,232,12
 s_add_u32 m0, s33, 98304
 Maav 116,232,76
 s_mov_b32 s32, 245760
 R 192,234,24576
 v_add_f32 v195, v195, v52
 v_add_f32 v196, v196, v116
 buffer_load_dwordx4 v248, s[16:19], s32 offen nt lds
 v_add_f32 v197, v197, v190
 Maav 180,232,140
 Maav 36,236,12
 Maav 100,236,76
 R 196,234,16384
 v_add_f32 v195, v195, v53
 v_add_f32 v196, v196, v117
 buffer_load_dwordx4 v249, s[16:19], s32 offen offset:1024 nt lds
 v_add_f32 v197, v197, v191
 Maav 56,240,12
 Maav 120,240,76
 Maav 184,240,140
 Maav 40,244,12
 v_add_f32 v195, v195, v54
 v_add_f32 v196, v196, v118
 R 200,235,24576
 buffer_load_dwordx4 v250, s[16:19], s32 offen offset:2048 nt lds
 Maav 104,244,76
 Maav 60,248,12
 v_add_f32 v195, v195, v55
 v_add_f32 v196, v196, v119
 Maav 124,248,76
 v_add_f32 v195, v195, v60
 v_add_f32 v196, v196, v124
 Maav 188,248,140
 v_add_f32 v195, v195, v61
 v_add_f32 v196, v196, v125
 Maav 44,252,12
 R 204,235,16384
 v_add_f32 v195, v195, v62
 v_add_f32 v196, v196, v126
 Maav 108,252,76
 s_waitcnt lgkmcnt(2)
 buffer_load_dwordx4 v251, s[16:19], s32 offen offset:3072 nt lds
 v_add_f32 v195, v195, v63
 v_add_f32 v196, v196, v127
 Mc 60,192,16,36
 s_add_u32 m0, s33, 106496
 R 208,234,24832
 Mc 124,192,80,100
 s_mov_b32 s32, 253952
 buffer_load_dwordx4 v248, s[16:19], s32 offen nt lds
 Mc 188,192,144,164
 Mc 52,196,16,36
 buffer_load_dwordx4 v249, s[16:19], s32 offen offset:1024 nt lds
 R 212,234,16640
 Mc 116,196,80,100
 s_waitcnt lgkmcnt(3)
 Mvav 60,200,24
 buffer_load_dwordx4 v250, s[16:19], s32 offen offset:2048 nt lds
 R 216,235,24832
 Mvav 124,200,88
 Mvav 188,200,152
 s_waitcnt lgkmcnt(2)
 buffer_load_dwordx4 v251, s[16:19], s32 offen offset:3072 nt lds
 Mvav 52,204,24
 R 220,235,16640
 Mvav 116,204,88
 Mvav 60,208,48
 R 224,232,24576
 Mvav 124,208,112
 R 228,232,16384
 EX 156
 EX 157
 s_waitcnt vmcnt(16)
 v_cmp_eq_u32 vcc, 1, v200
 Mvav 188,208,176
 s_waitcnt lgkmcnt(3)
 Mvav 52,212,48
 s_mov_b32 s43, vcc_lo
 Mvav 116,212,112
 Mvav 60,216,56
 R 232,233,24576
 EX 158
 EX 159
 CV 134,156,157
 Mvav 124,216,120
 Mvav 188,216,184
 s_waitcnt lgkmcnt(2)
 R 236,233,16384
 R 240,232,24832
 R 244,232,16640
 R 248,233,24832
 R 252,233,16640
 Mvav 52,220,56
 Mvav 116,220,120
 CV 135,158,159
 Mvav 60,224,0
 ds_write_b64 v202, v[134:135]
 Mvav 124,224,64
 Mvav 188,224,128
 s_waitcnt lgkmcnt(6)
 EX 20
 EX 21
 EX 22
 Mvav 52,228,0
 Mvav 116,228,64
 s_waitcnt vmcnt(8) lgkmcnt(0)
 s_barrier
 Mvav 60,232,8
 Mvav 124,232,72
 T 192,212,32768
 T 194,212,40960
 EX 23
 EX 28
 Mvav 188,232,136
 Mvav 52,236,8
 Mvav 116,236,72
 ds_read_b64 v[132:133], v203
 T 196,208,32768
 EX 29
 EX 30
 Mvav 60,240,32
 Mvav 124,240,96
 Mvav 188,240,160
 Mvav 52,244,32
 T 198,208,40960
 T 200,213,32768
 EX 31
 EX 84
 Mvav 116,244,96
 Mvav 60,248,40
 T 202,213,40960
 Mvav 124,248,104
 Mvav 188,248,168
 EX 85
 EX 86
 EX 87
 EX 92
 EX 93
 EX 94
 EX 95
 Mvav 52,252,40
 T 204,209,32768
 T 206,209,40960
 CV 4,20,21
 CV 5,22,23
 CV 6,28,29
 CV 7,30,31
 CV 68,84,85
 CV 69,86,87
 CV 70,92,93
 CV 71,94,95
 Mvav 116,252,104
 s_waitcnt lgkmcnt(5)
 Maav 16,192,4
 T 208,214,32768
 T 210,214,40960
 Maav 80,192,68
 T 212,210,32768
 T 214,210,40960
 Maav 144,192,132
 s_waitcnt lgkmcnt(6)
 T 216,215,32768
 T 218,215,40960
 Maav 0,196,4
 T 220,211,32768
 T 222,211,40960
 Maav 64,196,68
 T 224,212,33024
 T 226,212,41216
 Maav 20,200,4
 s_add_u32 m0, s33, 131072
 T 228,208,33024
 T 230,208,41216
 Maav 84,200,68
 s_mov_b32 s32, 114944
 buffer_load_dwordx4 v252, s[20:23], s32 offen lds
 Maav 148,200,132
 s_waitcnt lgkmcnt(10)
 buffer_load_dwordx4 v253, s[20:23], s32 offen offset:1024 lds
 Maav 4,204,4
 T 232,213,33024
 T 234,213,41216
 Maav 68,204,68
 s_waitcnt lgkmcnt(8)
 buffer_load_dwordx4 v254, s[20:23], s32 offen offset:2048 lds
 Maav 24,208,4
 T 236,209,33024
 T 238,209,41216
 Maav 88,208,68
 T 240,214,33024
 T 242,214,41216
 Maav 152,208,132
 s_waitcnt lgkmcnt(6)
 T 244,210,33024
 T 246,210,41216
 Maav 8,212,4
 T 248,215,33024
 T 250,215,41216
 Maav 72,212,68
 T 252,211,33024
 T 254,211,41216
 Maav 28,216,4
 EX 188
 Maav 92,216,68
 EX 189
 Maav 156,216,132
 s_waitcnt lgkmcnt(8)
 EX 190
 Maav 12,220,4
 EX 191
 Maav 76,220,68
 buffer_load_dwordx4 v255, s[20:23], s32 offen offset:3072 lds
 CV 142,188,189
 CV 143,190,191
 Maav 48,224,4
 s_add_u32 m0, s33, 139264
 ds_write_b64 v202, v[142:143] offset:8
 s_mov_b32 s32, 129280
 Maav 112,224,68
 buffer_load_dwordx4 v252, s[20:23], s32 offen lds
 Maav 176,224,132
 buffer_load_dwordx4 v253, s[20:23], s32 offen offset:1024 lds
 Maav 32,228,4
 buffer_load_dwordx4 v254, s[20:23], s32 offen offset:2048 lds
 Maav 96,228,68
 s_waitcnt vmcnt(7) lgkmcnt(0)
 s_barrier
 T 192,220,32768
 Maav 52,232,4
 buffer_load_dwordx4 v255, s[20:23], s32 offen offset:3072 lds
 Maav 116,232,68
 T 194,220,40960
 ds_read_b64 v[140:141], v203 offset:8
 Maav 180,232,132
 v_add_f32 v195, v195, v20
 v_add_f32 v196, v196, v84
 Maav 36,236,4
 T 196,221,32768
 T 198,221,40960
 Maav 100,236,68
 v_add_f32 v195, v195, v21
 v_add_f32 v196, v196, v85
 Maav 56,240,4
 v_add_f32 v195, v195, v22
 v_add_f32 v196, v196, v86
 Maav 120,240,68
 v_add_f32 v195, v195, v23
 v_add_f32 v196, v196, v87
 Maav 184,240,132
 T 200,222,32768
 T 202,222,40960
 Maav 40,244,4
 v_add_f32 v197, v197, v156
 v_add_f32 v195, v195, v28
 Maav 104,244,68
 v_add_f32 v196, v196, v92
 v_add_f32 v197, v197, v157
 Maav 60,248,4
 v_add_f32 v195, v195, v29
 v_add_f32 v196, v196, v93
 Maav 124,248,68
 EX 52
 Maav 188,248,132
 EX 53
 EX 54
 EX 55
 EX 60
 EX 61
 EX 62
 EX 63
 EX 116
 EX 117
 EX 118
 EX 119
 EX 124
 EX 125
 EX 126
 EX 127
 Maav 44,252,4
 v_add_f32 v197, v197, v158
 v_add_f32 v195, v195, v30
 v_add_f32 v196, v196, v94
 CV 12,52,53
 CV 13,54,55
 CV 14,60,61
 CV 15,62,63
 CV 76,116,117
 CV 77,118,119
 CV 78,124,125
 CV 79,126,127
 Maav 108,252,68
 s_waitcnt lgkmcnt(0)
 T 204,223,32768
 T 206,223,40960
 v_add_f32 v197, v197, v159
 v_add_f32 v195, v195, v31
 v_add_f32 v196, v196, v95
 Maav 16,192,12
 T 208,220,33024
 T 210,220,41216
 Maav 80,192,76
 T 212,221,33024
 T 214,221,41216
 Maav 144,192,140
 T 216,222,33024
 T 218,222,41216
 Maav 20,196,12
 T 220,223,33024
 T 222,223,41216
 Maav 84,196,76
 T 224,216,32768
 T 226,216,40960
 Maav 148,196,140
 T 228,217,32768
 T 230,217,40960
 Maav 24,200,12
 T 232,218,32768
 s_waitcnt lgkmcnt(14)
 T 234,218,40960
 Maav 88,200,76
 s_waitcnt lgkmcnt(14)
 T 236,219,32768
 s_waitcnt lgkmcnt(14)
 T 238,219,40960
 Maav 152,200,140
 s_waitcnt lgkmcnt(12)
 T 240,216,33024
 T 242,216,41216
 Maav 28,204,12
 v_add_f32 v195, v195, v52
 v_add_f32 v196, v196, v116
 Maav 92,204,76
 T 244,217,33024
 s_waitcnt lgkmcnt(14)
 T 246,217,41216
 Maav 156,204,140
 s_waitcnt lgkmcnt(10)
 v_add_f32 v195, v195, v53
 v_add_f32 v196, v196, v117
 Maav 48,208,12
 T 248,218,33024
 T 250,218,41216
 Maav 112,208,76
 v_add_f32 v195, v195, v54
 v_add_f32 v196, v196, v118
 Maav 176,208,140
 s_waitcnt lgkmcnt(6)
 T 252,219,33024
 T 254,219,41216
 Maav 52,212,12
 v_add_f32 v195, v195, v55
 v_add_f32 v196, v196, v119
 Maav 116,212,76
 v_add_f32 v197, v197, v188
 v_add_f32 v195, v195, v60
 Maav 180,212,140
 v_add_f32 v196, v196, v124
 v_add_f32 v197, v197, v189
 Maav 56,216,12
 v_add_f32 v195, v195, v61
 v_add_f32 v196, v196, v125
 Maav 120,216,76
 v_add_f32 v197, v197, v190
 v_add_f32 v195, v195, v62
 Maav 184,216,140
 v_add_f32 v196, v196, v126
 AR 232,16
 Maav 60,220,12
 AR 233,17
 CV 16,232,233
 Maav 124,220,76
 AR 234,18
 AR 235,19
 Maav 188,220,140
 CV 17,234,235
 AR 236,20
 Maav 0,224,12
 s_add_u32 m0, s33, 32768
 AR 237,21
 CV 18,236,237
 Maav 64,224,76
 AR 238,22
 AR 239,23
 Maav 4,228,12
 s_mov_b32 s32, 115072
 buffer_load_dwordx4 v252, s[20:23], s32 offen lds
 Maav 68,228,76
 s_waitcnt lgkmcnt(0)
 s_barrier
 T 192,210,256
 Maav 8,232,12
 T 194,210,8448
 CV 19,238,239
 Maav 72,232,76
 T 196,208,256
 T 198,208,8448
 Maav 12,236,12
 buffer_load_dwordx4 v253, s[20:23], s32 offen offset:1024 lds
 Maav 76,236,76
 T 200,211,256
 T 202,211,8448
 Maav 32,240,12
 buffer_load_dwordx4 v254, s[20:23], s32 offen offset:2048 lds
 Maav 96,240,76
 T 204,209,256
 T 206,209,8448
 Maav 36,244,12
 AR 240,80
 AR 241,81
 Maav 100,244,76
 CV 80,240,241
 AR 242,82
 Maav 40,248,12
 AR 243,83
 CV 81,242,243
 Maav 104,248,76
 AR 232,84
 AR 233,85
 Maav 44,252,12
 CV 82,232,233
 AR 234,86
 AR 235,87
 CV 83,234,235
 AR 236,144
 AR 237,145
 CV 144,236,237
 AR 238,146
 AR 239,147
 CV 145,238,239
 AR 240,148
 AR 241,149
 CV 146,240,241
 AR 242,150
 AR 243,151
 CV 147,242,243
 Maav 108,252,76
 s_waitcnt lgkmcnt(2)
 buffer_load_dwordx4 v255, s[20:23], s32 offen offset:3072 lds
 v_add_f32 v197, v197, v191
 v_add_f32 v195, v195, v63
 v_add_f32 v196, v196, v127
 Mvavz 52,192,16
 s_add_u32 m0, s33, 40960
 T 208,214,256
 T 210,214,8448
 Mvavz 116,192,80
 s_mov_b32 s32, 129408
 buffer_load_dwordx4 v252, s[20:23], s32 offen lds
 Mvavz 180,192,144
 buffer_load_dwordx4 v253, s[20:23], s32 offen offset:1024 lds
 Mvavz 20,196,16
 T 212,212,256
 T 214,212,8448
 Mvavz 84,196,80
 AR 232,152
 AR 233,153
 CV 152,232,233
 AR 234,154
 AR 235,155
 CV 153,234,235
 AR 236,156
 AR 237,157
 CV 154,236,237
 AR 238,158
 AR 239,159
 CV 155,238,239
 AR 240,176
 AR 241,177
 CV 176,240,241
 AR 242,178
 AR 243,179
 CV 177,242,243
 AR 232,180
 AR 233,181
 CV 178,232,233
 AR 234,182
 AR 235,183
 CV 179,234,235
 AR 236,184
 AR 237,185
 CV 184,236,237
 AR 238,186
 AR 239,187
 CV 185,238,239
 AR 240,188
 AR 241,189
 CV 186,240,241
 AR 242,190
 AR 243,191
 CV 187,242,243
 Mvavz 60,200,16
 buffer_load_dwordx4 v254, s[20:23], s32 offen offset:2048 lds
 T 216,215,256
 T 218,215,8448
 Mvavz 124,200,80
 ds_write_b128 v202, v[144:147]
 ds_write_b128 v202, v[152:155] offset:1024
 ds_write_b128 v202, v[176:179] offset:2048
 ds_write_b128 v202, v[184:187] offset:3072
 Mvavz 188,200,144
 s_waitcnt lgkmcnt(8)
 buffer_load_dwordx4 v255, s[20:23], s32 offen offset:3072 lds
 Mvavz 28,204,16
 T 220,213,256
 T 222,213,8448
 AR 232,24
 AR 233,25
 CV 24,232,233
 AR 234,26
 AR 235,27
 CV 25,234,235
 AR 236,28
 AR 237,29
 CV 26,236,237
 AR 238,30
 AR 239,31
 CV 27,238,239
 AR 240,88
 AR 241,89
 CV 88,240,241
 AR 242,90
 AR 243,91
 CV 89,242,243
 AR 232,92
 AR 233,93
 CV 90,232,233
 AR 234,94
 AR 235,95
 CV 91,234,235
 Mvavz 92,204,80
 s_waitcnt lgkmcnt(0)
 s_barrier
 T 224,210,0
 Mvav 52,208,24
 T 226,210,8192
 ds_read_b128 v[128:131], v203
 Mvav 116,208,88
 T 228,208,0
 T 230,208,8192
 Mvav 180,208,152
 T 232,211,0
 T 234,211,8192
 Mvav 20,212,24
 T 236,209,0
 T 238,209,8192
 Mvav 84,212,88
 T 240,214,0
 T 242,214,8192
 Mvav 60,216,24
 T 244,212,0
 T 246,212,8192
 Mvav 124,216,88
 T 248,215,0
 T 250,215,8192
 Mvav 188,216,152
 s_waitcnt lgkmcnt(12)
 T 252,213,0
 T 254,213,8192
 Mvav 28,220,24
 AR 236,0
 AR 237,1
 CV 0,236,237
 AR 238,2
 AR 239,3
 CV 1,238,239
 AR 240,4
 AR 241,5
 CV 2,240,241
 AR 242,6
 AR 243,7
 CV 3,242,243
 AR 232,64
 AR 233,65
 CV 64,232,233
 AR 234,66
 AR 235,67
 CV 65,234,235
 AR 236,68
 AR 237,69
 CV 66,236,237
 AR 238,70
 AR 239,71
 CV 67,238,239
 Mvav 92,220,88
 s_waitcnt lgkmcnt(10)
 ds_read_b128 v[136:139], v203 offset:1024
 AR 240,8
 Mvav 52,224,0
 ds_read_b128 v[160:163], v203 offset:2048
 AR 241,9
 Mvav 116,224,64
 ds_read_b128 v[168:171], v203 offset:3072
 CV 8,240,241
 Mvav 180,224,128
 s_waitcnt lgkmcnt(7)
 AR 242,10
 AR 243,11
 Mvav 20,228,0
 CV 9,242,243
 AR 232,12
 Mvav 84,228,64
 s_waitcnt lgkmcnt(0)
 s_barrier
 AR 233,13
 Mvav 60,232,0
 CV 10,232,233
 AR 234,14
 Mvav 124,232,64
 AR 235,15
 CV 11,234,235
 Mvav 188,232,128
 AR 236,72
 AR 237,73
 Mvav 28,236,0
 CV 72,236,237
 AR 238,74
 AR 239,75
 CV 73,238,239
 AR 240,76
 AR 241,77
 CV 74,240,241
 AR 242,78
 AR 243,79
 CV 75,242,243
 Mvav 92,236,64
 T 192,210,49408
 T 194,210,57600
 Mvav 52,240,8
 T 196,208,49408
 T 198,208,57600
 Mvav 116,240,72
 T 200,211,49408
 T 202,211,57600
 Mvav 180,240,136
 T 204,209,49408
 T 206,209,57600
 Mvav 20,244,8
 AR 232,48
 AR 233,49
 Mvav 84,244,72
 CV 48,232,233
 AR 234,50
 Mvav 60,248,8
 AR 235,51
 CV 49,234,235
 Mvav 124,248,72
 AR 236,52
 AR 237,53
 Mvav 188,248,136
 CV 50,236,237
 AR 238,54
 Mvav 28,252,8
 AR 239,55
 CV 51,238,239
 AR 240,112
 AR 241,113
 CV 112,240,241
 AR 242,114
 AR 243,115
 CV 113,242,243
 AR 232,116
 AR 233,117
 CV 114,232,233
 AR 234,118
 AR 235,119
 CV 115,234,235
 Mvav 92,252,72
 s_waitcnt lgkmcnt(0)
 T 208,214,49408
 T 210,214,57600
 Mvav 52,192,48
 T 212,212,49408
 T 214,212,57600
 Mvav 116,192,112
 T 216,215,49408
 T 218,215,57600
 Mvav 180,192,176
 T 220,213,49408
 T 222,213,57600
 Mvav 20,196,48
 AR 236,56
 AR 237,57
 Mvav 84,196,112
 CV 56,236,237
 AR 238,58
 Mvav 60,200,48
 s_add_u32 m0, s33, 0
 AR 239,59
 CV 57,238,239
 Mvav 124,200,112
 s_mov_b32 s32, 115200
 AR 240,60
 AR 241,61
 Mvav 188,200,176
 CV 58,240,241
 AR 242,62
 Mvav 28,204,48
 AR 243,63
 CV 59,242,243
 AR 232,120
 AR 233,121
 CV 120,232,233
 AR 234,122
 AR 235,123
 CV 121,234,235
 AR 236,124
 AR 237,125
 CV 122,236,237
 AR 238,126
 AR 239,127
 CV 123,238,239
 Mvav 92,204,112
 s_waitcnt lgkmcnt(0)
 T 224,210,49152
 T 226,210,57344
 Mvav 52,208,56
 buffer_load_dwordx4 v252, s[20:23], s32 offen lds
 Mvav 116,208,120
 T 228,208,49152
 T 230,208,57344
 Mvav 180,208,184
 buffer_load_dwordx4 v253, s[20:23], s32 offen offset:1024 lds
 Mvav 20,212,56
 T 232,211,49152
 T 234,211,57344
 Mvav 84,212,120
 buffer_load_dwordx4 v254, s[20:23], s32 offen offset:2048 lds
 Mvav 60,216,56
 T 236,209,49152
 T 238,209,57344
 Mvav 124,216,120
 T 240,214,49152
 T 242,214,57344
 Mvav 188,216,184
 T 244,212,49152
 T 246,212,57344
 T 248,215,49152
 T 250,215,57344
 T 252,213,49152
 s_waitcnt lgkmcnt(14)
 T 254,213,57344
 Mvav 28,220,56
 AR 240,32
 AR 241,33
 CV 32,240,241
 AR 242,34
 AR 243,35
 CV 33,242,243
 AR 232,36
 AR 233,37
 CV 34,232,233
 AR 234,38
 AR 235,39
 CV 35,234,235
 AR 236,96
 AR 237,97
 CV 96,236,237
 AR 238,98
 AR 239,99
 CV 97,238,239
 AR 240,100
 AR 241,101
 CV 98,240,241
 AR 242,102
 AR 243,103
 CV 99,242,243
 Mvav 92,220,120
 s_waitcnt lgkmcnt(12)
 buffer_load_dwordx4 v255, s[20:23], s32 offen offset:3072 lds
 v_max3_f32 v198, v195, v196, v197
 v_cmp_ngt_f32 vcc, s36, v198
 v_mov_b32 v200, v197
 s_cmp_lg_u64 vcc, 0
 s_cselect_b32 s45, s37, 0
 v_mov_b32 v201, s45
 ds_write_b64 v202, v[200:201]
 v_and_b32 v199, 48, v204
 v_lshlrev_b32 v199, 8, v199
 v_add_u32 v199, 81920, v199
 Mvav 52,224,32
 s_add_u32 m0, s33, 8192
 s_mov_b32 s32, 129536
 AR 232,40
 Mvav 116,224,96
 buffer_load_dwordx4 v252, s[20:23], s32 offen lds
 Mvav 180,224,160
 s_waitcnt lgkmcnt(9)
 buffer_load_dwordx4 v253, s[20:23], s32 offen offset:1024 lds
 Mvav 20,228,32
 buffer_load_dwordx4 v254, s[20:23], s32 offen offset:2048 lds
 Mvav 84,228,96
 s_waitcnt lgkmcnt(0)
 s_barrier
 ds_read_b32 v198, v203
 Mvav 60,232,32
 ds_read_b32 v199, v199 offset:4
 AR 233,41
 Mvav 124,232,96
 buffer_load_dwordx4 v255, s[20:23], s32 offen offset:3072 lds
 Mvav 188,232,160
 CV 40,232,233
 AR 234,42
 Mvav 28,236,32
 AR 235,43
 CV 41,234,235
 AR 236,44
 AR 237,45
 CV 42,236,237
 AR 238,46
 AR 239,47
 CV 43,238,239
 AR 240,104
 AR 241,105
 CV 104,240,241
 AR 242,106
 AR 243,107
 CV 105,242,243
 AR 232,108
 AR 233,109
 CV 106,232,233
 AR 234,110
 AR 235,111
 CV 107,234,235
 Mvav 92,236,96
 T 192,226,16640
 T 194,226,24832
 Mvav 52,240,40
 T 196,224,16640
 T 198,224,24832
 Mvav 116,240,104
 T 200,227,16640
 T 202,227,24832
 Mvav 180,240,168
 T 204,225,16640
 T 206,225,24832
 Mvav 20,244,40
 T 208,230,16640
 T 210,230,24832
 Mvav 84,244,104
 s_waitcnt lgkmcnt(10)
 T 212,228,16640
 T 214,228,24832
 Mvav 60,248,40
 v_add_f32 v197, v197, v198
 v_mov_b32 v192, v195
 Mvav 124,248,104
 T 216,231,16640
 T 218,231,24832
 Mvav 188,248,168
 s_waitcnt lgkmcnt(10)
 v_mov_b32 v193, v196
 v_mov_b32 v194, v197
 Mvav 28,252,40
 T 220,229,16640
 T 222,229,24832
 Mvav 92,252,104
 s_waitcnt lgkmcnt(8)
 v_permlane16_swap_b32 v195, v192
 v_add_f32 v195, v195, v192
 Mvavz 36,192,16
 v_mov_b32 v192, v195
 v_permlane16_swap_b32 v196, v193
 Mvavz 100,192,80
 v_add_f32 v196, v196, v193
 v_mov_b32 v193, v196
 Mvavz 164,192,144
 v_permlane16_swap_b32 v197, v194
 v_add_f32 v197, v197, v194
 Mvavz 4,196,16
 s_add_u32 s40, s68, 0
 v_mov_b32 v194, v197
 v_cmp_ne_u32 vcc, 0, v199
 Mvavz 68,196,80
 v_permlane32_swap_b32 v195, v192
 v_add_f32 v195, v195, v192
 Mvavz 44,200,16
 s_cbranch_vccnz L_restart
 v_rcp_f32 v195, v195
 Mvavz 108,200,80
 v_permlane32_swap_b32 v196, v193
 v_add_f32 v196, v196, v193
 Mvavz 172,200,144
 v_rcp_f32 v196, v196
 Mvavz 12,204,16
 v_permlane32_swap_b32 v197, v194
 v_add_f32 v197, v197, v194
 Mvavz 76,204,80
 s_waitcnt lgkmcnt(0)
 v_rcp_f32 v197, v197
 Mvav 36,208,24
 T 224,226,16384
 T 226,226,24576
 Mvav 100,208,88
 T 228,224,16384
 T 230,224,24576
 Mvav 164,208,152
 T 232,227,16384
 T 234,227,24576
 Mvav 4,212,24
 T 236,225,16384
 T 238,225,24576
 Mvav 68,212,88
 T 240,230,16384
 T 242,230,24576
 Mvav 44,216,24
 T 244,228,16384
 T 246,228,24576
 Mvav 108,216,88
 T 248,231,16384
 T 250,231,24576
 Mvav 172,216,152
 s_waitcnt lgkmcnt(12)
 T 252,229,16384
 T 254,229,24576
 Mvav 12,220,24
 v_mul_f32 v20, v20, v195
 v_mul_f32 v21, v21, v195
 Mvav 76,220,88
 s_waitcnt lgkmcnt(10)
 v_mul_f32 v22, v22, v195
 v_mul_f32 v23, v23, v195
 Mvav 36,224,0
 v_mul_f32 v28, v28, v195
 v_mul_f32 v29, v29, v195
 Mvav 100,224,64
 v_mul_f32 v30, v30, v195
 v_mul_f32 v31, v31, v195
 Mvav 164,224,128
 CV 20,20,21
 CV 21,22,23
 Mvav 4,228,0
 CV 22,28,29
 CV 23,30,31
 s_cmp_eq_u32 s78, 0
 s_cselect_b32 s79, 0x10000000, s40
 s_cbranch_scc1 LE1_k00
LE1_k00b:
 buffer_store_dwordx4 v[20:23], v204, s[24:27], s79 offen sc1
 Mvav 68,228,64
 s_waitcnt lgkmcnt(0)
 s_barrier
 T 192,218,256
 Mvav 44,232,0
 s_add_u32 m0, s33, 147456
 T 194,218,8448
 v_mul_f32 v52, v52, v195
 Mvav 108,232,64
 s_mov_b32 s32, 115328
 buffer_load_dwordx4 v252, s[20:23], s32 offen lds
 Mvav 172,232,128
 T 196,216,256
 T 198,216,8448
 Mvav 12,236,0
 buffer_load_dwordx4 v253, s[20:23], s32 offen offset:1024 lds
 Mvav 76,236,64
 T 200,219,256
 T 202,219,8448
 Mvav 36,240,8
 buffer_load_dwordx4 v254, s[20:23], s32 offen offset:2048 lds
 Mvav 100,240,72
 v_mul_f32 v53, v53, v195
 v_mul_f32 v54, v54, v195
 Mvav 164,240,136
 v_mul_f32 v55, v55, v195
 v_mul_f32 v60, v60, v195
 Mvav 4,244,8
 v_mul_f32 v61, v61, v195
 v_mul_f32 v62, v62, v195
 Mvav 68,244,72
 v_mul_f32 v63, v63, v195
 CV 52,52,53
 Mvav 44,248,8
 CV 53,54,55
 CV 54,60,61
 Mvav 108,248,72
 CV 55,62,63
 s_cmp_eq_u32 s78, 1
 s_cselect_b32 s79, 0x10000000, s40
 s_cbranch_scc1 LE1_k01
LE1_k01b:
 Mvav 172,248,136
 buffer_store_dwordx4 v[52:55], v204, s[24:27], s79 offen offset:1024 sc1
 Mvav 12,252,8
 T 204,217,256
 T 206,217,8448
 Mvav 76,252,72
 s_waitcnt lgkmcnt(2)
 buffer_load_dwordx4 v255, s[20:23], s32 offen offset:3072 lds
 Mvav 36,192,48
 s_add_u32 m0, s33, 155648
 T 208,222,256
 T 210,222,8448
 Mvav 100,192,112
 s_mov_b32 s32, 129664
 buffer_load_dwordx4 v252, s[20:23], s32 offen lds
 Mvav 164,192,176
 buffer_load_dwordx4 v253, s[20:23], s32 offen offset:1024 lds
 Mvav 4,196,48
 s_lshl_b32 s66, s39, 3
 T 212,220,256
 T 214,220,8448
 Mvav 68,196,112
 buffer_load_dwordx4 v254, s[20:23], s32 offen offset:2048 lds
 Mvav 44,200,48
 s_add_u32 s66, s66, s44
 T 216,223,256
 T 218,223,8448
 Mvav 108,200,112
 s_mul_i32 s66, s66, 2293760
 buffer_load_dwordx4 v255, s[20:23], s32 offen offset:3072 lds
 Mvav 172,200,176
 s_waitcnt lgkmcnt(4)
 T 220,221,256
 T 222,221,8448
 Mvav 12,204,48
 s_add_u32 s12, s58, s66
 s_addc_u32 s13, s59, 0
 T 224,218,0
 T 226,218,8192
 Mvav 76,204,112
 v_mul_f32 v84, v84, v196
 v_mul_f32 v85, v85, v196
 Mvav 36,208,56
 s_mov_b32 s14, 2293760
 v_mul_f32 v86, v86, v196
 v_mul_f32 v87, v87, v196
 Mvav 100,208,120
 s_mov_b32 s16, s92
 v_mul_f32 v92, v92, v196
 v_mul_f32 v93, v93, v196
 v_mul_f32 v94, v94, v196
 v_mul_f32 v95, v95, v196
 CV 84,84,85
 CV 85,86,87
 CV 86,92,93
 CV 87,94,95
 s_cmp_eq_u32 s78, 2
 s_cselect_b32 s79, 0x10000000, s40
 s_cbranch_scc1 LE1_k02
LE1_k02b:
 buffer_store_dwordx4 v[84:87], v204, s[24:27], s79 offen offset:2048 sc1
 Mvav 164,208,184
 s_waitcnt lgkmcnt(4)
 T 228,216,0
 T 230,216,8192
 Mvav 4,212,56
 s_mov_b32 s17, s93
 T 232,219,0
 T 234,219,8192
 Mvav 68,212,120
 T 236,217,0
 T 238,217,8192
 Mvav 44,216,56
 s_mov_b32 s18, 2293760
 T 240,222,0
 T 242,222,8192
 Mvav 108,216,120
 s_mov_b32 s19, 0x00020000
 T 244,220,0
 T 246,220,8192
 Mvav 172,216,184
 s_waitcnt lgkmcnt(10)
 T 248,223,0
 T 250,223,8192
 T 252,221,0
 T 254,221,8192
 Mvav 12,220,56
 v_mul_f32 v116, v116, v196
 v_mul_f32 v117, v117, v196
 Mvav 76,220,120
 s_waitcnt lgkmcnt(12)
 v_mul_f32 v118, v118, v196
 v_mul_f32 v119, v119, v196
 Mvav 36,224,32
 v_mul_f32 v124, v124, v196
 v_mul_f32 v125, v125, v196
 Mvav 100,224,96
 v_mul_f32 v126, v126, v196
 v_mul_f32 v127, v127, v196
 Mvav 164,224,160
 s_waitcnt lgkmcnt(6)
 CV 116,116,117
 CV 117,118,119
 Mvav 4,228,32
 CV 118,124,125
 CV 119,126,127
 Mvav 68,228,96
 s_waitcnt lgkmcnt(0)
 s_barrier
 s_cmp_eq_u32 s78, 3
 s_cselect_b32 s79, 0x10000000, s40
 s_cbranch_scc1 LE1_k03
LE1_k03b:
 Mvav 44,232,32
 buffer_store_dwordx4 v[116:119], v204, s[24:27], s79 offen offset:3072 sc1
 Mvav 108,232,96
 s_add_u32 s40, s68, 4096
 T 192,218,49408
 T 194,218,57600
 Mvav 172,232,160
 T 196,216,49408
 T 198,216,57600
 Mvav 12,236,32
 T 200,219,49408
 T 202,219,57600
 Mvav 76,236,96
 v_mul_f32 v180, v180, v197
 v_mul_f32 v181, v181, v197
 Mvav 36,240,40
 T 204,217,49408
 T 206,217,57600
 Mvav 100,240,104
 v_mul_f32 v182, v182, v197
 v_mul_f32 v183, v183, v197
 Mvav 164,240,168
 v_mul_f32 v188, v188, v197
 v_mul_f32 v189, v189, v197
 Mvav 4,244,40
 v_mul_f32 v190, v190, v197
 v_mul_f32 v191, v191, v197
 Mvav 68,244,104
 CV 180,180,181
 CV 181,182,183
 Mvav 44,248,40
 CV 182,188,189
 CV 183,190,191
 Mvav 108,248,104
 s_cmp_eq_u32 s78, 4
 s_cselect_b32 s79, 0x10000000, s40
 s_cbranch_scc1 LE1_k04
LE1_k04b:
 buffer_store_dwordx4 v[180:183], v204, s[24:27], s79 offen sc1
 Mvav 172,248,168
 T 208,222,49408
 T 210,222,57600
 Mvav 12,252,40
 T 212,220,49408
 T 214,220,57600
 Mvav 76,252,104
 s_waitcnt lgkmcnt(4)
 T 216,223,49408
 T 218,223,57600
 Mvavz 52,192,16
 T 220,221,49408
 T 222,221,57600
 Mvavz 116,192,80
 T 224,218,49152
 T 226,218,57344
 Mvavz 180,192,144
 T 228,216,49152
 T 230,216,57344
 Mvavz 20,196,16
 s_add_u32 s40, s68, 20480
 v_mul_f32 v4, v4, v195
 v_mul_f32 v5, v5, v195
 Mvavz 84,196,80
 s_waitcnt lgkmcnt(10)
 T 232,219,49152
 T 234,219,57344
 Mvavz 60,200,16
 v_mul_f32 v6, v6, v195
 v_mul_f32 v7, v7, v195
 Mvavz 124,200,80
 T 236,217,49152
 T 238,217,57344
 Mvavz 188,200,144
 s_waitcnt lgkmcnt(8)
 v_mul_f32 v12, v12, v195
 v_mul_f32 v13, v13, v195
 Mvavz 28,204,16
 T 240,222,49152
 T 242,222,57344
 Mvavz 92,204,80
 v_mul_f32 v14, v14, v195
 v_mul_f32 v15, v15, v195
 Mvav 52,208,24
 T 244,220,49152
 T 246,220,57344
 Mvav 116,208,88
 CV 4,4,5
 CV 5,6,7
 Mvav 180,208,152
 s_waitcnt lgkmcnt(6)
 T 248,223,49152
 T 250,223,57344
 Mvav 20,212,24
 CV 6,12,13
 CV 7,14,15
 Mvav 84,212,88
 T 252,221,49152
 T 254,221,57344
 Mvav 60,216,24
 s_cmp_eq_u32 s78, 5
 s_cselect_b32 s79, 0x10000000, s40
 s_cbranch_scc1 LE1_k10
LE1_k10b:
 buffer_store_dwordx4 v[4:7], v204, s[24:27], s79 offen sc1
 Mvav 124,216,88
 v_mul_f32 v36, v36, v195
 v_mul_f32 v37, v37, v195
 Mvav 188,216,152
 v_mul_f32 v38, v38, v195
 v_mul_f32 v39, v39, v195
 Mvav 28,220,24
 v_mul_f32 v44, v44, v195
 v_mul_f32 v45, v45, v195
 Mvav 92,220,88
 v_mul_f32 v46, v46, v195
 v_mul_f32 v47, v47, v195
 Mvav 52,224,0
 CV 36,36,37
 CV 37,38,39
 Mvav 116,224,64
 CV 38,44,45
 CV 39,46,47
 Mvav 180,224,128
 v_mul_f32 v68, v68, v196
 v_mul_f32 v69, v69, v196
 Mvav 20,228,0
 s_cmp_eq_u32 s78, 6
 s_cselect_b32 s79, 0x10000000, s40
 s_cbranch_scc1 LE1_k11
LE1_k11b:
 buffer_store_dwordx4 v[36:39], v204, s[24:27], s79 offen offset:1024 sc1
 Mvav 84,228,64
 s_waitcnt vmcnt(31) lgkmcnt(0)
 s_barrier
 T 192,226,256
 Mvav 60,232,0
 s_add_u32 m0, s33, 114688
 T 194,226,8448
 v_mul_f32 v70, v70, v196
 Mvav 124,232,64
 s_mov_b32 s32, 115456
 buffer_load_dwordx4 v252, s[20:23], s32 offen lds
 Mvav 188,232,128
 T 196,224,256
 T 198,224,8448
 Mvav 28,236,0
 buffer_load_dwordx4 v253, s[20:23], s32 offen offset:1024 lds
 Mvav 92,236,64
 T 200,227,256
 T 202,227,8448
 Mvav 52,240,8
 buffer_load_dwordx4 v254, s[20:23], s32 offen offset:2048 lds
 Mvav 116,240,72
 T 204,225,256
 T 206,225,8448
 Mvav 180,240,136
 buffer_load_dwordx4 v255, s[20:23], s32 offen offset:3072 lds
 Mvav 20,244,8
 s_add_u32 m0, s33, 122880
 T 208,230,256
 T 210,230,8448
 Mvav 84,244,72
 T 212,228,256
 T 214,228,8448
 Mvav 60,248,8
 s_mov_b32 s32, 129792
 buffer_load_dwordx4 v252, s[20:23], s32 offen lds
 Mvav 124,248,72
 buffer_load_dwordx4 v253, s[20:23], s32 offen offset:1024 lds
 Mvav 188,248,136
 s_waitcnt lgkmcnt(6)
 buffer_load_dwordx4 v254, s[20:23], s32 offen offset:2048 lds
 Mvav 28,252,8
 T 216,231,256
 T 218,231,8448
 Mvav 92,252,72
 buffer_load_dwordx4 v255, s[20:23], s32 offen offset:3072 lds
 Mvav 52,192,48
 T 220,229,256
 T 222,229,8448
 Mvav 116,192,112
 T 224,226,0
 T 226,226,8192
 Mvav 180,192,176
 s_waitcnt lgkmcnt(6)
 v_mul_f32 v71, v71, v196
 v_mul_f32 v76, v76, v196
 Mvav 20,196,48
 v_mul_f32 v77, v77, v196
 v_mul_f32 v78, v78, v196
 Mvav 84,196,112
 v_mul_f32 v79, v79, v196
 CV 68,68,69
 Mvav 60,200,48
 CV 69,70,71
 CV 70,76,77
 Mvav 124,200,112
 CV 71,78,79
 T 228,224,0
 Mvav 188,200,176
 T 230,224,8192
 T 232,227,0
 Mvav 28,204,48
 s_cmp_eq_u32 s78, 7
 s_cselect_b32 s79, 0x10000000, s40
 s_cbranch_scc1 LE1_k12
LE1_k12b:
 buffer_store_dwordx4 v[68:71], v204, s[24:27], s79 offen offset:2048 sc1
 Mvav 92,204,112
 T 234,227,8192
 T 236,225,0
 Mvav 52,208,56
 T 238,225,8192
 T 240,230,0
 Mvav 116,208,120
 T 242,230,8192
 T 244,228,0
 Mvav 180,208,184
 s_waitcnt lgkmcnt(9)
 T 246,228,8192
 T 248,231,0
 Mvav 20,212,56
 T 250,231,8192
 v_mul_f32 v100, v100, v196
 Mvav 84,212,120
 s_waitcnt lgkmcnt(9)
 T 252,229,0
 T 254,229,8192
 Mvav 60,216,56
 v_mul_f32 v101, v101, v196
 v_mul_f32 v102, v102, v196
 Mvav 124,216,120
 v_mul_f32 v103, v103, v196
 v_mul_f32 v108, v108, v196
 Mvav 188,216,184
 s_waitcnt lgkmcnt(7)
 v_mul_f32 v109, v109, v196
 v_mul_f32 v110, v110, v196
 Mvav 28,220,56
 v_mul_f32 v111, v111, v196
 CV 100,100,101
 Mvav 92,220,120
 CV 101,102,103
 CV 102,108,109
 Mvav 52,224,32
 CV 103,110,111
 v_mul_f32 v164, v164, v197
 Mvav 116,224,96
 s_cmp_eq_u32 s78, 8
 s_cselect_b32 s79, 0x10000000, s40
 s_cbranch_scc1 LE1_k13
LE1_k13b:
 buffer_store_dwordx4 v[100:103], v204, s[24:27], s79 offen offset:3072 sc1
 Mvav 180,224,160
 v_mul_f32 v165, v165, v197
 v_mul_f32 v166, v166, v197
 Mvav 20,228,32
 s_add_u32 s40, s68, 24576
 v_mul_f32 v167, v167, v197
 v_mul_f32 v172, v172, v197
 Mvav 84,228,96
 s_waitcnt lgkmcnt(0)
 s_barrier
 T 192,210,16640
 Mvav 60,232,32
 T 194,210,24832
 v_mul_f32 v173, v173, v197
 Mvav 124,232,96
 T 196,208,16640
 T 198,208,24832
 Mvav 188,232,160
 v_mul_f32 v174, v174, v197
 v_mul_f32 v175, v175, v197
 Mvav 28,236,32
 T 200,211,16640
 T 202,211,24832
 Mvav 92,236,96
 CV 164,164,165
 CV 165,166,167
 Mvav 52,240,40
 T 204,209,16640
 T 206,209,24832
 Mvav 116,240,104
 CV 166,172,173
 CV 167,174,175
 Mvav 180,240,168
 T 208,214,16640
 T 210,214,24832
 Mvav 20,244,40
 s_cmp_eq_u32 s78, 9
 s_cselect_b32 s79, 0x10000000, s40
 s_cbranch_scc1 LE1_k14
LE1_k14b:
 buffer_store_dwordx4 v[164:167], v204, s[24:27], s79 offen sc1
 Mvav 84,244,104
 T 212,212,16640
 T 214,212,24832
 Mvav 60,248,40
 v_lshlrev_b32 v241, 4, v204
 v_bfe_u32 v238, v207, 2, 2
 Mvav 124,248,104
 T 216,215,16640
 T 218,215,24832
 Mvav 188,248,168
 s_waitcnt lgkmcnt(6)
 v_lshrrev_b32 v239, 4, v207
 v_cmp_eq_u32 vcc, v238, v239
 Mvav 28,252,40
 T 220,213,16640
 T 222,213,24832
 Mvav 92,252,104
 v_and_b32 v238, 1, v207
 v_lshlrev_b32 v238, 4, v238
 Mvavz 36,192,16
 T 224,210,16384
 T 226,210,24576
 Mvavz 100,192,80
 v_mov_b32 v239, 0x3f80
 v_lshlrev_b32 v238, v238, v239
 Mvavz 164,192,144
 T 228,208,16384
 T 230,208,24576
 Mvavz 4,196,16
 s_add_u32 s40, s68, 40960
 v_mul_f32 v20, v20, v195
 v_mul_f32 v21, v21, v195
 Mvavz 68,196,80
 s_waitcnt lgkmcnt(6)
 T 232,211,16384
 T 234,211,24576
 Mvavz 44,200,16
 v_mul_f32 v22, v22, v195
 v_mul_f32 v23, v23, v195
 Mvavz 108,200,80
 T 236,209,16384
 T 238,209,24576
 Mvavz 172,200,144
 v_mul_f32 v28, v28, v195
 v_mul_f32 v29, v29, v195
 Mvavz 12,204,16
 T 240,214,16384
 T 242,214,24576
 Mvavz 76,204,80
 s_waitcnt lgkmcnt(6)
 v_mul_f32 v30, v30, v195
 v_mul_f32 v31, v31, v195
 Mvav 36,208,24
 T 244,212,16384
 T 246,212,24576
 Mvav 100,208,88
 CV 20,20,21
 CV 21,22,23
 Mvav 164,208,152
 T 248,215,16384
 T 250,215,24576
 Mvav 4,212,24
 CV 22,28,29
 CV 23,30,31
 Mvav 68,212,88
 T 252,213,16384
 T 254,213,24576
 Mvav 44,216,24
 s_cmp_eq_u32 s78, 10
 s_cselect_b32 s79, 0x10000000, s40
 s_cbranch_scc1 LE1_k20
LE1_k20b:
 buffer_store_dwordx4 v[20:23], v204, s[24:27], s79 offen sc1
 Mvav 108,216,88
 v_mul_f32 v52, v52, v195
 v_mul_f32 v53, v53, v195
 Mvav 172,216,152
 s_waitcnt lgkmcnt(4)
 v_mul_f32 v54, v54, v195
 v_mul_f32 v55, v55, v195
 Mvav 12,220,24
 v_mul_f32 v60, v60, v195
 v_mul_f32 v61, v61, v195
 Mvav 76,220,88
 v_mul_f32 v62, v62, v195
 v_mul_f32 v63, v63, v195
 Mvav 36,224,0
 CV 52,52,53
 CV 53,54,55
 Mvav 100,224,64
 CV 54,60,61
 CV 55,62,63
 Mvav 164,224,128
 v_mul_f32 v84, v84, v196
 v_mul_f32 v85, v85, v196
 Mvav 4,228,0
 s_cmp_eq_u32 s78, 11
 s_cselect_b32 s79, 0x10000000, s40
 s_cbranch_scc1 LE1_k21
LE1_k21b:
 buffer_store_dwordx4 v[52:55], v204, s[24:27], s79 offen offset:1024 sc1
 Mvav 68,228,64
 s_waitcnt vmcnt(36) lgkmcnt(0)
 s_barrier
 T 192,210,33024
 Mvav 44,232,0
 T 194,210,41216
 v_mul_f32 v86, v86, v196
 Mvav 108,232,64
 T 196,208,33024
 T 198,208,41216
 Mvav 172,232,128
 v_mul_f32 v87, v87, v196
 v_mul_f32 v92, v92, v196
 Mvav 12,236,0
 T 200,211,33024
 T 202,211,41216
 Mvav 76,236,64
 v_mul_f32 v93, v93, v196
 v_mul_f32 v94, v94, v196
 Mvav 36,240,8
 T 204,209,33024
 T 206,209,41216
 Mvav 100,240,72
 v_mul_f32 v95, v95, v196
 CV 84,84,85
 Mvav 164,240,136
 T 208,214,33024
 T 210,214,41216
 Mvav 4,244,8
 CV 85,86,87
 CV 86,92,93
 Mvav 68,244,72
 T 212,212,33024
 T 214,212,41216
 Mvav 44,248,8
 CV 87,94,95
 v_mul_f32 v116, v116, v196
 Mvav 108,248,72
 s_cmp_eq_u32 s78, 12
 s_cselect_b32 s79, 0x10000000, s40
 s_cbranch_scc1 LE1_k22
LE1_k22b:
 T 216,215,33024
 T 218,215,41216
 Mvav 172,248,136
 s_waitcnt lgkmcnt(6)
 buffer_store_dwordx4 v[84:87], v204, s[24:27], s79 offen offset:2048 sc1
 Mvav 12,252,8
 T 220,213,33024
 T 222,213,41216
 Mvav 76,252,72
 v_mul_f32 v117, v117, v196
 v_mul_f32 v118, v118, v196
 Mvav 36,192,48
 T 224,210,32768
 T 226,210,40960
 Mvav 100,192,112
 v_mul_f32 v119, v119, v196
 v_mul_f32 v124, v124, v196
 Mvav 164,192,176
 T 228,208,32768
 T 230,208,40960
 Mvav 4,196,48
 v_mul_f32 v125, v125, v196
 v_mul_f32 v126, v126, v196
 Mvav 68,196,112
 s_waitcnt lgkmcnt(6)
 T 232,211,32768
 T 234,211,40960
 Mvav 44,200,48
 v_mul_f32 v127, v127, v196
 CV 116,116,117
 Mvav 108,200,112
 T 236,209,32768
 T 238,209,40960
 Mvav 172,200,176
 CV 117,118,119
 CV 118,124,125
 Mvav 12,204,48
 T 240,214,32768
 T 242,214,40960
 Mvav 76,204,112
 s_waitcnt lgkmcnt(6)
 CV 119,126,127
 v_cndmask_b32 v238, 0, v238, vcc
 Mvav 36,208,56
 s_cmp_eq_u32 s78, 13
 s_cselect_b32 s79, 0x10000000, s40
 s_cbranch_scc1 LE1_k23
LE1_k23b:
 T 244,212,32768
 T 246,212,40960
 Mvav 100,208,120
 buffer_store_dwordx4 v[116:119], v204, s[24:27], s79 offen offset:3072 sc1
 Mvav 164,208,184
 T 248,215,32768
 T 250,215,40960
 Mvav 4,212,56
 s_add_u32 s40, s68, 45056
 v_and_b32 v239, 2, v207
 v_cmp_eq_u32 vcc, 0, v239
 Mvav 68,212,120
 T 252,213,32768
 T 254,213,40960
 Mvav 44,216,56
 v_mov_b32 v232, 0
 v_mov_b32 v233, 0
 Mvav 108,216,120
 v_mov_b32 v236, 0
 v_mov_b32 v237, 0
 Mvav 172,216,184
 s_waitcnt lgkmcnt(4)
 v_cndmask_b32 v234, 0, v238, vcc
 v_sub_u32 v235, v238, v234
 Mvav 12,220,56
 v_and_b32 v238, 15, v207
 v_mul_u32_u24 v240, 1792, v238
 Mvav 76,220,120
 v_bfe_u32 v238, v207, 4, 1
 v_lshl_add_u32 v240, v238, 5, v240
 Mvav 36,224,32
 v_lshrrev_b32 v238, 5, v207
 v_lshl_add_u32 v240, v238, 4, v240
 Mvav 100,224,96
 v_mul_f32 v180, v180, v197
 v_mul_f32 v181, v181, v197
 Mvav 164,224,160
 v_mul_f32 v182, v182, v197
 v_mul_f32 v183, v183, v197
 Mvav 4,228,32
 v_mul_f32 v188, v188, v197
 v_mul_f32 v189, v189, v197
 Mvav 68,228,96
 s_waitcnt lgkmcnt(0)
 s_barrier
 T 192,218,33024
 Mvav 44,232,32
 T 194,218,41216
 v_mul_f32 v190, v190, v197
 Mvav 108,232,96
 T 196,216,33024
 T 198,216,41216
 Mvav 172,232,160
 v_mul_f32 v191, v191, v197
 CV 180,180,181
 Mvav 12,236,32
 T 200,219,33024
 T 202,219,41216
 Mvav 76,236,96
 CV 181,182,183
 CV 182,188,189
 Mvav 36,240,40
 T 204,217,33024
 T 206,217,41216
 Mvav 100,240,104
 CV 183,190,191
 Mvav 164,240,168
 T 208,222,33024
 T 210,222,41216
 Mvav 4,244,40
 s_cmp_eq_u32 s78, 14
 s_cselect_b32 s79, 0x10000000, s40
 s_cbranch_scc1 LE1_k24
LE1_k24b:
 buffer_store_dwordx4 v[180:183], v204, s[24:27], s79 offen sc1
 Mvav 68,244,104
 T 212,220,33024
 T 214,220,41216
 Mvav 44,248,40
 Mvav 108,248,104
 T 216,223,33024
 T 218,223,41216
 Mvav 172,248,168
 s_waitcnt lgkmcnt(6)
 Mvav 12,252,40
 T 220,221,33024
 T 222,221,41216
 Mvav 76,252,104
 Mvavz 52,192,16
 T 224,218,32768
 T 226,218,40960
 Mvavz 116,192,80
 Mvavz 180,192,144
 T 228,216,32768
 T 230,216,40960
 Mvavz 20,196,16
 s_add_u32 s40, s68, 61440
 v_mul_f32 v4, v4, v195
 v_mul_f32 v5, v5, v195
 Mvavz 84,196,80
 s_waitcnt lgkmcnt(6)
 T 232,219,32768
 T 234,219,40960
 Mvavz 60,200,16
 v_mul_f32 v6, v6, v195
 v_mul_f32 v7, v7, v195
 Mvavz 124,200,80
 T 236,217,32768
 T 238,217,40960
 Mvavz 188,200,144
 v_mul_f32 v12, v12, v195
 v_mul_f32 v13, v13, v195
 Mvavz 28,204,16
 T 240,222,32768
 T 242,222,40960
 Mvavz 92,204,80
 s_waitcnt lgkmcnt(6)
 v_mul_f32 v14, v14, v195
 v_mul_f32 v15, v15, v195
 Mvav 52,208,24
 T 244,220,32768
 T 246,220,40960
 Mvav 116,208,88
 CV 4,4,5
 CV 5,6,7
 Mvav 180,208,152
 T 248,223,32768
 T 250,223,40960
 Mvav 20,212,24
 CV 6,12,13
 CV 7,14,15
 Mvav 84,212,88
 T 252,221,32768
 T 254,221,40960
 Mvav 60,216,24
 s_cmp_eq_u32 s78, 15
 s_cselect_b32 s79, 0x10000000, s40
 s_cbranch_scc1 LE1_k30
LE1_k30b:
 buffer_store_dwordx4 v[4:7], v204, s[24:27], s79 offen sc1
 Mvav 124,216,88
 v_mul_f32 v36, v36, v195
 v_mul_f32 v37, v37, v195
 Mvav 188,216,152
 s_waitcnt lgkmcnt(4)
 v_mul_f32 v38, v38, v195
 v_mul_f32 v39, v39, v195
 Mvav 28,220,24
 v_mul_f32 v44, v44, v195
 v_mul_f32 v45, v45, v195
 Mvav 92,220,88
 v_mul_f32 v46, v46, v195
 v_mul_f32 v47, v47, v195
 Mvav 52,224,0
 CV 36,36,37
 CV 37,38,39
 Mvav 116,224,64
 CV 38,44,45
 CV 39,46,47
 Mvav 180,224,128
 v_mul_f32 v68, v68, v196
 v_mul_f32 v69, v69, v196
 Mvav 20,228,0
 s_cmp_eq_u32 s78, 0
 s_cselect_b32 s79, 0x10000000, s40
 s_cbranch_scc1 LE1_k31
LE1_k31b:
 buffer_store_dwordx4 v[36:39], v204, s[24:27], s79 offen offset:1024 sc1
 Mvav 84,228,64
 s_waitcnt vmcnt(33) lgkmcnt(0)
 s_barrier
 T 192,210,256
 Mvav 60,232,0
 T 194,210,8448
 v_mul_f32 v70, v70, v196
 Mvav 124,232,64
 T 196,208,256
 T 198,208,8448
 Mvav 188,232,128
 v_mul_f32 v71, v71, v196
 v_mul_f32 v76, v76, v196
 Mvav 28,236,0
 T 200,211,256
 T 202,211,8448
 Mvav 92,236,64
 v_mul_f32 v77, v77, v196
 v_mul_f32 v78, v78, v196
 Mvav 52,240,8
 T 204,209,256
 T 206,209,8448
 Mvav 116,240,72
 v_mul_f32 v79, v79, v196
 CV 68,68,69
 Mvav 180,240,136
 T 208,214,256
 T 210,214,8448
 Mvav 20,244,8
 CV 69,70,71
 CV 70,76,77
 Mvav 84,244,72
 T 212,212,256
 T 214,212,8448
 Mvav 60,248,8
 CV 71,78,79
 v_mul_f32 v100, v100, v196
 Mvav 124,248,72
 s_cmp_eq_u32 s78, 1
 s_cselect_b32 s79, 0x10000000, s40
 s_cbranch_scc1 LE1_k32
LE1_k32b:
 T 216,215,256
 T 218,215,8448
 Mvav 188,248,136
 s_waitcnt lgkmcnt(6)
 buffer_store_dwordx4 v[68:71], v204, s[24:27], s79 offen offset:2048 sc1
 Mvav 28,252,8
 T 220,213,256
 T 222,213,8448
 Mvav 92,252,72
 v_mul_f32 v101, v101, v196
 v_mul_f32 v102, v102, v196
 Mvav 52,192,48
 T 224,210,0
 T 226,210,8192
 Mvav 116,192,112
 v_mul_f32 v103, v103, v196
 v_mul_f32 v108, v108, v196
 Mvav 180,192,176
 T 228,208,0
 T 230,208,8192
 Mvav 20,196,48
 v_mul_f32 v109, v109, v196
 v_mul_f32 v110, v110, v196
 Mvav 84,196,112
 s_waitcnt lgkmcnt(6)
 T 232,211,0
 T 234,211,8192
 Mvav 60,200,48
 v_mul_f32 v111, v111, v196
 CV 100,100,101
 Mvav 124,200,112
 T 236,209,0
 T 238,209,8192
 Mvav 188,200,176
 CV 101,102,103
 CV 102,108,109
 Mvav 28,204,48
 T 240,214,0
 T 242,214,8192
 Mvav 92,204,112
 s_waitcnt lgkmcnt(6)
 CV 103,110,111
 v_mul_f32 v164, v164, v197
 Mvav 52,208,56
 s_cmp_eq_u32 s78, 2
 s_cselect_b32 s79, 0x10000000, s40
 s_cbranch_scc1 LE1_k33
LE1_k33b:
 T 244,212,0
 T 246,212,8192
 Mvav 116,208,120
 buffer_store_dwordx4 v[100:103], v204, s[24:27], s79 offen offset:3072 sc1
 Mvav 180,208,184
 T 248,215,0
 T 250,215,8192
 Mvav 20,212,56
 s_add_u32 s40, s68, 65536
 v_mul_f32 v165, v165, v197
 v_mul_f32 v166, v166, v197
 Mvav 84,212,120
 T 252,213,0
 T 254,213,8192
 Mvav 60,216,56
 v_mul_f32 v167, v167, v197
 v_mul_f32 v172, v172, v197
 Mvav 124,216,120
 v_mul_f32 v173, v173, v197
 v_mul_f32 v174, v174, v197
 Mvav 188,216,184
 s_waitcnt lgkmcnt(4)
 v_mul_f32 v175, v175, v197
 CV 164,164,165
 Mvav 28,220,56
 CV 165,166,167
 CV 166,172,173
 Mvav 92,220,120
 CV 167,174,175
 Mvav 52,224,32
 s_cmp_eq_u32 s78, 3
 s_cselect_b32 s79, 0x10000000, s40
 s_cbranch_scc1 LE1_k34
LE1_k34b:
 buffer_store_dwordx4 v[164:167], v204, s[24:27], s79 offen sc1
 Mvav 116,224,96
 Mvav 180,224,160
 Mvav 20,228,32
 Mvav 84,228,96
 s_waitcnt lgkmcnt(0)
 s_barrier
 T 192,210,49408
 Mvav 60,232,32
 T 194,210,57600
 Mvav 124,232,96
 T 196,208,49408
 T 198,208,57600
 Mvav 188,232,160
 Mvav 28,236,32
 T 200,211,49408
 T 202,211,57600
 Mvav 92,236,96
 Mvav 52,240,40
 T 204,209,49408
 T 206,209,57600
 Mvav 116,240,104
 Mvav 180,240,168
 T 208,214,49408
 T 210,214,57600
 Mvav 20,244,40
 Mvav 84,244,104
 T 212,212,49408
 T 214,212,57600
 Mvav 60,248,40
 Mvav 124,248,104
 T 216,215,49408
 T 218,215,57600
 Mvav 188,248,168
 s_waitcnt lgkmcnt(6)
 Mvav 28,252,40
 T 220,213,49408
 T 222,213,57600
 Mvav 92,252,104
 Mvavz 36,192,16
 T 224,210,49152
 T 226,210,57344
 Mvavz 100,192,80
 Mvavz 164,192,144
 T 228,208,49152
 T 230,208,57344
 Mvavz 4,196,16
 s_add_u32 s40, s68, 81920
 v_mul_f32 v20, v20, v195
 v_mul_f32 v21, v21, v195
 Mvavz 68,196,80
 s_waitcnt lgkmcnt(6)
 T 232,211,49152
 T 234,211,57344
 Mvavz 44,200,16
 v_mul_f32 v22, v22, v195
 v_mul_f32 v23, v23, v195
 Mvavz 108,200,80
 T 236,209,49152
 T 238,209,57344
 Mvavz 172,200,144
 v_mul_f32 v28, v28, v195
 v_mul_f32 v29, v29, v195
 Mvavz 12,204,16
 T 240,214,49152
 T 242,214,57344
 Mvavz 76,204,80
 s_waitcnt lgkmcnt(6)
 v_mul_f32 v30, v30, v195
 v_mul_f32 v31, v31, v195
 Mvav 36,208,24
 T 244,212,49152
 T 246,212,57344
 Mvav 100,208,88
 CV 20,20,21
 CV 21,22,23
 Mvav 164,208,152
 T 248,215,49152
 T 250,215,57344
 Mvav 4,212,24
 CV 22,28,29
 CV 23,30,31
 Mvav 68,212,88
 T 252,213,49152
 T 254,213,57344
 Mvav 44,216,24
 s_cmp_eq_u32 s78, 0
 s_cselect_b32 s79, 0x10000000, s40
 s_cbranch_scc1 LE1_k40
LE1_k40b:
 v_mul_f32 v52, v52, v195
 v_mul_f32 v53, v53, v195
 Mvav 108,216,88
 v_mul_f32 v54, v54, v195
 v_mul_f32 v55, v55, v195
 Mvav 172,216,152
 s_waitcnt lgkmcnt(4)
 v_mul_f32 v60, v60, v195
 v_mul_f32 v61, v61, v195
 Mvav 12,220,24
 v_mul_f32 v62, v62, v195
 v_mul_f32 v63, v63, v195
 Mvav 76,220,88
 CV 52,52,53
 CV 53,54,55
 Mvav 36,224,0
 CV 54,60,61
 CV 55,62,63
 Mvav 100,224,64
 v_mul_f32 v84, v84, v196
 v_mul_f32 v85, v85, v196
 Mvav 164,224,128
 v_mul_f32 v86, v86, v196
 v_mul_f32 v87, v87, v196
 Mvav 4,228,0
 v_mul_f32 v92, v92, v196
 v_mul_f32 v93, v93, v196
 Mvav 68,228,64
 s_waitcnt vmcnt(0) lgkmcnt(0)
 s_barrier
 T 192,226,16640
 Mvav 44,232,0
 buffer_store_dwordx4 v[20:23], v204, s[24:27], s79 offen sc1
 Mvav 108,232,64
 s_cmp_eq_u32 s78, 1
 s_cselect_b32 s79, 0x10000000, s40
 s_cbranch_scc1 LE1_k41
LE1_k41b:
 T 194,226,24832
 T 196,224,16640
 Mvav 172,232,128
 T 198,224,24832
 v_mul_f32 v94, v94, v196
 Mvav 12,236,0
 T 200,227,16640
 T 202,227,24832
 Mvav 76,236,64
 buffer_store_dwordx4 v[52:55], v204, s[24:27], s79 offen offset:1024 sc1
 Mvav 36,240,8
 T 204,225,16640
 T 206,225,24832
 Mvav 100,240,72
 v_mul_f32 v95, v95, v196
 CV 84,84,85
 Mvav 164,240,136
 T 208,230,16640
 T 210,230,24832
 Mvav 4,244,8
 CV 85,86,87
 CV 86,92,93
 Mvav 68,244,72
 T 212,228,16640
 T 214,228,24832
 Mvav 44,248,8
 CV 87,94,95
 v_mul_f32 v116, v116, v196
 Mvav 108,248,72
 s_cmp_eq_u32 s78, 2
 s_cselect_b32 s79, 0x10000000, s40
 s_cbranch_scc1 LE1_k42
LE1_k42b:
 T 216,231,16640
 T 218,231,24832
 Mvav 172,248,136
 s_waitcnt lgkmcnt(6)
 buffer_store_dwordx4 v[84:87], v204, s[24:27], s79 offen offset:2048 sc1
 Mvav 12,252,8
 T 220,229,16640
 T 222,229,24832
 Mvav 76,252,72
 v_mul_f32 v117, v117, v196
 v_mul_f32 v118, v118, v196
 Mvav 36,192,48
 T 224,226,16384
 T 226,226,24576
 Mvav 100,192,112
 v_mul_f32 v119, v119, v196
 v_mul_f32 v124, v124, v196
 Mvav 164,192,176
 T 228,224,16384
 T 230,224,24576
 Mvav 4,196,48
 v_mul_f32 v125, v125, v196
 v_mul_f32 v126, v126, v196
 Mvav 68,196,112
 s_waitcnt lgkmcnt(6)
 T 232,227,16384
 T 234,227,24576
 Mvav 44,200,48
 v_mul_f32 v127, v127, v196
 CV 116,116,117
 Mvav 108,200,112
 T 236,225,16384
 T 238,225,24576
 Mvav 172,200,176
 CV 117,118,119
 CV 118,124,125
 Mvav 12,204,48
 T 240,230,16384
 T 242,230,24576
 Mvav 76,204,112
 s_waitcnt lgkmcnt(6)
 CV 119,126,127
 v_mul_f32 v180, v180, v197
 Mvav 36,208,56
 s_cmp_eq_u32 s78, 3
 s_cselect_b32 s79, 0x10000000, s40
 s_cbranch_scc1 LE1_k43
LE1_k43b:
 T 244,228,16384
 T 246,228,24576
 Mvav 100,208,120
 buffer_store_dwordx4 v[116:119], v204, s[24:27], s79 offen offset:3072 sc1
 Mvav 164,208,184
 T 248,231,16384
 T 250,231,24576
 Mvav 4,212,56
 s_add_u32 s40, s68, 86016
 v_mul_f32 v181, v181, v197
 v_mul_f32 v182, v182, v197
 Mvav 68,212,120
 T 252,229,16384
 T 254,229,24576
 Mvav 44,216,56
 v_mul_f32 v183, v183, v197
 v_mul_f32 v188, v188, v197
 Mvav 108,216,120
 v_mul_f32 v189, v189, v197
 v_mul_f32 v190, v190, v197
 Mvav 172,216,184
 s_waitcnt lgkmcnt(4)
 v_mul_f32 v191, v191, v197
 CV 180,180,181
 Mvav 12,220,56
 CV 181,182,183
 CV 182,188,189
 Mvav 76,220,120
 CV 183,190,191
 Mvav 36,224,32
 s_cmp_eq_u32 s78, 4
 s_cselect_b32 s79, 0x10000000, s40
 s_cbranch_scc1 LE1_k44
LE1_k44b:
 buffer_store_dwordx4 v[180:183], v204, s[24:27], s79 offen sc1
 Mvav 100,224,96
 Mvav 164,224,160
 Mvav 4,228,32
 Mvav 68,228,96
 s_waitcnt lgkmcnt(0)
 s_barrier
 T 192,218,256
 Mvav 44,232,32
 T 194,218,8448
 Mvav 108,232,96
 T 196,216,256
 T 198,216,8448
 Mvav 172,232,160
 Mvav 12,236,32
 T 200,219,256
 T 202,219,8448
 Mvav 76,236,96
 Mvav 36,240,40
 T 204,217,256
 T 206,217,8448
 Mvav 100,240,104
 Mvav 164,240,168
 T 208,222,256
 T 210,222,8448
 Mvav 4,244,40
 Mvav 68,244,104
 T 212,220,256
 T 214,220,8448
 Mvav 44,248,40
 Mvav 108,248,104
 T 216,223,256
 T 218,223,8448
 Mvav 172,248,168
 s_waitcnt lgkmcnt(6)
 Mvav 12,252,40
 T 220,221,256
 T 222,221,8448
 Mvav 76,252,104
 Mvavz 52,192,16
 T 224,218,0
 T 226,218,8192
 Mvavz 116,192,80
 Mvavz 180,192,144
 T 228,216,0
 T 230,216,8192
 Mvavz 20,196,16
 s_add_u32 s40, s68, 102400
 v_mul_f32 v4, v4, v195
 v_mul_f32 v5, v5, v195
 Mvavz 84,196,80
 s_waitcnt lgkmcnt(6)
 T 232,219,0
 T 234,219,8192
 Mvavz 60,200,16
 v_mul_f32 v6, v6, v195
 v_mul_f32 v7, v7, v195
 Mvavz 124,200,80
 T 236,217,0
 T 238,217,8192
 Mvavz 188,200,144
 v_mul_f32 v12, v12, v195
 v_mul_f32 v13, v13, v195
 Mvavz 28,204,16
 T 240,222,0
 T 242,222,8192
 Mvavz 92,204,80
 s_waitcnt lgkmcnt(6)
 v_mul_f32 v14, v14, v195
 v_mul_f32 v15, v15, v195
 Mvav 52,208,24
 T 244,220,0
 T 246,220,8192
 Mvav 116,208,88
 CV 4,4,5
 CV 5,6,7
 Mvav 180,208,152
 T 248,223,0
 T 250,223,8192
 Mvav 20,212,24
 CV 6,12,13
 CV 7,14,15
 Mvav 84,212,88
 T 252,221,0
 T 254,221,8192
 Mvav 60,216,24
 s_cmp_eq_u32 s78, 5
 s_cselect_b32 s79, 0x10000000, s40
 s_cbranch_scc1 LE1_k50
LE1_k50b:
 buffer_store_dwordx4 v[4:7], v204, s[24:27], s79 offen sc1
 Mvav 124,216,88
 v_mul_f32 v36, v36, v195
 v_mul_f32 v37, v37, v195
 Mvav 188,216,152
 s_waitcnt lgkmcnt(4)
 v_mul_f32 v38, v38, v195
 v_mul_f32 v39, v39, v195
 Mvav 28,220,24
 v_mul_f32 v44, v44, v195
 v_mul_f32 v45, v45, v195
 Mvav 92,220,88
 v_mul_f32 v46, v46, v195
 v_mul_f32 v47, v47, v195
 Mvav 52,224,0
 CV 36,36,37
 CV 37,38,39
 Mvav 116,224,64
 CV 38,44,45
 CV 39,46,47
 Mvav 180,224,128
 v_mul_f32 v68, v68, v196
 v_mul_f32 v69, v69, v196
 Mvav 20,228,0
 s_cmp_eq_u32 s78, 6
 s_cselect_b32 s79, 0x10000000, s40
 s_cbranch_scc1 LE1_k51
LE1_k51b:
 buffer_store_dwordx4 v[36:39], v204, s[24:27], s79 offen offset:1024 sc1
 Mvav 84,228,64
 s_waitcnt lgkmcnt(0)
 s_barrier
 T 192,218,49408
 Mvav 60,232,0
 T 194,218,57600
 v_mul_f32 v70, v70, v196
 Mvav 124,232,64
 T 196,219,49408
 T 198,219,57600
 Mvav 188,232,128
 v_mul_f32 v71, v71, v196
 v_mul_f32 v76, v76, v196
 Mvav 28,236,0
 T 200,222,49408
 T 202,222,57600
 Mvav 92,236,64
 v_mul_f32 v77, v77, v196
 v_mul_f32 v78, v78, v196
 Mvav 52,240,8
 T 204,223,49408
 T 206,223,57600
 Mvav 116,240,72
 v_mul_f32 v79, v79, v196
 CV 68,68,69
 Mvav 180,240,136
 T 208,218,49152
 T 210,218,57344
 Mvav 20,244,8
 CV 69,70,71
 CV 70,76,77
 Mvav 84,244,72
 T 212,219,49152
 T 214,219,57344
 Mvav 60,248,8
 CV 71,78,79
 v_mul_f32 v100, v100, v196
 Mvav 124,248,72
 s_cmp_eq_u32 s78, 7
 s_cselect_b32 s79, 0x10000000, s40
 s_cbranch_scc1 LE1_k52
LE1_k52b:
 T 216,222,49152
 T 218,222,57344
 Mvav 188,248,136
 s_waitcnt lgkmcnt(6)
 buffer_store_dwordx4 v[68:71], v204, s[24:27], s79 offen offset:2048 sc1
 Mvav 28,252,8
 T 220,223,49152
 T 222,223,57344
 Mvav 92,252,72
 v_mul_f32 v101, v101, v196
 v_mul_f32 v102, v102, v196
 Mvav 52,192,48
 T 224,216,49408
 T 226,216,57600
 Mvav 116,192,112
 v_mul_f32 v103, v103, v196
 v_mul_f32 v108, v108, v196
 Mvav 180,192,176
 T 228,217,49408
 T 230,217,57600
 Mvav 60,196,48
 v_mul_f32 v109, v109, v196
 v_mul_f32 v110, v110, v196
 Mvav 124,196,112
 T 232,220,49408
 T 234,220,57600
 Mvav 188,196,176
 s_waitcnt lgkmcnt(6)
 v_mul_f32 v111, v111, v196
 CV 100,100,101
 Mvav 52,200,56
 buffer_load_dword v198, v205, s[84:87], 0 offen sc1
 Mvav 116,200,120
 T 236,221,49408
 T 238,221,57600
 Mvav 180,200,184
 T 240,216,49152
 T 242,216,57344
 Mvav 60,204,56
 CV 101,102,103
 CV 102,108,109
 Mvav 124,204,120
 T 244,217,49152
 T 246,217,57344
 Mvav 188,204,184
 s_waitcnt lgkmcnt(6)
 CV 103,110,111
 v_mul_f32 v164, v164, v197
 Mvav 52,208,32
 s_cmp_eq_u32 s78, 8
 s_cselect_b32 s79, 0x10000000, s40
 s_cbranch_scc1 LE1_k53
LE1_k53b:
 buffer_store_dwordx4 v[100:103], v204, s[24:27], s79 offen offset:3072 sc1
 Mvav 116,208,96
 s_add_u32 s40, s68, 106496
 T 248,220,49152
 T 250,220,57344
 Mvav 180,208,160
 T 252,221,49152
 T 254,221,57344
 Mvav 60,212,32
 v_mul_f32 v165, v165, v197
 v_mul_f32 v166, v166, v197
 Mvav 124,212,96
 v_mul_f32 v167, v167, v197
 v_mul_f32 v172, v172, v197
 Mvav 188,212,160
 v_mul_f32 v173, v173, v197
 v_mul_f32 v174, v174, v197
 Mvav 52,216,40
 v_mul_f32 v175, v175, v197
 CV 164,164,165
 Mvav 116,216,104
 CV 165,166,167
 CV 166,172,173
 Mvav 180,216,168
 CV 167,174,175
 Mvav 60,220,40
 s_cmp_eq_u32 s78, 9
 s_cselect_b32 s79, 0x10000000, s40
 s_cbranch_scc1 LE1_k54
LE1_k54b:
 buffer_store_dwordx4 v[164:167], v204, s[24:27], s79 offen sc1
 Mvav 124,220,104
 Mvav 188,220,168
 Mvav 20,224,48
 Mvav 84,224,112
 Mvav 28,228,48
 Mvav 92,228,112
 v_mul_f32 v180, v180, v197
 v_mul_f32 v181, v181, v197
 Mvav 20,232,56
 s_add_u32 s40, s68, 126976
 v_mul_f32 v182, v182, v197
 v_mul_f32 v183, v183, v197
 Mvav 84,232,120
 s_waitcnt lgkmcnt(0)
 v_mul_f32 v188, v188, v197
 v_mul_f32 v189, v189, v197
 Mvav 28,236,56
 v_mul_f32 v190, v190, v197
 v_mul_f32 v191, v191, v197
 Mvav 92,236,120
 CV 180,180,181
 CV 181,182,183
 Mvav 20,240,32
 CV 182,188,189
 CV 183,190,191
 Mvav 84,240,96
 v_mul_f32 v52, v52, v195
 v_mul_f32 v53, v53, v195
 Mvav 28,244,32
 s_cmp_eq_u32 s78, 14
 s_cselect_b32 s79, 0x10000000, s40
 s_cbranch_scc1 LE1_k64
LE1_k64b:
 buffer_store_dwordx4 v[180:183], v204, s[24:27], s79 offen sc1
 Mvav 92,244,96
 v_mul_f32 v54, v54, v195
 v_mul_f32 v55, v55, v195
 Mvav 20,248,40
 s_add_u32 s40, s68, 122880
 v_mul_f32 v60, v60, v195
 v_mul_f32 v61, v61, v195
 Mvav 84,248,104
 v_mul_f32 v62, v62, v195
 v_mul_f32 v63, v63, v195
 Mvav 28,252,40
 CV 52,52,53
 CV 53,54,55
 Mvav 92,252,104
 CV 54,60,61
 CV 55,62,63
 s_cmp_eq_u32 s78, 11
 s_cselect_b32 s79, 0x10000000, s40
 s_cbranch_scc1 LE1_k61
LE1_k61b:
 buffer_store_dwordx4 v[52:55], v204, s[24:27], s79 offen offset:1024 sc1
 v_mul_f32 v116, v116, v196
 v_mul_f32 v117, v117, v196
 v_mul_f32 v118, v118, v196
 v_mul_f32 v119, v119, v196
 v_mul_f32 v124, v124, v196
 v_mul_f32 v125, v125, v196
 v_mul_f32 v126, v126, v196
 v_mul_f32 v127, v127, v196
 CV 116,116,117
 CV 117,118,119
 CV 118,124,125
 CV 119,126,127
 v_mul_f32 v20, v20, v195
 v_mul_f32 v21, v21, v195
 s_cmp_eq_u32 s78, 13
 s_cselect_b32 s79, 0x10000000, s40
 s_cbranch_scc1 LE1_k63
LE1_k63b:
 buffer_store_dwordx4 v[116:119], v204, s[24:27], s79 offen offset:3072 sc1
 v_mul_f32 v22, v22, v195
 v_mul_f32 v23, v23, v195
 v_mul_f32 v28, v28, v195
 v_mul_f32 v29, v29, v195
 v_mul_f32 v30, v30, v195
 v_mul_f32 v31, v31, v195
 CV 20,20,21
 CV 21,22,23
 CV 22,28,29
 CV 23,30,31
 s_cmp_eq_u32 s78, 10
 s_cselect_b32 s79, 0x10000000, s40
 s_cbranch_scc1 LE1_k60
LE1_k60b:
 buffer_store_dwordx4 v[20:23], v204, s[24:27], s79 offen sc1
 v_mul_f32 v84, v84, v196
 v_mul_f32 v85, v85, v196
 v_mul_f32 v86, v86, v196
 v_mul_f32 v87, v87, v196
 v_mul_f32 v92, v92, v196
 v_mul_f32 v93, v93, v196
 v_mul_f32 v94, v94, v196
 v_mul_f32 v95, v95, v196
 CV 84,84,85
 CV 85,86,87
 CV 86,92,93
 CV 87,94,95
 s_cmp_eq_u32 s78, 12
 s_cselect_b32 s79, 0x10000000, s40
 s_cbranch_scc1 LE1_k62
LE1_k62b:
 buffer_store_dwordx4 v[84:87], v204, s[24:27], s79 offen offset:2048 sc1
 s_waitcnt vmcnt(7)
 s_branch L_tail
L_tail:
 v_cmp_le_u32 vcc, 1, v198
 s_nop 0
 s_and_b32 s42, vcc_lo, s43
 s_cmp_eq_u32 s42, 0xffff
 s_cbranch_scc0 L_tail_n
 s_mov_b32 s35, s70
 s_cmp_eq_u32 s3, 0
 s_cselect_b32 s96, s80, 0
 s_add_u32 s35, s35, s96
 buffer_load_dwordx4 a[0:3], v204, s[12:15], s35 offen sc1
 s_cmp_eq_u32 s3, 1
 s_cselect_b32 s96, s81, s80
 s_add_u32 s35, s35, s96
 buffer_load_dwordx4 a[4:7], v204, s[12:15], s35 offen sc1
 s_cmp_eq_u32 s3, 2
 s_cselect_b32 s96, s81, s80
 s_add_u32 s35, s35, s96
 buffer_load_dwordx4 a[8:11], v204, s[12:15], s35 offen sc1
 s_cmp_eq_u32 s3, 3
 s_cselect_b32 s96, s81, s80
 s_add_u32 s35, s35, s96
 v_mov_b32 v242, 2
 s_lshl_b32 s66, s60, 12
 s_add_u32 s66, s66, s47
 s_waitcnt vmcnt(0)
 s_barrier
 buffer_store_dword v242, v241, s[84:87], s66 offen sc1
 s_branch L_tail_m
L_tail_n:
 v_mov_b32 v242, 2
 s_lshl_b32 s66, s60, 12
 s_add_u32 s66, s66, s47
 s_waitcnt vmcnt(0)
 s_barrier
 buffer_store_dword v242, v241, s[84:87], s66 offen sc1
 s_mov_b32 s42, 1
 s_call_b64 s[82:83], L_wait
 s_mov_b32 s35, s70
 s_cmp_eq_u32 s3, 0
 s_cselect_b32 s96, s80, 0
 s_add_u32 s35, s35, s96
 buffer_load_dwordx4 a[0:3], v204, s[12:15], s35 offen sc1
 s_cmp_eq_u32 s3, 1
 s_cselect_b32 s96, s81, s80
 s_add_u32 s35, s35, s96
 buffer_load_dwordx4 a[4:7], v204, s[12:15], s35 offen sc1
 s_cmp_eq_u32 s3, 2
 s_cselect_b32 s96, s81, s80
 s_add_u32 s35, s35, s96
 buffer_load_dwordx4 a[8:11], v204, s[12:15], s35 offen sc1
 s_cmp_eq_u32 s3, 3
 s_cselect_b32 s96, s81, s80
 s_add_u32 s35, s35, s96
L_tail_m:
 buffer_load_dwordx4 a[12:15], v204, s[12:15], s35 offen sc1
 s_cmp_eq_u32 s3, 4
 s_cselect_b32 s96, s81, s80
 s_add_u32 s35, s35, s96
 buffer_load_dwordx4 a[16:19], v204, s[12:15], s35 offen sc1
 s_cmp_eq_u32 s3, 5
 s_cselect_b32 s96, s81, s80
 s_add_u32 s35, s35, s96
 buffer_load_dwordx4 a[20:23], v204, s[12:15], s35 offen sc1
 s_cmp_eq_u32 s3, 6
 s_cselect_b32 s96, s81, s80
 s_add_u32 s35, s35, s96
 buffer_load_dwordx4 a[24:27], v204, s[12:15], s35 offen sc1
 s_cmp_eq_u32 s3, 7
 s_cselect_b32 s96, s81, s80
 s_add_u32 s35, s35, s96
 buffer_load_dwordx4 a[28:31], v204, s[12:15], s35 offen sc1
 s_cmp_eq_u32 s3, 8
 s_cselect_b32 s96, s81, s80
 s_add_u32 s35, s35, s96
 buffer_load_dwordx4 a[32:35], v204, s[12:15], s35 offen sc1
 s_cmp_eq_u32 s3, 9
 s_cselect_b32 s96, s81, s80
 s_add_u32 s35, s35, s96
 buffer_load_dwordx4 a[36:39], v204, s[12:15], s35 offen sc1
 s_cmp_eq_u32 s3, 10
 s_cselect_b32 s96, s81, s80
 s_add_u32 s35, s35, s96
 buffer_load_dwordx4 a[40:43], v204, s[12:15], s35 offen sc1
 s_cmp_eq_u32 s3, 11
 s_cselect_b32 s96, s81, s80
 s_add_u32 s35, s35, s96
 buffer_load_dwordx4 a[44:47], v204, s[12:15], s35 offen sc1
 s_cmp_eq_u32 s3, 12
 s_cselect_b32 s96, s81, s80
 s_add_u32 s35, s35, s96
 buffer_load_dwordx4 a[48:51], v204, s[12:15], s35 offen sc1
 s_cmp_eq_u32 s3, 13
 s_cselect_b32 s96, s81, s80
 s_add_u32 s35, s35, s96
 buffer_load_dwordx4 a[52:55], v204, s[12:15], s35 offen sc1
 s_cmp_eq_u32 s3, 14
 s_cselect_b32 s96, s81, s80
 s_add_u32 s35, s35, s96
 buffer_load_dwordx4 a[56:59], v204, s[12:15], s35 offen sc1
 s_mov_b32 s35, s71
 s_cmp_eq_u32 s3, 0
 s_cselect_b32 s96, s80, 0
 s_add_u32 s35, s35, s96
 buffer_load_dwordx4 a[64:67], v204, s[12:15], s35 offen sc1
 s_cmp_eq_u32 s3, 1
 s_cselect_b32 s96, s81, s80
 s_add_u32 s35, s35, s96
 buffer_load_dwordx4 a[68:71], v204, s[12:15], s35 offen sc1
 s_cmp_eq_u32 s3, 2
 s_cselect_b32 s96, s81, s80
 s_add_u32 s35, s35, s96
 buffer_load_dwordx4 a[72:75], v204, s[12:15], s35 offen sc1
 s_cmp_eq_u32 s3, 3
 s_cselect_b32 s96, s81, s80
 s_add_u32 s35, s35, s96
 buffer_load_dwordx4 a[76:79], v204, s[12:15], s35 offen sc1
 s_cmp_eq_u32 s3, 4
 s_cselect_b32 s96, s81, s80
 s_add_u32 s35, s35, s96
 buffer_load_dwordx4 a[80:83], v204, s[12:15], s35 offen sc1
 s_cmp_eq_u32 s3, 5
 s_cselect_b32 s96, s81, s80
 s_add_u32 s35, s35, s96
 buffer_load_dwordx4 a[84:87], v204, s[12:15], s35 offen sc1
 s_cmp_eq_u32 s3, 6
 s_cselect_b32 s96, s81, s80
 s_add_u32 s35, s35, s96
 buffer_load_dwordx4 a[88:91], v204, s[12:15], s35 offen sc1
 s_cmp_eq_u32 s3, 7
 s_cselect_b32 s96, s81, s80
 s_add_u32 s35, s35, s96
 buffer_load_dwordx4 a[92:95], v204, s[12:15], s35 offen sc1
 s_cmp_eq_u32 s3, 8
 s_cselect_b32 s96, s81, s80
 s_add_u32 s35, s35, s96
 buffer_load_dwordx4 a[96:99], v204, s[12:15], s35 offen sc1
 s_cmp_eq_u32 s3, 9
 s_cselect_b32 s96, s81, s80
 s_add_u32 s35, s35, s96
 buffer_load_dwordx4 a[100:103], v204, s[12:15], s35 offen sc1
 s_cmp_eq_u32 s3, 10
 s_cselect_b32 s96, s81, s80
 s_add_u32 s35, s35, s96
 buffer_load_dwordx4 a[104:107], v204, s[12:15], s35 offen sc1
 s_cmp_eq_u32 s3, 11
 s_cselect_b32 s96, s81, s80
 s_add_u32 s35, s35, s96
 buffer_load_dwordx4 a[108:111], v204, s[12:15], s35 offen sc1
 s_cmp_eq_u32 s3, 12
 s_cselect_b32 s96, s81, s80
 s_add_u32 s35, s35, s96
 buffer_load_dwordx4 a[112:115], v204, s[12:15], s35 offen sc1
 s_cmp_eq_u32 s3, 13
 s_cselect_b32 s96, s81, s80
 s_add_u32 s35, s35, s96
 buffer_load_dwordx4 a[116:119], v204, s[12:15], s35 offen sc1
 s_cmp_eq_u32 s3, 14
 s_cselect_b32 s96, s81, s80
 s_add_u32 s35, s35, s96
 buffer_load_dwordx4 a[120:123], v204, s[12:15], s35 offen sc1
 s_mov_b32 s42, 2
 s_call_b64 s[82:83], L_wait
 s_mov_b32 s35, s72
 s_cmp_eq_u32 s3, 0
 s_cselect_b32 s96, s80, 0
 s_add_u32 s35, s35, s96
 buffer_load_dwordx4 a[128:131], v204, s[12:15], s35 offen sc1
 s_cmp_eq_u32 s3, 1
 s_cselect_b32 s96, s81, s80
 s_add_u32 s35, s35, s96
 buffer_load_dwordx4 a[132:135], v204, s[12:15], s35 offen sc1
 s_cmp_eq_u32 s3, 2
 s_cselect_b32 s96, s81, s80
 s_add_u32 s35, s35, s96
 buffer_load_dwordx4 a[136:139], v204, s[12:15], s35 offen sc1
 s_cmp_eq_u32 s3, 3
 s_cselect_b32 s96, s81, s80
 s_add_u32 s35, s35, s96
 buffer_load_dwordx4 a[140:143], v204, s[12:15], s35 offen sc1
 s_cmp_eq_u32 s3, 4
 s_cselect_b32 s96, s81, s80
 s_add_u32 s35, s35, s96
 buffer_load_dwordx4 a[144:147], v204, s[12:15], s35 offen sc1
 s_cmp_eq_u32 s3, 5
 s_cselect_b32 s96, s81, s80
 s_add_u32 s35, s35, s96
 buffer_load_dwordx4 a[148:151], v204, s[12:15], s35 offen sc1
 s_cmp_eq_u32 s3, 6
 s_cselect_b32 s96, s81, s80
 s_add_u32 s35, s35, s96
 buffer_load_dwordx4 a[152:155], v204, s[12:15], s35 offen sc1
 s_cmp_eq_u32 s3, 7
 s_cselect_b32 s96, s81, s80
 s_add_u32 s35, s35, s96
 buffer_load_dwordx4 a[156:159], v204, s[12:15], s35 offen sc1
 s_cmp_eq_u32 s3, 8
 s_cselect_b32 s96, s81, s80
 s_add_u32 s35, s35, s96
 buffer_load_dwordx4 a[160:163], v204, s[12:15], s35 offen sc1
 s_cmp_eq_u32 s3, 9
 s_cselect_b32 s96, s81, s80
 s_add_u32 s35, s35, s96
 buffer_load_dwordx4 a[164:167], v204, s[12:15], s35 offen sc1
 s_cmp_eq_u32 s3, 10
 s_cselect_b32 s96, s81, s80
 s_add_u32 s35, s35, s96
 buffer_load_dwordx4 a[168:171], v204, s[12:15], s35 offen sc1
 s_cmp_eq_u32 s3, 11
 s_cselect_b32 s96, s81, s80
 s_add_u32 s35, s35, s96
 buffer_load_dwordx4 a[172:175], v204, s[12:15], s35 offen sc1
 s_cmp_eq_u32 s3, 12
 s_cselect_b32 s96, s81, s80
 s_add_u32 s35, s35, s96
 buffer_load_dwordx4 a[176:179], v204, s[12:15], s35 offen sc1
 s_cmp_eq_u32 s3, 13
 s_cselect_b32 s96, s81, s80
 s_add_u32 s35, s35, s96
 buffer_load_dwordx4 a[180:183], v204, s[12:15], s35 offen sc1
 s_cmp_eq_u32 s3, 14
 s_cselect_b32 s96, s81, s80
 s_add_u32 s35, s35, s96
 buffer_load_dwordx4 a[184:187], v204, s[12:15], s35 offen sc1
 Mvvaz 8,234,0
 Mvvaz 12,232,0
 Mvva 8,234,4
 Mvva 12,232,4
 Mvva 8,234,8
 Mvva 12,232,8
 Mvva 8,234,12
 Mvva 12,232,12
 Mvva 8,234,16
 Mvva 12,232,16
 Mvva 8,234,20
 Mvva 12,232,20
 Mvva 8,234,24
 Mvva 12,232,24
 Mvva 8,234,28
 Mvva 12,232,28
 Mvva 8,234,32
 Mvva 12,232,32
 Mvva 8,234,36
 Mvva 12,232,36
 Mvva 8,234,40
 Mvva 12,232,40
 Mvva 8,234,44
 Mvva 12,232,44
 Mvva 8,234,48
 Mvva 12,232,48
 Mvva 8,234,52
 Mvva 12,232,52
 Mvva 8,234,56
 Mvva 12,232,56
 Mvva 8,234,60
 Mvva 12,232,60
 s_nop 6
 CV 8,8,9
 CV 9,10,11
 CV 10,12,13
 CV 11,14,15
 s_nop 0
 v_permlane16_swap_b32 v8, v10
 v_permlane16_swap_b32 v9, v11
 buffer_store_dwordx4 v[8:11], v240, s[16:19], s74 offen
 Mvvaz 16,234,64
 Mvvaz 20,232,64
 Mvva 16,234,68
 Mvva 20,232,68
 Mvva 16,234,72
 Mvva 20,232,72
 Mvva 16,234,76
 Mvva 20,232,76
 Mvva 16,234,80
 Mvva 20,232,80
 Mvva 16,234,84
 Mvva 20,232,84
 Mvva 16,234,88
 Mvva 20,232,88
 Mvva 16,234,92
 Mvva 20,232,92
 Mvva 16,234,96
 Mvva 20,232,96
 Mvva 16,234,100
 Mvva 20,232,100
 Mvva 16,234,104
 Mvva 20,232,104
 Mvva 16,234,108
 Mvva 20,232,108
 Mvva 16,234,112
 Mvva 20,232,112
 Mvva 16,234,116
 Mvva 20,232,116
 Mvva 16,234,120
 Mvva 20,232,120
 Mvva 16,234,124
 Mvva 20,232,124
 s_nop 6
 CV 16,16,17
 CV 17,18,19
 CV 18,20,21
 CV 19,22,23
 s_nop 0
 v_permlane16_swap_b32 v16, v18
 v_permlane16_swap_b32 v17, v19
 buffer_store_dwordx4 v[16:19], v240, s[16:19], s75 offen
 s_waitcnt vmcnt(16)
 Mvvaz 24,234,128
 Mvvaz 28,232,128
 s_waitcnt vmcnt(15)
 Mvva 24,234,132
 Mvva 28,232,132
 s_waitcnt vmcnt(14)
 Mvva 24,234,136
 Mvva 28,232,136
 s_waitcnt vmcnt(13)
 Mvva 24,234,140
 Mvva 28,232,140
 s_waitcnt vmcnt(12)
 Mvva 24,234,144
 Mvva 28,232,144
 s_waitcnt vmcnt(11)
 Mvva 24,234,148
 Mvva 28,232,148
 s_waitcnt vmcnt(10)
 Mvva 24,234,152
 Mvva 28,232,152
 s_waitcnt vmcnt(9)
 Mvva 24,234,156
 Mvva 28,232,156
 s_waitcnt vmcnt(8)
 Mvva 24,234,160
 Mvva 28,232,160
 s_waitcnt vmcnt(7)
 Mvva 24,234,164
 Mvva 28,232,164
 s_waitcnt vmcnt(6)
 Mvva 24,234,168
 Mvva 28,232,168
 s_waitcnt vmcnt(5)
 Mvva 24,234,172
 Mvva 28,232,172
 s_waitcnt vmcnt(4)
 Mvva 24,234,176
 Mvva 28,232,176
 s_waitcnt vmcnt(3)
 Mvva 24,234,180
 Mvva 28,232,180
 s_waitcnt vmcnt(2)
 Mvva 24,234,184
 Mvva 28,232,184
 Mvva 24,234,188
 Mvva 28,232,188
 s_nop 6
 CV 24,24,25
 CV 25,26,27
 CV 26,28,29
 CV 27,30,31
 s_nop 0
 v_permlane16_swap_b32 v24, v26
 v_permlane16_swap_b32 v25, v27
 buffer_store_dwordx4 v[24:27], v240, s[16:19], s76 offen
 s_endpgm
L_wait:
 s_mov_b32 s63, 0
L_wait_p:
 s_cmp_eq_u32 s43, 0xffff
 s_cbranch_scc1 L_wait_f
 buffer_load_ubyte v198, v207, s[88:91], 0 offen sc1
 s_waitcnt vmcnt(0)
 v_cmp_eq_u32 vcc, 1, v198
 s_add_u32 s63, s63, 1
 s_mov_b32 s43, vcc_lo
 s_cmp_lt_u32 s63, 1000000
 s_cbranch_scc1 L_wait_p
L_wait_f:
 buffer_load_dword v198, v205, s[84:87], 0 offen sc1
 s_waitcnt vmcnt(0)
 v_cmp_le_u32 vcc, s42, v198
 s_add_u32 s63, s63, 1
 s_cmp_gt_u32 s63, 1000000
 s_cbranch_scc1 L_wait_r
 s_and_b32 s97, vcc_lo, 0xffff
 s_cmp_eq_u32 s97, 0xffff
 s_cbranch_scc0 L_wait_f
L_wait_r:
 s_setpc_b64 s[82:83]
L_code_end:
LE0_maxpass:
 s_waitcnt vmcnt(0) lgkmcnt(0)
 s_nop 15
 s_mov_b32 s63, 0
 s_mov_b32 s64, m0
 s_mov_b32 s65, s32
LE0_maxloop:
 s_barrier
 s_add_u32 m0, s33, 81920
 s_add_u32 s32, s63, 0
 buffer_load_dwordx4 v244, s[12:15], s32 offen nt lds
 buffer_load_dwordx4 v245, s[12:15], s32 offen offset:1024 nt lds
 buffer_load_dwordx4 v246, s[12:15], s32 offen offset:2048 nt lds
 buffer_load_dwordx4 v247, s[12:15], s32 offen offset:3072 nt lds
 s_add_u32 m0, s33, 90112
 s_add_u32 s32, s63, 8192
 buffer_load_dwordx4 v244, s[12:15], s32 offen nt lds
 buffer_load_dwordx4 v245, s[12:15], s32 offen offset:1024 nt lds
 buffer_load_dwordx4 v246, s[12:15], s32 offen offset:2048 nt lds
 buffer_load_dwordx4 v247, s[12:15], s32 offen offset:3072 nt lds
 s_waitcnt vmcnt(0)
 s_barrier
 R 0,236,16384
 R 4,236,24576
 R 8,237,16384
 R 12,237,24576
 R 16,238,16384
 R 20,238,24576
 R 24,239,16384
 R 28,239,24576
 s_waitcnt lgkmcnt(7)
 Mvavz 36,0,0
 Mvavz 100,0,64
 Mvavz 164,0,128
 s_waitcnt lgkmcnt(6)
 Mvavz 44,4,0
 Mvavz 108,4,64
 Mvavz 172,4,128
 s_waitcnt lgkmcnt(5)
 Mvav 36,8,8
 Mvav 100,8,72
 Mvav 164,8,136
 s_waitcnt lgkmcnt(0)
 Mvav 44,12,8
 Mvav 108,12,72
 Mvav 172,12,136
 Mvav 36,16,16
 Mvav 100,16,80
 Mvav 164,16,144
 Mvav 44,20,16
 Mvav 108,20,80
 Mvav 172,20,144
 Mvav 36,24,24
 Mvav 100,24,88
 Mvav 164,24,152
 Mvav 44,28,24
 Mvav 108,28,88
 Mvav 172,28,152
 R 0,236,16640
 R 4,236,24832
 R 8,237,16640
 R 12,237,24832
 R 16,238,16640
 R 20,238,24832
 R 24,239,16640
 R 28,239,24832
 s_waitcnt lgkmcnt(7)
 Mvav 36,0,32
 Mvav 100,0,96
 Mvav 164,0,160
 s_waitcnt lgkmcnt(6)
 Mvav 44,4,32
 Mvav 108,4,96
 Mvav 172,4,160
 s_waitcnt lgkmcnt(5)
 Mvav 36,8,40
 Mvav 100,8,104
 Mvav 164,8,168
 s_waitcnt lgkmcnt(0)
 Mvav 44,12,40
 Mvav 108,12,104
 Mvav 172,12,168
 Mvav 36,16,48
 Mvav 100,16,112
 Mvav 164,16,176
 Mvav 44,20,48
 Mvav 108,20,112
 Mvav 172,20,176
 Mvav 36,24,56
 Mvav 100,24,120
 Mvav 164,24,184
 Mvav 44,28,56
 Mvav 108,28,120
 Mvav 172,28,184
 s_nop 2
 v_max3_f32 v192, v192, v36, v37
 v_max3_f32 v193, v193, v100, v101
 v_max3_f32 v194, v194, v164, v165
 v_max3_f32 v192, v192, v38, v39
 v_max3_f32 v193, v193, v102, v103
 v_max3_f32 v194, v194, v166, v167
 v_max3_f32 v192, v192, v44, v45
 v_max3_f32 v193, v193, v108, v109
 v_max3_f32 v194, v194, v172, v173
 v_max3_f32 v192, v192, v46, v47
 v_max3_f32 v193, v193, v110, v111
 v_max3_f32 v194, v194, v174, v175
 s_add_u32 s63, s63, 16384
 s_cmp_lt_u32 s63, 262144
 s_nop 7
 s_cbranch_scc1 LE0_maxloop
 s_mov_b32 m0, s64
 s_mov_b32 s32, s65
 s_branch LE0_maxback
LE1_maxpass:
 s_waitcnt vmcnt(0) lgkmcnt(0)
 s_nop 15
 s_mov_b32 s63, 0
 s_mov_b32 s64, m0
 s_mov_b32 s65, s32
LE1_maxloop:
 s_barrier
 s_barrier
 R 0,236,16384
 R 4,236,24576
 R 8,237,16384
 R 12,237,24576
 R 16,238,16384
 R 20,238,24576
 R 24,239,16384
 R 28,239,24576
 s_waitcnt lgkmcnt(7)
 Mvavz 52,0,0
 Mvavz 116,0,64
 Mvavz 180,0,128
 s_waitcnt lgkmcnt(6)
 Mvavz 60,4,0
 Mvavz 124,4,64
 Mvavz 188,4,128
 s_waitcnt lgkmcnt(5)
 Mvav 52,8,8
 Mvav 116,8,72
 Mvav 180,8,136
 s_waitcnt lgkmcnt(0)
 Mvav 60,12,8
 Mvav 124,12,72
 Mvav 188,12,136
 Mvav 52,16,16
 Mvav 116,16,80
 Mvav 180,16,144
 Mvav 60,20,16
 Mvav 124,20,80
 Mvav 188,20,144
 Mvav 52,24,24
 Mvav 116,24,88
 Mvav 180,24,152
 Mvav 60,28,24
 Mvav 124,28,88
 Mvav 188,28,152
 R 0,236,16640
 R 4,236,24832
 R 8,237,16640
 R 12,237,24832
 R 16,238,16640
 R 20,238,24832
 R 24,239,16640
 R 28,239,24832
 s_waitcnt lgkmcnt(7)
 Mvav 52,0,32
 Mvav 116,0,96
 Mvav 180,0,160
 s_waitcnt lgkmcnt(6)
 Mvav 60,4,32
 Mvav 124,4,96
 Mvav 188,4,160
 s_waitcnt lgkmcnt(5)
 Mvav 52,8,40
 Mvav 116,8,104
 Mvav 180,8,168
 s_waitcnt lgkmcnt(0)
 Mvav 60,12,40
 Mvav 124,12,104
 Mvav 188,12,168
 Mvav 52,16,48
 Mvav 116,16,112
 Mvav 180,16,176
 Mvav 60,20,48
 Mvav 124,20,112
 Mvav 188,20,176
 Mvav 52,24,56
 Mvav 116,24,120
 Mvav 180,24,184
 Mvav 60,28,56
 Mvav 124,28,120
 Mvav 188,28,184
 s_nop 2
 v_max3_f32 v192, v192, v52, v53
 v_max3_f32 v193, v193, v116, v117
 v_max3_f32 v194, v194, v180, v181
 v_max3_f32 v192, v192, v54, v55
 v_max3_f32 v193, v193, v118, v119
 v_max3_f32 v194, v194, v182, v183
 v_max3_f32 v192, v192, v60, v61
 v_max3_f32 v193, v193, v124, v125
 v_max3_f32 v194, v194, v188, v189
 v_max3_f32 v192, v192, v62, v63
 v_max3_f32 v193, v193, v126, v127
 v_max3_f32 v194, v194, v190, v191
 s_add_u32 s63, s63, 16384
 s_cmp_lt_u32 s63, 262144
 s_nop 7
 s_cbranch_scc1 LE1_maxloop
 s_mov_b32 m0, s64
 s_mov_b32 s32, s65
 s_branch LE1_maxback
.section .rodata,"a"
.p2align 6
.amdhsa_kernel concat_heads__mha_block_cached__gqa_block_cached__near_ridge_kernel
  .amdhsa_next_free_vgpr 512
  .amdhsa_next_free_sgpr 102
  .amdhsa_accum_offset 256
  .amdhsa_group_segment_fixed_size 0
  .amdhsa_kernarg_size 104
  .amdhsa_user_sgpr_count 2
  .amdhsa_user_sgpr_kernarg_segment_ptr 1
  .amdhsa_system_sgpr_workgroup_id_x 1
.end_amdhsa_kernel
```
